```python
import torch

def _softmax(x, axis=-1):
    return torch.softmax(x, dim=axis)
def _gelu(x):
    return torch.nn.functional.gelu(x, approximate="tanh")
def _silu(x):
    return torch.nn.functional.silu(x)
def _sigmoid(x):
    return torch.sigmoid(x)
def _layernorm(x, axis=-1, eps=1e-5):
    m = x.mean(dim=axis, keepdim=True)
    v = x.var(dim=axis, keepdim=True, unbiased=False)
    return (x - m) / torch.sqrt(v + eps)
def _scatter_add(tgt, idx, src, axis=0):
    return tgt.clone().index_add_(axis, idx, src)
def _segment_sum(src, seg, n):
    out = torch.zeros((n,) + src.shape[1:], dtype=src.dtype)
    return out.index_add_(0, seg, src)
def _pad(x, pw):
    flat = tuple(v for pair in reversed(pw) for v in pair)
    return torch.nn.functional.pad(x, flat)

kernel_name = 'recurrent_scan__mha_block_cached__dense_activation_silu__prompt'

def setup_inputs():

    _w = (lambda a: (lambda t: t.to(torch.bfloat16) if t.is_floating_point() else t)(torch.as_tensor(a)))
    def _A_setup():
        B, Sq, D = 1, 2048, 512
        H, Sk, Dh = 32, 2048, 128
        return {
            "x": _w((lambda *s: torch.randn(*s, dtype=torch.bfloat16) * 0.05)(B, Sq, D)),
            "k_cache": _w((lambda *s: torch.randn(*s, dtype=torch.bfloat16) * 3.2)(B, H, Sk, Dh)),
            "v_cache": _w((lambda *s: torch.randn(*s, dtype=torch.bfloat16) * 3.2)(B, H, Sk, Dh)),
            "wq": _w((lambda *s: torch.randn(*s, dtype=torch.bfloat16) * 3.2)(D, H * Dh) * (D ** -0.5)),
            "wo": _w((lambda *s: torch.randn(*s, dtype=torch.bfloat16) * 3.2)(H * Dh, D) * ((H * Dh) ** -0.5)),
        }
    _A_in = _A_setup()

    def _B_setup():
        B, S, D, F = 1, 2048, 512, 1792
        return {
            "x": _w((lambda *s: torch.randn(*s, dtype=torch.bfloat16) * 0.05)(B, S, D)),
            "w1": _w((lambda *s: torch.randn(*s, dtype=torch.bfloat16) * 3.2)(D, F) * (D ** -0.5)),
            "w2": _w((lambda *s: torch.randn(*s, dtype=torch.bfloat16) * 0.4)(F, D) * (F ** -0.5)),
        }
    _B_in = _B_setup()

    return {
        "A_x": _A_in["x"],
        "A_k_cache": _A_in["k_cache"],
        "A_v_cache": _A_in["v_cache"],
        "A_wq": _A_in["wq"],
        "A_wo": _A_in["wo"],
        "B_x": _B_in["x"],
        "B_w1": _B_in["w1"],
        "B_w2": _B_in["w2"],
    }

def reference(A_x, A_k_cache, A_v_cache, A_wq, A_wo, B_x, B_w1, B_w2):
    def _A_ref(x, k_cache, v_cache, wq, wo):
        B, Sq, D = x.shape
        H, Dh = 32, 128
        q = (lambda x, *d: x.permute(*d))((x @ wq).reshape(B, Sq, H, Dh), 0, 2, 1, 3)
        scores = torch.einsum("bhqd,bhkd->bhqk", q, k_cache) * (Dh ** -0.5)
        p = _softmax(scores, axis=-1)
        o = torch.einsum("bhqk,bhkd->bhqd", p, v_cache)
        return (lambda x, *d: x.permute(*d))(o, 0, 2, 1, 3).reshape(B, Sq, H * Dh) @ wo

    def _B_ref(x, w1, w2):
        h = torch.einsum("bsd,df->bsf", x, w1)
        h = _silu(h)
        out = torch.einsum("bsf,fd->bsd", h, w2)
        return out

    x = A_x
    xn = _layernorm(x, axis=-1)
    s = _A_ref(xn, A_k_cache, A_v_cache, A_wq, A_wo)
    g = _silu(_B_ref(xn, B_w1, B_w2))
    return x + s * g
```

```asm
; @launch grid=(256,1,1) block=(256,1,1) lds=163840
.amdgcn_target "amdgcn-amd-amdhsa--gfx950"
.text
.p2align 12
.globl recurrent_scan__mha_block_cached__dense_activation_silu__prompt_kernel
.p2align 8
.type recurrent_scan__mha_block_cached__dense_activation_silu__prompt_kernel,@function
recurrent_scan__mha_block_cached__dense_activation_silu__prompt_kernel:
    s_cmp_ge_u32 s2, 256
    s_cbranch_scc1 L2_end
    s_load_dwordx4 s[4:7], s[0:1], 8
    s_load_dwordx2 s[36:37], s[0:1], 24
    s_load_dwordx2 s[38:39], s[0:1], 48
    s_load_dwordx2 s[72:73], s[0:1], 32
    s_load_dwordx2 s[74:75], s[0:1], 56
    s_load_dwordx2 s[40:41], s[0:1], 80
    s_load_dwordx2 s[88:89], s[0:1], 0
    s_load_dwordx4 s[92:95], s[0:1], 64
    s_getpc_b64 s[56:57]
L_cpf:
    s_lshr_b32 s3, s2, 1
    s_and_b32 s3, s3, 0x7c
    v_lshrrev_b32 v228, 6, v0
    v_and_b32 v230, 63, v0
    v_add_u32 v228, s3, v228
    v_min_u32 v230, 3, v230
    v_mad_u32_u24 v228, v228, 4, v230
    v_lshlrev_b32 v228, 7, v228
    v_min_u32 v228, L2_end-L_cpf, v228
    v_mov_b32 v229, s57
    v_add_co_u32 v228, vcc, s56, v228
    s_nop 1
    v_addc_co_u32 v229, vcc, 0, v229, vcc
    global_load_dword v254, v[228:229], off
    v_lshrrev_b32 v212, 6, v0
    v_and_b32 v213, 63, v0
    s_and_b32 s42, s2, 7
    s_lshl_b32 s42, s42, 2
    s_lshr_b32 s3, s2, 3
    s_and_b32 s3, s3, 3
    s_add_u32 s42, s42, s3
    s_lshr_b32 s43, s2, 5
    v_readfirstlane_b32 s44, v212
    v_lshrrev_b32 v214, 4, v213
    v_and_b32 v215, 15, v213
    v_lshrrev_b32 v216, 2, v215
    v_and_b32 v217, 3, v213
    v_lshlrev_b32 v211, 4, v213
    s_lshl_b32 s45, s44, 11
    s_lshl_b32 s46, s44, 10
    s_and_b32 s3, s44, 1
    s_lshl_b32 s3, s3, 1
    v_and_b32 v220, 1, v214
    v_or_b32 v220, s3, v220
    v_lshlrev_b32 v218, 2, v220
    v_xor_b32 v218, v218, v215
    v_lshlrev_b32 v218, 4, v218
    s_lshl_b32 s51, s44, 3
    v_add_u32 v219, s51, v214
    v_lshl_add_u32 v204, v219, 13, v218
    v_add_u32 v205, 31744, v204
    v_lshrrev_b32 v219, 3, v213
    v_lshlrev_b32 v220, 1, v220
    v_and_b32 v218, 7, v213
    v_xor_b32 v218, v218, v220
    v_lshlrev_b32 v218, 4, v218
    v_add_u32 v219, s51, v219
    v_mul_u32_u24 v219, 3584, v219
    v_add_u32 v206, v219, v218
    s_lshl_b32 s3, s43, 8
    s_lshl_b32 s51, s44, 6
    s_add_u32 s3, s3, s51
    v_lshrrev_b32 v218, 4, v213
    v_bfe_u32 v219, v213, 3, 1
    v_lshl_add_u32 v219, v219, 3, v218
    v_add_u32 v219, s3, v219
    v_and_b32 v220, 7, v213
    v_xor_b32 v218, v218, v220
    v_lshlrev_b32 v218, 4, v218
    v_lshl_add_u32 v207, v219, 10, v218
    v_xor_b32 v208, 64, v207
    v_add_u32 v208, 3072, v208
    s_waitcnt lgkmcnt(0)
    s_lshl_b32 s3, s42, 8
    s_add_u32 s16, s36, s3
    s_addc_u32 s17, s37, 0
    s_sub_u32 s18, 0x400000, s3
    s_mov_b32 s19, 0x00020000
    s_mov_b32 s76, s88
    s_mov_b32 s77, s89
    s_mov_b32 s78, 0x200000
    s_mov_b32 s79, 0x00020000
    s_min_u32 s3, s42, 27
    s_lshl_b32 s3, s3, 7
    s_add_u32 s20, s38, s3
    s_addc_u32 s21, s39, 0
    s_sub_u32 s22, 1835008, s3
    s_mov_b32 s23, 0x00020000
    s_add_u32 m0, s45, 0x16000
    s_mov_b32 s51, 0x0
    buffer_load_dwordx4 v204, s[16:19], s51 offen lds
    buffer_load_dwordx4 v205, s[16:19], s51 offen offset:1024 lds
    s_add_u32 m0, s46, 0x18000
    s_mov_b32 s51, 0x0
    buffer_load_dwordx4 v206, s[20:23], s51 offen lds
    s_add_u32 m0, s45, 0x0
    s_mov_b32 s52, 0x0
    buffer_load_dwordx4 v207, s[76:79], s52 offen lds
    buffer_load_dwordx4 v208, s[76:79], s52 offen offset:1024 lds
    s_add_u32 m0, s45, 0x2000
    s_mov_b32 s52, 0x4000
    buffer_load_dwordx4 v207, s[76:79], s52 offen lds
    buffer_load_dwordx4 v208, s[76:79], s52 offen offset:1024 lds
    s_add_u32 m0, s45, 0x4000
    s_mov_b32 s52, 0x8000
    buffer_load_dwordx4 v207, s[76:79], s52 offen lds
    buffer_load_dwordx4 v208, s[76:79], s52 offen offset:1024 lds
    s_add_u32 m0, s45, 0x6000
    s_mov_b32 s52, 0xc000
    buffer_load_dwordx4 v207, s[76:79], s52 offen lds
    buffer_load_dwordx4 v208, s[76:79], s52 offen offset:1024 lds
    s_lshl_b32 s3, s2, 3
    s_lshl_b32 s51, s44, 1
    s_add_u32 s3, s3, s51
    s_lshl_b32 s3, s3, 10
    v_lshrrev_b32 v236, 9, v211
    v_and_b32 v237, 0x1f0, v211
    v_lshl_add_u32 v236, v236, 10, v237
    buffer_load_dwordx4 v[228:231], v236, s[76:79], s3 offen offset:0
    buffer_load_dwordx4 v[232:235], v236, s[76:79], s3 offen offset:512
    s_add_u32 m0, s45, 0x19000
    s_mov_b32 s51, 0x40000
    buffer_load_dwordx4 v204, s[16:19], s51 offen lds
    buffer_load_dwordx4 v205, s[16:19], s51 offen offset:1024 lds
    s_add_u32 m0, s46, 0x1b000
    s_mov_b32 s51, 0x1c000
    buffer_load_dwordx4 v206, s[20:23], s51 offen lds
    v_and_b32 v218, 1, v216
    v_and_b32 v220, 1, v214
    v_lshl_add_u32 v220, v220, 1, v218
    v_lshl_add_u32 v219, v214, 3, v216
    v_lshlrev_b32 v219, 8, v219
    v_lshl_add_u32 v219, v217, 4, v219
    v_add_u32 v219, 0x16000, v219
    v_xor_b32 v218, 0, v220
    v_lshl_add_u32 v196, v218, 6, v219
    v_xor_b32 v218, 1, v220
    v_lshl_add_u32 v197, v218, 6, v219
    v_xor_b32 v218, 2, v220
    v_lshl_add_u32 v198, v218, 6, v219
    v_xor_b32 v218, 3, v220
    v_lshl_add_u32 v199, v218, 6, v219
    v_xor_b32 v218, s44, v220
    v_lshl_add_u32 v209, v218, 6, v219
    v_lshrrev_b32 v218, 1, v216
    v_and_b32 v220, 1, v214
    v_lshl_add_u32 v220, v220, 1, v218
    v_lshl_add_u32 v219, v214, 3, v216
    v_lshlrev_b32 v219, 7, v219
    v_lshl_add_u32 v219, v217, 3, v219
    v_add_u32 v219, 0x18000, v219
    v_xor_b32 v218, 0, v220
    v_lshl_add_u32 v200, v218, 5, v219
    v_xor_b32 v218, 1, v220
    v_lshl_add_u32 v201, v218, 5, v219
    v_xor_b32 v218, 2, v220
    v_lshl_add_u32 v202, v218, 5, v219
    v_xor_b32 v218, 3, v220
    v_lshl_add_u32 v203, v218, 5, v219
    v_xor_b32 v218, s44, v220
    v_lshl_add_u32 v210, v218, 5, v219
    v_and_b32 v220, 7, v215
    v_lshrrev_b32 v218, 3, v215
    v_lshl_add_u32 v218, v220, 1, v218
    v_lshlrev_b32 v218, 7, v218
    v_add_u32 v218, s45, v218
    v_xor_b32 v220, v220, v214
    v_lshl_add_u32 v176, v220, 4, v218
    v_xor_b32 v177, 64, v176
    s_lshl_b32 s3, s42, 19
    s_add_u32 s8, s4, s3
    s_addc_u32 s9, s5, 0
    s_mov_b32 s10, 0x80000
    s_mov_b32 s11, 0x00020000
    s_add_u32 s12, s6, s3
    s_addc_u32 s13, s7, 0
    s_mov_b32 s14, 0x80000
    s_mov_b32 s15, 0x00020000
    s_mov_b32 s24, s40
    s_mov_b32 s25, s41
    s_mov_b32 s26, 0x2000000
    s_mov_b32 s27, 0x00020000
    s_add_u32 s28, s40, 0x200000
    s_addc_u32 s29, s41, 0
    s_mov_b32 s30, 0x700000
    s_mov_b32 s31, 0x00020000
    s_cmp_ge_u32 s42, 28
    s_cselect_b32 s30, 0, s30
    s_add_u32 s32, s40, 0x1000000
    s_addc_u32 s33, s41, 0
    s_mov_b32 s34, 0x1000000
    s_mov_b32 s35, 0x00020000
    s_mov_b32 s60, s72
    s_mov_b32 s61, s73
    s_mov_b32 s62, 0x400000
    s_mov_b32 s63, 0x00020000
    s_mov_b32 s64, s74
    s_mov_b32 s65, s75
    s_mov_b32 s66, 0x1c0000
    s_mov_b32 s67, 0x00020000
    s_add_u32 s68, s40, 0xa00000
    s_addc_u32 s69, s41, 0
    s_mov_b32 s70, 0x5c0000
    s_mov_b32 s71, 0x00020000
    s_mov_b32 s80, s92
    s_mov_b32 s81, s93
    s_mov_b32 s82, 0x200000
    s_mov_b32 s83, 0x00020000
    s_mov_b32 s84, s94
    s_mov_b32 s85, s95
    s_mov_b32 s86, 0x100
    s_mov_b32 s87, 0x00020000
    v_add_u32 v218, 0, v214
    v_xor_b32 v218, v218, v215
    v_lshlrev_b32 v218, 4, v218
    v_lshl_add_u32 v180, v215, 8, v218
    v_add_u32 v218, 4, v214
    v_xor_b32 v218, v218, v215
    v_lshlrev_b32 v218, 4, v218
    v_lshl_add_u32 v181, v215, 8, v218
    v_add_u32 v218, 8, v214
    v_xor_b32 v218, v218, v215
    v_lshlrev_b32 v218, 4, v218
    v_lshl_add_u32 v182, v215, 8, v218
    v_add_u32 v218, 12, v214
    v_xor_b32 v218, v218, v215
    v_lshlrev_b32 v218, 4, v218
    v_lshl_add_u32 v183, v215, 8, v218
    v_lshl_add_u32 v219, v214, 2, v216
    v_and_b32 v220, 7, v219
    v_lshlrev_b32 v219, 8, v219
    v_lshl_add_u32 v219, v217, 3, v219
    v_add_u32 v219, 0x10000, v219
    v_xor_b32 v218, 0, v220
    v_lshl_add_u32 v184, v218, 5, v219
    v_xor_b32 v218, 1, v220
    v_lshl_add_u32 v185, v218, 5, v219
    v_xor_b32 v218, 2, v220
    v_lshl_add_u32 v186, v218, 5, v219
    v_xor_b32 v218, 3, v220
    v_lshl_add_u32 v187, v218, 5, v219
    v_xor_b32 v218, 4, v220
    v_lshl_add_u32 v188, v218, 5, v219
    v_xor_b32 v218, 5, v220
    v_lshl_add_u32 v189, v218, 5, v219
    v_xor_b32 v218, 6, v220
    v_lshl_add_u32 v190, v218, 5, v219
    v_xor_b32 v218, 7, v220
    v_lshl_add_u32 v191, v218, 5, v219
    v_mov_b32 v219, s44
    v_lshl_add_u32 v219, v219, 3, v214
    v_add_u32 v218, 0, v219
    v_and_b32 v218, 15, v218
    v_xor_b32 v218, v218, v215
    v_lshlrev_b32 v218, 4, v218
    v_lshl_add_u32 v192, v219, 8, v218
    v_add_u32 v218, 0, v214
    v_lshlrev_b32 v218, 1, v218
    v_xor_b32 v218, v218, v215
    v_lshlrev_b32 v218, 4, v218
    v_lshl_add_u32 v194, v219, 8, v218
    v_add_u32 v218, 4, v219
    v_and_b32 v218, 15, v218
    v_xor_b32 v218, v218, v215
    v_lshlrev_b32 v218, 4, v218
    v_lshl_add_u32 v193, v219, 8, v218
    v_add_u32 v218, 4, v214
    v_lshlrev_b32 v218, 1, v218
    v_xor_b32 v218, v218, v215
    v_lshlrev_b32 v218, 4, v218
    v_lshl_add_u32 v195, v219, 8, v218
    v_lshrrev_b32 v219, 3, v213
    v_mul_u32_u24 v219, 753664, v219
    v_and_b32 v220, 7, v213
    s_lshl_b32 s51, s44, 1
    s_add_u32 s3, s51, 0
    s_and_b32 s3, s3, 3
    s_lshl_b32 s3, s3, 1
    v_xor_b32 v218, s3, v220
    v_lshl_add_u32 v244, v218, 4, v219
    s_add_u32 s3, s51, 1
    s_and_b32 s3, s3, 3
    s_lshl_b32 s3, s3, 1
    v_xor_b32 v218, s3, v220
    v_lshl_add_u32 v245, v218, 4, v219
    s_mul_i32 s52, s2, 7
    s_add_u32 s52, s52, s51
    s_add_u32 s3, s52, 0
    s_min_u32 s3, s3, 1791
    s_lshl_b32 s56, s3, 10
    s_lshr_b32 s53, s3, 5
    s_add_u32 s53, s53, 128
    s_lshl_b32 s53, s53, 12
    s_and_b32 s51, s3, 31
    s_lshl_b32 s51, s51, 7
    s_add_u32 s58, s53, s51
    s_lshr_b32 s3, s3, 1
    s_and_b32 s3, s3, 3
    s_lshl_b32 s3, s3, 1
    v_xor_b32 v218, s3, v220
    v_lshl_add_u32 v246, v218, 4, v219
    s_add_u32 s3, s52, 1
    s_min_u32 s3, s3, 1791
    s_lshl_b32 s57, s3, 10
    s_lshr_b32 s53, s3, 5
    s_add_u32 s53, s53, 128
    s_lshl_b32 s53, s53, 12
    s_and_b32 s51, s3, 31
    s_lshl_b32 s51, s51, 7
    s_add_u32 s59, s53, s51
    s_lshr_b32 s3, s3, 1
    s_and_b32 s3, s3, 3
    s_lshl_b32 s3, s3, 1
    v_xor_b32 v218, s3, v220
    v_lshl_add_u32 v247, v218, 4, v219
    s_lshl_b32 s3, s43, 4
    s_lshl_b32 s51, s44, 2
    s_add_u32 s3, s3, s51
    s_mul_i32 s54, s3, 57344
    s_lshl_b32 s55, s3, 17
    s_lshl_b32 s51, s42, 12
    s_add_u32 s55, s55, s51
    s_lshl_b32 s3, s2, 4
    s_lshl_b32 s51, s44, 2
    s_add_u32 s3, s3, s51
    s_lshl_b32 s4, s3, 10
    s_lshr_b32 s51, s3, 5
    s_lshl_b32 s51, s51, 12
    s_and_b32 s3, s3, 31
    s_lshl_b32 s3, s3, 7
    s_add_u32 s5, s51, s3
    s_mov_b32 s6, 0x3e0293ee
    s_mov_b32 s7, 0x3e0293ee
    s_mov_b32 s50, 0
    v_mov_b32 v212, 0x3f803f80
    v_accvgpr_write_b32 a140, v212
    v_accvgpr_write_b32 a141, v212
    v_accvgpr_write_b32 a142, v212
    v_accvgpr_write_b32 a143, v212
    s_and_b32 s3, s2, 3
    s_lshl_b32 s51, s43, 2
    s_add_u32 s51, s51, s3
    s_lshr_b32 s3, s2, 2
    s_and_b32 s3, s3, 1
    s_lshl_b32 s3, s3, 2
    s_lshr_b32 s52, s2, 3
    s_and_b32 s52, s52, 3
    s_add_u32 s52, s52, s3
    s_lshl_b32 s3, s51, 6
    s_lshl_b32 s53, s44, 4
    s_add_u32 s3, s3, s53
    v_add_u32 v218, s3, v215
    v_lshlrev_b32 v218, 10, v218
    v_lshl_add_u32 v218, v214, 3, v218
    s_lshl_b32 s3, s52, 7
    v_add_u32 v252, s3, v218
    s_lshl_b32 s51, s51, 2
    s_mul_i32 s3, s51, 56
    s_mul_i32 s53, s44, 1
    s_add_u32 s3, s3, s53
    s_lshl_b32 s3, s3, 10
    s_add_u32 s38, s3, 0x200000
    s_lshl_b32 s3, s51, 7
    s_lshl_b32 s53, s44, 5
    s_add_u32 s3, s3, s53
    s_lshl_b32 s3, s3, 10
    s_add_u32 s39, s3, 0x1000000
    s_mul_i32 s3, s52, 753664
    s_mul_i32 s53, s44, 131072
    s_add_u32 s36, s3, s53
    s_mul_i32 s53, s44, 4096
    s_add_u32 s3, s3, s53
    s_add_u32 s37, s3, 524288
    s_lshl_b32 s95, s44, 12
    v_and_b32 v220, 1, v214
    v_lshrrev_b32 v218, 1, v216
    v_lshl_add_u32 v220, v220, 1, v218
    v_lshl_add_u32 v219, v214, 2, v216
    v_lshlrev_b32 v219, 7, v219
    v_lshl_add_u32 v219, v217, 3, v219
    v_add_u32 v219, s95, v219
    v_xor_b32 v218, 0, v220
    v_lshl_add_u32 v248, v218, 5, v219
    v_xor_b32 v218, 1, v220
    v_lshl_add_u32 v249, v218, 5, v219
    v_xor_b32 v218, 2, v220
    v_lshl_add_u32 v250, v218, 5, v219
    v_xor_b32 v218, 3, v220
    v_lshl_add_u32 v251, v218, 5, v219
    v_lshlrev_b32 v253, 2, v213
    s_and_b32 s73, s2, 0xe0
    s_mov_b32 s75, 5
    s_lshl_b32 s3, s43, 7
    s_add_u32 s3, s3, 0x4000
    buffer_load_dword v227, off, s[24:27], s3 sc1
    s_add_u32 m0, s45, 0x1c000
    s_mov_b32 s51, 0x80000
    buffer_load_dwordx4 v204, s[16:19], s51 offen lds
    buffer_load_dwordx4 v205, s[16:19], s51 offen offset:1024 lds
    s_add_u32 m0, s46, 0x1e000
    s_mov_b32 s51, 0x38000
    buffer_load_dwordx4 v206, s[20:23], s51 offen lds
    s_add_u32 m0, s45, 0x8000
    s_mov_b32 s52, 0x80
    buffer_load_dwordx4 v207, s[76:79], s52 offen lds
    buffer_load_dwordx4 v208, s[76:79], s52 offen offset:1024 lds
    s_add_u32 m0, s45, 0xa000
    s_mov_b32 s52, 0x4080
    buffer_load_dwordx4 v207, s[76:79], s52 offen lds
    buffer_load_dwordx4 v208, s[76:79], s52 offen offset:1024 lds
    s_add_u32 m0, s45, 0xc000
    s_mov_b32 s52, 0x8080
    buffer_load_dwordx4 v207, s[76:79], s52 offen lds
    buffer_load_dwordx4 v208, s[76:79], s52 offen offset:1024 lds
    s_add_u32 m0, s45, 0xe000
    s_mov_b32 s52, 0xc080
    buffer_load_dwordx4 v207, s[76:79], s52 offen lds
    buffer_load_dwordx4 v208, s[76:79], s52 offen offset:1024 lds
    s_waitcnt vmcnt(17)
    s_barrier
    ds_read_b128 a[0:3], v176 offset:0
    ds_read_b128 a[4:7], v176 offset:8192
    ds_read_b128 a[8:11], v176 offset:16384
    ds_read_b128 a[12:15], v176 offset:24576
    ds_read_b64_tr_b16 v[128:129], v196 offset:0
    ds_read_b64_tr_b16 v[130:131], v196 offset:1024
    ds_read_b64_tr_b16 v[132:133], v196 offset:8
    ds_read_b64_tr_b16 v[134:135], v196 offset:1032
    ds_read_b64_tr_b16 v[136:137], v197 offset:0
    ds_read_b64_tr_b16 v[138:139], v197 offset:1024
    ds_read_b64_tr_b16 v[140:141], v197 offset:8
    ds_read_b64_tr_b16 v[142:143], v197 offset:1032
    ds_read_b64_tr_b16 v[144:145], v198 offset:0
    ds_read_b64_tr_b16 v[146:147], v198 offset:1024
    ds_read_b64_tr_b16 v[148:149], v198 offset:8
    ds_read_b64_tr_b16 v[150:151], v198 offset:1032
    ds_read_b64_tr_b16 v[152:153], v199 offset:0
    ds_read_b64_tr_b16 v[154:155], v199 offset:1024
    ds_read_b128 a[16:19], v177 offset:0
    ds_read_b128 a[20:23], v177 offset:8192
    ds_read_b128 a[24:27], v177 offset:16384
    ds_read_b128 a[28:31], v177 offset:24576
    s_waitcnt lgkmcnt(15)
    v_mfma_f32_16x16x32_bf16 v[0:3], v[128:131], a[0:3], 0
    ds_read_b64_tr_b16 v[212:213], v209 offset:0
    ds_read_b64_tr_b16 v[214:215], v209 offset:1024
    v_mfma_f32_16x16x32_bf16 v[8:11], v[128:131], a[4:7], 0
    ds_read_b64_tr_b16 v[156:157], v199 offset:8
    ds_read_b64_tr_b16 v[158:159], v199 offset:1032
    v_mfma_f32_16x16x32_bf16 v[16:19], v[128:131], a[8:11], 0
    ds_read_b64_tr_b16 v[216:217], v209 offset:8
    ds_read_b64_tr_b16 v[218:219], v209 offset:1032
    v_mfma_f32_16x16x32_bf16 v[24:27], v[128:131], a[12:15], 0
    s_waitcnt lgkmcnt(15)
    ds_read_b64_tr_b16 v[220:221], v210 offset:0
    ds_read_b64_tr_b16 v[222:223], v210 offset:512
    v_mfma_f32_16x16x32_bf16 v[4:7], v[132:135], a[0:3], 0
    s_add_u32 m0, s45, 0x1f000
    s_mov_b32 s51, 0xc0000
    buffer_load_dwordx4 v204, s[16:19], s51 offen lds
    v_mfma_f32_16x16x32_bf16 v[12:15], v[132:135], a[4:7], 0
    ds_read_b64_tr_b16 v[160:161], v200 offset:0
    ds_read_b64_tr_b16 v[162:163], v200 offset:512
    v_mfma_f32_16x16x32_bf16 v[20:23], v[132:135], a[8:11], 0
    buffer_load_dwordx4 v205, s[16:19], s51 offen offset:1024 lds
    v_mfma_f32_16x16x32_bf16 v[28:31], v[132:135], a[12:15], 0
    s_add_u32 m0, s46, 0x21000
    s_mov_b32 s51, 0x54000
    buffer_load_dwordx4 v206, s[20:23], s51 offen lds
    v_mfma_f32_16x16x32_bf16 v[32:35], v[136:139], a[0:3], 0
    v_mfma_f32_16x16x32_bf16 v[40:43], v[136:139], a[4:7], 0
    ds_read_b64_tr_b16 v[164:165], v201 offset:0
    ds_read_b64_tr_b16 v[166:167], v201 offset:512
    v_mfma_f32_16x16x32_bf16 v[48:51], v[136:139], a[8:11], 0
    s_add_u32 m0, s45, 0x22000
    s_mov_b32 s51, 0x100000
    buffer_load_dwordx4 v204, s[16:19], s51 offen lds
    v_mfma_f32_16x16x32_bf16 v[56:59], v[136:139], a[12:15], 0
    buffer_load_dwordx4 v205, s[16:19], s51 offen offset:1024 lds
    v_mfma_f32_16x16x32_bf16 v[36:39], v[140:143], a[0:3], 0
    v_mfma_f32_16x16x32_bf16 v[44:47], v[140:143], a[4:7], 0
    ds_read_b64_tr_b16 v[168:169], v202 offset:0
    ds_read_b64_tr_b16 v[170:171], v202 offset:512
    v_mfma_f32_16x16x32_bf16 v[52:55], v[140:143], a[8:11], 0
    s_add_u32 m0, s46, 0x24000
    s_mov_b32 s51, 0x70000
    buffer_load_dwordx4 v206, s[20:23], s51 offen lds
    v_mfma_f32_16x16x32_bf16 v[60:63], v[140:143], a[12:15], 0
    s_waitcnt lgkmcnt(15)
    s_add_u32 m0, s45, 0x25000
    s_mov_b32 s51, 0x140000
    buffer_load_dwordx4 v204, s[16:19], s51 offen lds
    s_waitcnt lgkmcnt(6)
    v_mfma_f32_16x16x32_bf16 a[128:131], v[212:215], a[140:143], 0
    buffer_load_dwordx4 v205, s[16:19], s51 offen offset:1024 lds
    v_mfma_f32_16x16x32_bf16 a[132:135], v[216:219], a[140:143], 0
    v_mfma_f32_16x16x32_bf16 a[136:139], v[220:223], a[140:143], 0
    s_add_u32 m0, s46, 0x27000
    s_mov_b32 s51, 0x8c000
    buffer_load_dwordx4 v206, s[20:23], s51 offen lds
    v_mfma_f32_16x16x32_bf16 v[64:67], v[144:147], a[0:3], 0
    s_waitcnt vmcnt(24)
    v_lshlrev_b32 v236, 16, v228
    v_mfma_f32_16x16x32_bf16 v[72:75], v[144:147], a[4:7], 0
    ds_read_b64_tr_b16 v[172:173], v203 offset:0
    ds_read_b64_tr_b16 v[174:175], v203 offset:512
    v_mfma_f32_16x16x32_bf16 v[80:83], v[144:147], a[8:11], 0
    v_mfma_f32_16x16x32_bf16 v[88:91], v[144:147], a[12:15], 0
    s_mov_b64 exec, 0
    s_cmp_eq_u32 s44, 0
    s_cbranch_scc1 L_it2
    s_cmp_eq_u32 s44, 1
    s_cbranch_scc1 L_it3
    s_cmp_eq_u32 s44, 2
    s_cbranch_scc1 L_it4
    s_cmp_eq_u32 s44, 3
    s_cbranch_scc1 L_it5
L_itrB:
    s_mov_b64 exec, -1
    s_waitcnt vmcnt(21)
    s_barrier
    v_mfma_f32_16x16x32_bf16 v[68:71], v[148:151], a[0:3], 0
    ds_read_b64_tr_b16 v[212:213], v209 offset:12288
    ds_read_b64_tr_b16 v[214:215], v209 offset:13312
    v_mfma_f32_16x16x32_bf16 v[76:79], v[148:151], a[4:7], 0
    ds_read_b64_tr_b16 v[128:129], v196 offset:12288
    ds_read_b64_tr_b16 v[130:131], v196 offset:13312
    v_mfma_f32_16x16x32_bf16 v[84:87], v[148:151], a[8:11], 0
    ds_read_b64_tr_b16 v[216:217], v209 offset:12296
    ds_read_b64_tr_b16 v[218:219], v209 offset:13320
    v_mfma_f32_16x16x32_bf16 v[92:95], v[148:151], a[12:15], 0
    ds_read_b64_tr_b16 v[220:221], v210 offset:12288
    ds_read_b64_tr_b16 v[222:223], v210 offset:12800
    v_mfma_f32_16x16x32_bf16 v[96:99], v[152:155], a[0:3], 0
    s_add_u32 m0, s45, 0x0
    s_mov_b32 s52, 0x100
    buffer_load_dwordx4 v207, s[76:79], s52 offen lds
    v_mfma_f32_16x16x32_bf16 v[104:107], v[152:155], a[4:7], 0
    ds_read_b64_tr_b16 v[132:133], v196 offset:12296
    ds_read_b64_tr_b16 v[134:135], v196 offset:13320
    v_mfma_f32_16x16x32_bf16 v[112:115], v[152:155], a[8:11], 0
    buffer_load_dwordx4 v208, s[76:79], s52 offen offset:1024 lds
    v_mfma_f32_16x16x32_bf16 v[120:123], v[152:155], a[12:15], 0
    s_add_u32 m0, s45, 0x2000
    s_mov_b32 s52, 0x4100
    buffer_load_dwordx4 v207, s[76:79], s52 offen lds
    v_mfma_f32_16x16x32_bf16 v[100:103], v[156:159], a[0:3], 0
    buffer_load_dwordx4 v208, s[76:79], s52 offen offset:1024 lds
    v_mfma_f32_16x16x32_bf16 v[108:111], v[156:159], a[4:7], 0
    ds_read_b64_tr_b16 v[136:137], v197 offset:12288
    ds_read_b64_tr_b16 v[138:139], v197 offset:13312
    v_mfma_f32_16x16x32_bf16 v[116:119], v[156:159], a[8:11], 0
    s_add_u32 m0, s45, 0x4000
    s_mov_b32 s52, 0x8100
    buffer_load_dwordx4 v207, s[76:79], s52 offen lds
    v_mfma_f32_16x16x32_bf16 v[124:127], v[156:159], a[12:15], 0
    s_waitcnt lgkmcnt(15)
    buffer_load_dwordx4 v208, s[76:79], s52 offen offset:1024 lds
    v_mfma_f32_16x16x32_bf16 a[192:195], v[160:163], a[0:3], 0
    s_add_u32 m0, s45, 0x6000
    s_mov_b32 s52, 0xc100
    buffer_load_dwordx4 v207, s[76:79], s52 offen lds
    v_mfma_f32_16x16x32_bf16 a[196:199], v[160:163], a[4:7], 0
    ds_read_b64_tr_b16 v[140:141], v197 offset:12296
    ds_read_b64_tr_b16 v[142:143], v197 offset:13320
    v_mfma_f32_16x16x32_bf16 a[200:203], v[160:163], a[8:11], 0
    buffer_load_dwordx4 v208, s[76:79], s52 offen offset:1024 lds
    v_mfma_f32_16x16x32_bf16 a[204:207], v[160:163], a[12:15], 0
    v_and_b32 v237, 0xffff0000, v228
    v_lshlrev_b32 v240, 16, v229
    v_mfma_f32_16x16x32_bf16 a[208:211], v[164:167], a[0:3], 0
    v_and_b32 v241, 0xffff0000, v229
    v_add_f32 v236, v236, v240
    v_mfma_f32_16x16x32_bf16 a[212:215], v[164:167], a[4:7], 0
    ds_read_b64_tr_b16 v[144:145], v198 offset:12288
    ds_read_b64_tr_b16 v[146:147], v198 offset:13312
    v_mfma_f32_16x16x32_bf16 a[216:219], v[164:167], a[8:11], 0
    v_mfma_f32_16x16x32_bf16 a[220:223], v[164:167], a[12:15], 0
    s_waitcnt lgkmcnt(15)
    v_add_f32 v237, v237, v241
    v_lshlrev_b32 v242, 16, v230
    s_waitcnt lgkmcnt(8)
    v_mfma_f32_16x16x32_bf16 a[128:131], v[212:215], a[140:143], a[128:131]
    v_and_b32 v243, 0xffff0000, v230
    v_add_f32 v236, v236, v242
    v_mfma_f32_16x16x32_bf16 a[132:135], v[216:219], a[140:143], a[132:135]
    v_add_f32 v237, v237, v243
    v_lshlrev_b32 v240, 16, v231
    v_mfma_f32_16x16x32_bf16 a[136:139], v[220:223], a[140:143], a[136:139]
    v_and_b32 v241, 0xffff0000, v231
    v_add_f32 v236, v236, v240
    v_mfma_f32_16x16x32_bf16 a[224:227], v[168:171], a[0:3], 0
    v_add_f32 v237, v237, v241
    v_lshlrev_b32 v242, 16, v232
    v_mfma_f32_16x16x32_bf16 a[228:231], v[168:171], a[4:7], 0
    ds_read_b64_tr_b16 v[148:149], v198 offset:12296
    ds_read_b64_tr_b16 v[150:151], v198 offset:13320
    v_mfma_f32_16x16x32_bf16 a[232:235], v[168:171], a[8:11], 0
    v_and_b32 v243, 0xffff0000, v232
    v_add_f32 v236, v236, v242
    v_mfma_f32_16x16x32_bf16 a[236:239], v[168:171], a[12:15], 0
    v_add_f32 v237, v237, v243
    v_lshlrev_b32 v240, 16, v233
    v_mfma_f32_16x16x32_bf16 a[240:243], v[172:175], a[0:3], 0
    v_and_b32 v241, 0xffff0000, v233
    v_add_f32 v236, v236, v240
    v_mfma_f32_16x16x32_bf16 a[244:247], v[172:175], a[4:7], 0
    ds_read_b64_tr_b16 v[152:153], v199 offset:12288
    ds_read_b64_tr_b16 v[154:155], v199 offset:13312
    v_mfma_f32_16x16x32_bf16 a[248:251], v[172:175], a[8:11], 0
    v_add_f32 v237, v237, v241
    v_lshlrev_b32 v242, 16, v234
    v_mfma_f32_16x16x32_bf16 a[252:255], v[172:175], a[12:15], 0
    v_mfma_f32_16x16x32_bf16 v[0:3], v[128:131], a[16:19], v[0:3]
    s_waitcnt vmcnt(17)
    ds_read_b128 a[32:35], v176 offset:32768
    v_mfma_f32_16x16x32_bf16 v[8:11], v[128:131], a[20:23], v[8:11]
    ds_read_b64_tr_b16 v[156:157], v199 offset:12296
    ds_read_b64_tr_b16 v[158:159], v199 offset:13320
    v_mfma_f32_16x16x32_bf16 v[16:19], v[128:131], a[24:27], v[16:19]
    ds_read_b128 a[36:39], v176 offset:40960
    v_mfma_f32_16x16x32_bf16 v[24:27], v[128:131], a[28:31], v[24:27]
    s_waitcnt lgkmcnt(14)
    ds_read_b128 a[40:43], v176 offset:49152
    v_mfma_f32_16x16x32_bf16 v[4:7], v[132:135], a[16:19], v[4:7]
    ds_read_b128 a[44:47], v176 offset:57344
    v_mfma_f32_16x16x32_bf16 v[12:15], v[132:135], a[20:23], v[12:15]
    ds_read_b64_tr_b16 v[160:161], v200 offset:12288
    ds_read_b64_tr_b16 v[162:163], v200 offset:12800
    v_mfma_f32_16x16x32_bf16 v[20:23], v[132:135], a[24:27], v[20:23]
    ds_read_b128 a[48:51], v177 offset:32768
    v_mfma_f32_16x16x32_bf16 v[28:31], v[132:135], a[28:31], v[28:31]
    s_waitcnt lgkmcnt(15)
    ds_read_b128 a[52:55], v177 offset:40960
    v_mfma_f32_16x16x32_bf16 v[32:35], v[136:139], a[16:19], v[32:35]
    ds_read_b128 a[56:59], v177 offset:49152
    v_mfma_f32_16x16x32_bf16 v[40:43], v[136:139], a[20:23], v[40:43]
    ds_read_b64_tr_b16 v[164:165], v201 offset:12288
    ds_read_b64_tr_b16 v[166:167], v201 offset:12800
    v_mfma_f32_16x16x32_bf16 v[48:51], v[136:139], a[24:27], v[48:51]
    ds_read_b128 a[60:63], v177 offset:57344
    v_mfma_f32_16x16x32_bf16 v[56:59], v[136:139], a[28:31], v[56:59]
    v_and_b32 v243, 0xffff0000, v234
    v_add_f32 v236, v236, v242
    v_mfma_f32_16x16x32_bf16 v[36:39], v[140:143], a[16:19], v[36:39]
    v_add_f32 v237, v237, v243
    v_lshlrev_b32 v240, 16, v235
    v_mfma_f32_16x16x32_bf16 v[44:47], v[140:143], a[20:23], v[44:47]
    ds_read_b64_tr_b16 v[168:169], v202 offset:12288
    ds_read_b64_tr_b16 v[170:171], v202 offset:12800
    v_mfma_f32_16x16x32_bf16 v[52:55], v[140:143], a[24:27], v[52:55]
    v_and_b32 v241, 0xffff0000, v235
    v_add_f32 v236, v236, v240
    v_mfma_f32_16x16x32_bf16 v[60:63], v[140:143], a[28:31], v[60:63]
    s_waitcnt lgkmcnt(15)
    v_add_f32 v237, v237, v241
    v_add_f32 v236, v236, v237
    v_mfma_f32_16x16x32_bf16 v[64:67], v[144:147], a[16:19], v[64:67]
    s_nop 0
    v_add_f32_dpp v236, v236, v236 row_ror:1 row_mask:0xf bank_mask:0xf
    s_nop 1
    v_add_f32_dpp v236, v236, v236 row_ror:2 row_mask:0xf bank_mask:0xf
    v_mfma_f32_16x16x32_bf16 v[72:75], v[144:147], a[20:23], v[72:75]
    ds_read_b64_tr_b16 v[172:173], v203 offset:12288
    ds_read_b64_tr_b16 v[174:175], v203 offset:12800
    v_mfma_f32_16x16x32_bf16 v[80:83], v[144:147], a[24:27], v[80:83]
    v_mfma_f32_16x16x32_bf16 v[88:91], v[144:147], a[28:31], v[88:91]
    s_barrier
    v_mfma_f32_16x16x32_bf16 v[68:71], v[148:151], a[16:19], v[68:71]
    ds_read_b64_tr_b16 v[212:213], v209 offset:24576
    ds_read_b64_tr_b16 v[214:215], v209 offset:25600
    v_mfma_f32_16x16x32_bf16 v[76:79], v[148:151], a[20:23], v[76:79]
    ds_read_b64_tr_b16 v[128:129], v196 offset:24576
    ds_read_b64_tr_b16 v[130:131], v196 offset:25600
    v_mfma_f32_16x16x32_bf16 v[84:87], v[148:151], a[24:27], v[84:87]
    ds_read_b64_tr_b16 v[216:217], v209 offset:24584
    ds_read_b64_tr_b16 v[218:219], v209 offset:25608
    v_mfma_f32_16x16x32_bf16 v[92:95], v[148:151], a[28:31], v[92:95]
    ds_read_b64_tr_b16 v[220:221], v210 offset:24576
    ds_read_b64_tr_b16 v[222:223], v210 offset:25088
    v_mfma_f32_16x16x32_bf16 v[96:99], v[152:155], a[16:19], v[96:99]
    s_waitcnt lgkmcnt(12)
    s_add_u32 m0, s45, 0x8000
    s_mov_b32 s52, 0x180
    buffer_load_dwordx4 v207, s[76:79], s52 offen lds
    v_mfma_f32_16x16x32_bf16 v[104:107], v[152:155], a[20:23], v[104:107]
    ds_read_b64_tr_b16 v[132:133], v196 offset:24584
    ds_read_b64_tr_b16 v[134:135], v196 offset:25608
    v_mfma_f32_16x16x32_bf16 v[112:115], v[152:155], a[24:27], v[112:115]
    buffer_load_dwordx4 v208, s[76:79], s52 offen offset:1024 lds
    v_mfma_f32_16x16x32_bf16 v[120:123], v[152:155], a[28:31], v[120:123]
    s_add_u32 m0, s45, 0xa000
    s_mov_b32 s52, 0x4180
    buffer_load_dwordx4 v207, s[76:79], s52 offen lds
    v_mfma_f32_16x16x32_bf16 v[100:103], v[156:159], a[16:19], v[100:103]
    buffer_load_dwordx4 v208, s[76:79], s52 offen offset:1024 lds
    v_mfma_f32_16x16x32_bf16 v[108:111], v[156:159], a[20:23], v[108:111]
    ds_read_b64_tr_b16 v[136:137], v197 offset:24576
    ds_read_b64_tr_b16 v[138:139], v197 offset:25600
    v_mfma_f32_16x16x32_bf16 v[116:119], v[156:159], a[24:27], v[116:119]
    s_add_u32 m0, s45, 0xc000
    s_mov_b32 s52, 0x8180
    buffer_load_dwordx4 v207, s[76:79], s52 offen lds
    v_mfma_f32_16x16x32_bf16 v[124:127], v[156:159], a[28:31], v[124:127]
    buffer_load_dwordx4 v208, s[76:79], s52 offen offset:1024 lds
    v_mfma_f32_16x16x32_bf16 a[192:195], v[160:163], a[16:19], a[192:195]
    s_add_u32 m0, s45, 0xe000
    s_mov_b32 s52, 0xc180
    buffer_load_dwordx4 v207, s[76:79], s52 offen lds
    v_mfma_f32_16x16x32_bf16 a[196:199], v[160:163], a[20:23], a[196:199]
    ds_read_b64_tr_b16 v[140:141], v197 offset:24584
    ds_read_b64_tr_b16 v[142:143], v197 offset:25608
    v_mfma_f32_16x16x32_bf16 a[200:203], v[160:163], a[24:27], a[200:203]
    buffer_load_dwordx4 v208, s[76:79], s52 offen offset:1024 lds
    v_mfma_f32_16x16x32_bf16 a[204:207], v[160:163], a[28:31], a[204:207]
    s_add_u32 m0, s45, 0x16000
    s_mov_b32 s51, 0x180000
    buffer_load_dwordx4 v204, s[16:19], s51 offen lds
    v_mfma_f32_16x16x32_bf16 a[208:211], v[164:167], a[16:19], a[208:211]
    buffer_load_dwordx4 v205, s[16:19], s51 offen offset:1024 lds
    v_mfma_f32_16x16x32_bf16 a[212:215], v[164:167], a[20:23], a[212:215]
    ds_read_b64_tr_b16 v[144:145], v198 offset:24576
    ds_read_b64_tr_b16 v[146:147], v198 offset:25600
    v_mfma_f32_16x16x32_bf16 a[216:219], v[164:167], a[24:27], a[216:219]
    v_mfma_f32_16x16x32_bf16 a[220:223], v[164:167], a[28:31], a[220:223]
    s_waitcnt lgkmcnt(15)
    s_add_u32 m0, s46, 0x18000
    s_mov_b32 s51, 0xa8000
    buffer_load_dwordx4 v206, s[20:23], s51 offen lds
    s_waitcnt lgkmcnt(8)
    v_mfma_f32_16x16x32_bf16 a[128:131], v[212:215], a[140:143], a[128:131]
    v_add_f32_dpp v236, v236, v236 row_ror:4 row_mask:0xf bank_mask:0xf
    s_nop 1
    v_add_f32_dpp v236, v236, v236 row_ror:8 row_mask:0xf bank_mask:0xf
    v_mfma_f32_16x16x32_bf16 a[132:135], v[216:219], a[140:143], a[132:135]
    v_mov_b32 v237, v236
    s_nop 1
    v_permlane16_swap_b32 v236, v237
    v_mfma_f32_16x16x32_bf16 a[136:139], v[220:223], a[140:143], a[136:139]
    v_add_f32 v236, v236, v237
    v_mul_f32 v238, 0x3b000000, v236
    v_mfma_f32_16x16x32_bf16 a[224:227], v[168:171], a[16:19], a[224:227]
    v_cvt_pk_bf16_f32 v239, v238, v238
    v_and_b32 v239, 0xffff0000, v239
    v_mfma_f32_16x16x32_bf16 a[228:231], v[168:171], a[20:23], a[228:231]
    ds_read_b64_tr_b16 v[148:149], v198 offset:24584
    ds_read_b64_tr_b16 v[150:151], v198 offset:25608
    v_mfma_f32_16x16x32_bf16 a[232:235], v[168:171], a[24:27], a[232:235]
    v_lshlrev_b32 v240, 16, v228
    v_and_b32 v241, 0xffff0000, v228
    v_mfma_f32_16x16x32_bf16 a[236:239], v[168:171], a[28:31], a[236:239]
    v_sub_f32 v240, v240, v238
    v_sub_f32 v241, v241, v238
    v_mfma_f32_16x16x32_bf16 a[240:243], v[172:175], a[16:19], a[240:243]
    v_mul_f32 v236, v240, v240
    v_mul_f32 v237, v241, v241
    v_mfma_f32_16x16x32_bf16 a[244:247], v[172:175], a[20:23], a[244:247]
    ds_read_b64_tr_b16 v[152:153], v199 offset:24576
    ds_read_b64_tr_b16 v[154:155], v199 offset:25600
    v_mfma_f32_16x16x32_bf16 a[248:251], v[172:175], a[24:27], a[248:251]
    v_lshlrev_b32 v242, 16, v229
    v_and_b32 v243, 0xffff0000, v229
    v_mfma_f32_16x16x32_bf16 a[252:255], v[172:175], a[28:31], a[252:255]
    v_mfma_f32_16x16x32_bf16 v[0:3], v[128:131], a[32:35], v[0:3]
    v_sub_f32 v242, v242, v238
    v_sub_f32 v243, v243, v238
    v_mfma_f32_16x16x32_bf16 v[8:11], v[128:131], a[36:39], v[8:11]
    ds_read_b64_tr_b16 v[156:157], v199 offset:24584
    ds_read_b64_tr_b16 v[158:159], v199 offset:25608
    v_mfma_f32_16x16x32_bf16 v[16:19], v[128:131], a[40:43], v[16:19]
    v_fmac_f32 v236, v242, v242
    v_fmac_f32 v237, v243, v243
    v_mfma_f32_16x16x32_bf16 v[24:27], v[128:131], a[44:47], v[24:27]
    s_waitcnt lgkmcnt(12)
    v_lshlrev_b32 v240, 16, v230
    v_and_b32 v241, 0xffff0000, v230
    v_mfma_f32_16x16x32_bf16 v[4:7], v[132:135], a[32:35], v[4:7]
    v_sub_f32 v240, v240, v238
    v_sub_f32 v241, v241, v238
    v_mfma_f32_16x16x32_bf16 v[12:15], v[132:135], a[36:39], v[12:15]
    ds_read_b64_tr_b16 v[160:161], v200 offset:24576
    ds_read_b64_tr_b16 v[162:163], v200 offset:25088
    v_mfma_f32_16x16x32_bf16 v[20:23], v[132:135], a[40:43], v[20:23]
    v_fmac_f32 v236, v240, v240
    v_fmac_f32 v237, v241, v241
    v_mfma_f32_16x16x32_bf16 v[28:31], v[132:135], a[44:47], v[28:31]
    s_waitcnt lgkmcnt(12)
    v_lshlrev_b32 v242, 16, v231
    v_and_b32 v243, 0xffff0000, v231
    v_mfma_f32_16x16x32_bf16 v[32:35], v[136:139], a[32:35], v[32:35]
    v_sub_f32 v242, v242, v238
    v_sub_f32 v243, v243, v238
    v_mfma_f32_16x16x32_bf16 v[40:43], v[136:139], a[36:39], v[40:43]
    ds_read_b64_tr_b16 v[164:165], v201 offset:24576
    ds_read_b64_tr_b16 v[166:167], v201 offset:25088
    v_mfma_f32_16x16x32_bf16 v[48:51], v[136:139], a[40:43], v[48:51]
    v_fmac_f32 v236, v242, v242
    v_fmac_f32 v237, v243, v243
    v_mfma_f32_16x16x32_bf16 v[56:59], v[136:139], a[44:47], v[56:59]
    s_waitcnt lgkmcnt(12)
    v_lshlrev_b32 v240, 16, v232
    v_and_b32 v241, 0xffff0000, v232
    v_mfma_f32_16x16x32_bf16 v[36:39], v[140:143], a[32:35], v[36:39]
    v_sub_f32 v240, v240, v238
    v_sub_f32 v241, v241, v238
    v_mfma_f32_16x16x32_bf16 v[44:47], v[140:143], a[36:39], v[44:47]
    ds_read_b64_tr_b16 v[168:169], v202 offset:24576
    ds_read_b64_tr_b16 v[170:171], v202 offset:25088
    v_mfma_f32_16x16x32_bf16 v[52:55], v[140:143], a[40:43], v[52:55]
    v_fmac_f32 v236, v240, v240
    v_fmac_f32 v237, v241, v241
    v_mfma_f32_16x16x32_bf16 v[60:63], v[140:143], a[44:47], v[60:63]
    s_waitcnt lgkmcnt(12)
    v_lshlrev_b32 v242, 16, v233
    v_and_b32 v243, 0xffff0000, v233
    v_mfma_f32_16x16x32_bf16 v[64:67], v[144:147], a[32:35], v[64:67]
    v_sub_f32 v242, v242, v238
    v_sub_f32 v243, v243, v238
    v_mfma_f32_16x16x32_bf16 v[72:75], v[144:147], a[36:39], v[72:75]
    ds_read_b64_tr_b16 v[172:173], v203 offset:24576
    ds_read_b64_tr_b16 v[174:175], v203 offset:25088
    v_mfma_f32_16x16x32_bf16 v[80:83], v[144:147], a[40:43], v[80:83]
    v_mfma_f32_16x16x32_bf16 v[88:91], v[144:147], a[44:47], v[88:91]
    s_waitcnt lgkmcnt(12)
    s_waitcnt vmcnt(25)
    s_barrier
    v_mfma_f32_16x16x32_bf16 v[68:71], v[148:151], a[32:35], v[68:71]
    ds_read_b64_tr_b16 v[212:213], v209 offset:36864
    ds_read_b64_tr_b16 v[214:215], v209 offset:37888
    v_mfma_f32_16x16x32_bf16 v[76:79], v[148:151], a[36:39], v[76:79]
    ds_read_b64_tr_b16 v[128:129], v196 offset:36864
    ds_read_b64_tr_b16 v[130:131], v196 offset:37888
    v_mfma_f32_16x16x32_bf16 v[84:87], v[148:151], a[40:43], v[84:87]
    ds_read_b64_tr_b16 v[216:217], v209 offset:36872
    ds_read_b64_tr_b16 v[218:219], v209 offset:37896
    v_mfma_f32_16x16x32_bf16 v[92:95], v[148:151], a[44:47], v[92:95]
    s_waitcnt lgkmcnt(15)
    ds_read_b64_tr_b16 v[220:221], v210 offset:36864
    ds_read_b64_tr_b16 v[222:223], v210 offset:37376
    v_mfma_f32_16x16x32_bf16 v[96:99], v[152:155], a[32:35], v[96:99]
    s_add_u32 m0, s45, 0x19000
    s_mov_b32 s51, 0x1c0000
    buffer_load_dwordx4 v204, s[16:19], s51 offen lds
    v_mfma_f32_16x16x32_bf16 v[104:107], v[152:155], a[36:39], v[104:107]
    ds_read_b64_tr_b16 v[132:133], v196 offset:36872
    ds_read_b64_tr_b16 v[134:135], v196 offset:37896
    v_mfma_f32_16x16x32_bf16 v[112:115], v[152:155], a[40:43], v[112:115]
    buffer_load_dwordx4 v205, s[16:19], s51 offen offset:1024 lds
    v_mfma_f32_16x16x32_bf16 v[120:123], v[152:155], a[44:47], v[120:123]
    s_waitcnt lgkmcnt(15)
    s_add_u32 m0, s46, 0x1b000
    s_mov_b32 s51, 0xc4000
    buffer_load_dwordx4 v206, s[20:23], s51 offen lds
    v_mfma_f32_16x16x32_bf16 v[100:103], v[156:159], a[32:35], v[100:103]
    v_fmac_f32 v236, v242, v242
    v_fmac_f32 v237, v243, v243
    v_mfma_f32_16x16x32_bf16 v[108:111], v[156:159], a[36:39], v[108:111]
    ds_read_b64_tr_b16 v[136:137], v197 offset:36864
    ds_read_b64_tr_b16 v[138:139], v197 offset:37888
    v_mfma_f32_16x16x32_bf16 v[116:119], v[156:159], a[40:43], v[116:119]
    v_lshlrev_b32 v240, 16, v234
    v_and_b32 v241, 0xffff0000, v234
    v_mfma_f32_16x16x32_bf16 v[124:127], v[156:159], a[44:47], v[124:127]
    v_sub_f32 v240, v240, v238
    v_sub_f32 v241, v241, v238
    v_mfma_f32_16x16x32_bf16 a[192:195], v[160:163], a[32:35], a[192:195]
    v_fmac_f32 v236, v240, v240
    v_fmac_f32 v237, v241, v241
    v_mfma_f32_16x16x32_bf16 a[196:199], v[160:163], a[36:39], a[196:199]
    ds_read_b64_tr_b16 v[140:141], v197 offset:36872
    ds_read_b64_tr_b16 v[142:143], v197 offset:37896
    v_mfma_f32_16x16x32_bf16 a[200:203], v[160:163], a[40:43], a[200:203]
    v_lshlrev_b32 v242, 16, v235
    v_and_b32 v243, 0xffff0000, v235
    v_mfma_f32_16x16x32_bf16 a[204:207], v[160:163], a[44:47], a[204:207]
    s_waitcnt lgkmcnt(15)
    v_sub_f32 v242, v242, v238
    v_sub_f32 v243, v243, v238
    v_mfma_f32_16x16x32_bf16 a[208:211], v[164:167], a[32:35], a[208:211]
    v_fmac_f32 v236, v242, v242
    v_fmac_f32 v237, v243, v243
    v_mfma_f32_16x16x32_bf16 a[212:215], v[164:167], a[36:39], a[212:215]
    ds_read_b64_tr_b16 v[144:145], v198 offset:36864
    ds_read_b64_tr_b16 v[146:147], v198 offset:37888
    v_mfma_f32_16x16x32_bf16 a[216:219], v[164:167], a[40:43], a[216:219]
    v_mfma_f32_16x16x32_bf16 a[220:223], v[164:167], a[44:47], a[220:223]
    v_add_f32 v236, v236, v237
    s_nop 1
    v_add_f32_dpp v236, v236, v236 row_ror:1 row_mask:0xf bank_mask:0xf
    s_waitcnt lgkmcnt(8)
    v_mfma_f32_16x16x32_bf16 a[128:131], v[212:215], a[140:143], a[128:131]
    v_add_f32_dpp v236, v236, v236 row_ror:2 row_mask:0xf bank_mask:0xf
    s_nop 1
    v_add_f32_dpp v236, v236, v236 row_ror:4 row_mask:0xf bank_mask:0xf
    v_mfma_f32_16x16x32_bf16 a[132:135], v[216:219], a[140:143], a[132:135]
    s_nop 0
    v_add_f32_dpp v236, v236, v236 row_ror:8 row_mask:0xf bank_mask:0xf
    v_mov_b32 v237, v236
    v_mfma_f32_16x16x32_bf16 a[136:139], v[220:223], a[140:143], a[136:139]
    s_nop 0
    v_permlane16_swap_b32 v236, v237
    v_add_f32 v236, v236, v237
    v_mfma_f32_16x16x32_bf16 a[224:227], v[168:171], a[32:35], a[224:227]
    v_mul_f32 v236, 0x3b000000, v236
    v_cvt_pk_bf16_f32 v236, v236, v236
    v_mfma_f32_16x16x32_bf16 a[228:231], v[168:171], a[36:39], a[228:231]
    ds_read_b64_tr_b16 v[148:149], v198 offset:36872
    ds_read_b64_tr_b16 v[150:151], v198 offset:37896
    v_mfma_f32_16x16x32_bf16 a[232:235], v[168:171], a[40:43], a[232:235]
    v_and_b32 v236, 0xffff0000, v236
    v_add_f32 v236, 0x3727c5ac, v236
    v_mfma_f32_16x16x32_bf16 a[236:239], v[168:171], a[44:47], a[236:239]
    v_cvt_pk_bf16_f32 v236, v236, v236
    v_and_b32 v236, 0xffff0000, v236
    v_mfma_f32_16x16x32_bf16 a[240:243], v[172:175], a[32:35], a[240:243]
    v_sqrt_f32 v236, v236
    v_mfma_f32_16x16x32_bf16 a[244:247], v[172:175], a[36:39], a[244:247]
    ds_read_b64_tr_b16 v[152:153], v199 offset:36864
    ds_read_b64_tr_b16 v[154:155], v199 offset:37888
    v_mfma_f32_16x16x32_bf16 a[248:251], v[172:175], a[40:43], a[248:251]
    v_lshrrev_b32 v240, 9, v211
    v_and_b32 v241, 0x1f0, v211
    v_mfma_f32_16x16x32_bf16 a[252:255], v[172:175], a[44:47], a[252:255]
    v_mfma_f32_16x16x32_bf16 v[0:3], v[128:131], a[48:51], v[0:3]
    s_waitcnt vmcnt(14)
    ds_read_b128 a[64:67], v176 offset:0
    v_mfma_f32_16x16x32_bf16 v[8:11], v[128:131], a[52:55], v[8:11]
    ds_read_b64_tr_b16 v[156:157], v199 offset:36872
    ds_read_b64_tr_b16 v[158:159], v199 offset:37896
    v_mfma_f32_16x16x32_bf16 v[16:19], v[128:131], a[56:59], v[16:19]
    ds_read_b128 a[68:71], v176 offset:8192
    v_mfma_f32_16x16x32_bf16 v[24:27], v[128:131], a[60:63], v[24:27]
    s_waitcnt lgkmcnt(14)
    ds_read_b128 a[72:75], v176 offset:16384
    v_mfma_f32_16x16x32_bf16 v[4:7], v[132:135], a[48:51], v[4:7]
    ds_read_b128 a[76:79], v176 offset:24576
    v_mfma_f32_16x16x32_bf16 v[12:15], v[132:135], a[52:55], v[12:15]
    ds_read_b64_tr_b16 v[160:161], v200 offset:36864
    ds_read_b64_tr_b16 v[162:163], v200 offset:37376
    v_mfma_f32_16x16x32_bf16 v[20:23], v[132:135], a[56:59], v[20:23]
    ds_read_b128 a[80:83], v177 offset:0
    v_mfma_f32_16x16x32_bf16 v[28:31], v[132:135], a[60:63], v[28:31]
    s_waitcnt lgkmcnt(15)
    ds_read_b128 a[84:87], v177 offset:8192
    v_mfma_f32_16x16x32_bf16 v[32:35], v[136:139], a[48:51], v[32:35]
    ds_read_b128 a[88:91], v177 offset:16384
    v_mfma_f32_16x16x32_bf16 v[40:43], v[136:139], a[52:55], v[40:43]
    ds_read_b64_tr_b16 v[164:165], v201 offset:36864
    ds_read_b64_tr_b16 v[166:167], v201 offset:37376
    v_mfma_f32_16x16x32_bf16 v[48:51], v[136:139], a[56:59], v[48:51]
    ds_read_b128 a[92:95], v177 offset:24576
    v_mfma_f32_16x16x32_bf16 v[56:59], v[136:139], a[60:63], v[56:59]
    v_cvt_pk_bf16_f32 v236, v236, v236
    v_lshlrev_b32 v240, 3, v240
    v_mfma_f32_16x16x32_bf16 v[36:39], v[140:143], a[48:51], v[36:39]
    v_and_b32 v236, 0xffff0000, v236
    v_lshl_add_u32 v240, v241, 22, v240
    v_mfma_f32_16x16x32_bf16 v[44:47], v[140:143], a[52:55], v[44:47]
    ds_read_b64_tr_b16 v[168:169], v202 offset:36864
    ds_read_b64_tr_b16 v[170:171], v202 offset:37376
    v_mfma_f32_16x16x32_bf16 v[52:55], v[140:143], a[56:59], v[52:55]
    v_lshrrev_b32 v242, 16, v239
    v_mfma_f32_16x16x32_bf16 v[60:63], v[140:143], a[60:63], v[60:63]
    s_waitcnt lgkmcnt(15)
    v_xor_b32 v227, 0x9e3779b1, v227
    s_nop 0
    v_readfirstlane_b32 s72, v227
    v_mfma_f32_16x16x32_bf16 v[64:67], v[144:147], a[48:51], v[64:67]
    v_or_b32 v242, v242, v236
    v_mov_b32 v243, v227
    v_mfma_f32_16x16x32_bf16 v[72:75], v[144:147], a[52:55], v[72:75]
    ds_read_b64_tr_b16 v[172:173], v203 offset:36864
    ds_read_b64_tr_b16 v[174:175], v203 offset:37376
    v_mfma_f32_16x16x32_bf16 v[80:83], v[144:147], a[56:59], v[80:83]
    v_mfma_f32_16x16x32_bf16 v[88:91], v[144:147], a[60:63], v[88:91]
    s_barrier
    v_mfma_f32_16x16x32_bf16 v[68:71], v[148:151], a[48:51], v[68:71]
    ds_read_b64_tr_b16 v[212:213], v209 offset:49152
    ds_read_b64_tr_b16 v[214:215], v209 offset:50176
    v_mfma_f32_16x16x32_bf16 v[76:79], v[148:151], a[52:55], v[76:79]
    ds_read_b64_tr_b16 v[128:129], v196 offset:49152
    ds_read_b64_tr_b16 v[130:131], v196 offset:50176
    v_mfma_f32_16x16x32_bf16 v[84:87], v[148:151], a[56:59], v[84:87]
    ds_read_b64_tr_b16 v[216:217], v209 offset:49160
    ds_read_b64_tr_b16 v[218:219], v209 offset:50184
    v_mfma_f32_16x16x32_bf16 v[92:95], v[148:151], a[60:63], v[92:95]
    ds_read_b64_tr_b16 v[220:221], v210 offset:49152
    ds_read_b64_tr_b16 v[222:223], v210 offset:49664
    v_mfma_f32_16x16x32_bf16 v[96:99], v[152:155], a[48:51], v[96:99]
    s_waitcnt lgkmcnt(12)
    s_add_u32 m0, s45, 0x0
    s_mov_b32 s52, 0x200
    buffer_load_dwordx4 v207, s[76:79], s52 offen lds
    v_mfma_f32_16x16x32_bf16 v[104:107], v[152:155], a[52:55], v[104:107]
    ds_read_b64_tr_b16 v[132:133], v196 offset:49160
    ds_read_b64_tr_b16 v[134:135], v196 offset:50184
    v_mfma_f32_16x16x32_bf16 v[112:115], v[152:155], a[56:59], v[112:115]
    buffer_load_dwordx4 v208, s[76:79], s52 offen offset:1024 lds
    v_mfma_f32_16x16x32_bf16 v[120:123], v[152:155], a[60:63], v[120:123]
    v_mfma_f32_16x16x32_bf16 v[100:103], v[156:159], a[48:51], v[100:103]
    s_add_u32 m0, s45, 0x2000
    s_mov_b32 s52, 0x4200
    buffer_load_dwordx4 v207, s[76:79], s52 offen lds
    v_mfma_f32_16x16x32_bf16 v[108:111], v[156:159], a[52:55], v[108:111]
    ds_read_b64_tr_b16 v[136:137], v197 offset:49152
    ds_read_b64_tr_b16 v[138:139], v197 offset:50176
    v_mfma_f32_16x16x32_bf16 v[116:119], v[156:159], a[56:59], v[116:119]
    v_mfma_f32_16x16x32_bf16 v[124:127], v[156:159], a[60:63], v[124:127]
    buffer_load_dwordx4 v208, s[76:79], s52 offen offset:1024 lds
    v_mfma_f32_16x16x32_bf16 a[192:195], v[160:163], a[48:51], a[192:195]
    v_mfma_f32_16x16x32_bf16 a[196:199], v[160:163], a[52:55], a[196:199]
    ds_read_b64_tr_b16 v[140:141], v197 offset:49160
    ds_read_b64_tr_b16 v[142:143], v197 offset:50184
    v_mfma_f32_16x16x32_bf16 a[200:203], v[160:163], a[56:59], a[200:203]
    s_add_u32 m0, s45, 0x4000
    s_mov_b32 s52, 0x8200
    buffer_load_dwordx4 v207, s[76:79], s52 offen lds
    v_mfma_f32_16x16x32_bf16 a[204:207], v[160:163], a[60:63], a[204:207]
    buffer_load_dwordx4 v208, s[76:79], s52 offen offset:1024 lds
    v_mfma_f32_16x16x32_bf16 a[208:211], v[164:167], a[48:51], a[208:211]
    v_mfma_f32_16x16x32_bf16 a[212:215], v[164:167], a[52:55], a[212:215]
    ds_read_b64_tr_b16 v[144:145], v198 offset:49152
    ds_read_b64_tr_b16 v[146:147], v198 offset:50176
    v_mfma_f32_16x16x32_bf16 a[216:219], v[164:167], a[56:59], a[216:219]
    s_add_u32 m0, s45, 0x6000
    s_mov_b32 s52, 0xc200
    buffer_load_dwordx4 v207, s[76:79], s52 offen lds
    v_mfma_f32_16x16x32_bf16 a[220:223], v[164:167], a[60:63], a[220:223]
    s_waitcnt lgkmcnt(15)
    s_waitcnt lgkmcnt(8)
    v_mfma_f32_16x16x32_bf16 a[128:131], v[212:215], a[140:143], a[128:131]
    buffer_load_dwordx4 v208, s[76:79], s52 offen offset:1024 lds
    v_mfma_f32_16x16x32_bf16 a[132:135], v[216:219], a[140:143], a[132:135]
    v_mfma_f32_16x16x32_bf16 a[136:139], v[220:223], a[140:143], a[136:139]
    s_add_u32 m0, s45, 0x1c000
    s_mov_b32 s51, 0x200000
    buffer_load_dwordx4 v204, s[16:19], s51 offen lds
    v_mfma_f32_16x16x32_bf16 a[224:227], v[168:171], a[48:51], a[224:227]
    buffer_load_dwordx4 v205, s[16:19], s51 offen offset:1024 lds
    v_mfma_f32_16x16x32_bf16 a[228:231], v[168:171], a[52:55], a[228:231]
    ds_read_b64_tr_b16 v[148:149], v198 offset:49160
    ds_read_b64_tr_b16 v[150:151], v198 offset:50184
    v_mfma_f32_16x16x32_bf16 a[232:235], v[168:171], a[56:59], a[232:235]
    v_mfma_f32_16x16x32_bf16 a[236:239], v[168:171], a[60:63], a[236:239]
    s_add_u32 m0, s46, 0x1e000
    s_mov_b32 s51, 0xe0000
    buffer_load_dwordx4 v206, s[20:23], s51 offen lds
    v_mfma_f32_16x16x32_bf16 a[240:243], v[172:175], a[48:51], a[240:243]
    v_mfma_f32_16x16x32_bf16 a[244:247], v[172:175], a[52:55], a[244:247]
    ds_read_b64_tr_b16 v[152:153], v199 offset:49152
    ds_read_b64_tr_b16 v[154:155], v199 offset:50176
    v_mfma_f32_16x16x32_bf16 a[248:251], v[172:175], a[56:59], a[248:251]
    s_lshl_b32 s3, s2, 3
    s_lshl_b32 s53, s44, 1
    s_add_u32 s3, s3, s53
    s_lshl_b32 s3, s3, 3
    buffer_store_dwordx2 v[242:243], v240, s[24:27], s3 offen sc1
    v_mfma_f32_16x16x32_bf16 a[252:255], v[172:175], a[60:63], a[252:255]
    v_mfma_f32_16x16x32_bf16 v[0:3], v[128:131], a[64:67], v[0:3]
    v_mfma_f32_16x16x32_bf16 v[8:11], v[128:131], a[68:71], v[8:11]
    ds_read_b64_tr_b16 v[156:157], v199 offset:49160
    ds_read_b64_tr_b16 v[158:159], v199 offset:50184
    v_mfma_f32_16x16x32_bf16 v[16:19], v[128:131], a[72:75], v[16:19]
    v_mfma_f32_16x16x32_bf16 v[24:27], v[128:131], a[76:79], v[24:27]
    s_waitcnt lgkmcnt(12)
    v_mfma_f32_16x16x32_bf16 v[4:7], v[132:135], a[64:67], v[4:7]
    v_mfma_f32_16x16x32_bf16 v[12:15], v[132:135], a[68:71], v[12:15]
    ds_read_b64_tr_b16 v[160:161], v200 offset:49152
    ds_read_b64_tr_b16 v[162:163], v200 offset:49664
    v_mfma_f32_16x16x32_bf16 v[20:23], v[132:135], a[72:75], v[20:23]
    v_mfma_f32_16x16x32_bf16 v[28:31], v[132:135], a[76:79], v[28:31]
    s_waitcnt lgkmcnt(12)
    v_mfma_f32_16x16x32_bf16 v[32:35], v[136:139], a[64:67], v[32:35]
    v_mfma_f32_16x16x32_bf16 v[40:43], v[136:139], a[68:71], v[40:43]
    ds_read_b64_tr_b16 v[164:165], v201 offset:49152
    ds_read_b64_tr_b16 v[166:167], v201 offset:49664
    v_mfma_f32_16x16x32_bf16 v[48:51], v[136:139], a[72:75], v[48:51]
    v_mfma_f32_16x16x32_bf16 v[56:59], v[136:139], a[76:79], v[56:59]
    s_waitcnt lgkmcnt(12)
    v_mfma_f32_16x16x32_bf16 v[36:39], v[140:143], a[64:67], v[36:39]
    v_mfma_f32_16x16x32_bf16 v[44:47], v[140:143], a[68:71], v[44:47]
    ds_read_b64_tr_b16 v[168:169], v202 offset:49152
    ds_read_b64_tr_b16 v[170:171], v202 offset:49664
    v_mfma_f32_16x16x32_bf16 v[52:55], v[140:143], a[72:75], v[52:55]
    v_mfma_f32_16x16x32_bf16 v[60:63], v[140:143], a[76:79], v[60:63]
    s_waitcnt lgkmcnt(12)
    v_mfma_f32_16x16x32_bf16 v[64:67], v[144:147], a[64:67], v[64:67]
    v_mfma_f32_16x16x32_bf16 v[72:75], v[144:147], a[68:71], v[72:75]
    ds_read_b64_tr_b16 v[172:173], v203 offset:49152
    ds_read_b64_tr_b16 v[174:175], v203 offset:49664
    v_mfma_f32_16x16x32_bf16 v[80:83], v[144:147], a[72:75], v[80:83]
    v_mfma_f32_16x16x32_bf16 v[88:91], v[144:147], a[76:79], v[88:91]
    s_waitcnt lgkmcnt(12)
    s_barrier
    v_mfma_f32_16x16x32_bf16 v[68:71], v[148:151], a[64:67], v[68:71]
    ds_read_b64_tr_b16 v[212:213], v209 offset:61440
    ds_read_b64_tr_b16 v[214:215], v209 offset:62464
    v_mfma_f32_16x16x32_bf16 v[76:79], v[148:151], a[68:71], v[76:79]
    ds_read_b64_tr_b16 v[128:129], v196 offset:61440
    ds_read_b64_tr_b16 v[130:131], v196 offset:62464
    v_mfma_f32_16x16x32_bf16 v[84:87], v[148:151], a[72:75], v[84:87]
    ds_read_b64_tr_b16 v[216:217], v209 offset:61448
    ds_read_b64_tr_b16 v[218:219], v209 offset:62472
    v_mfma_f32_16x16x32_bf16 v[92:95], v[148:151], a[76:79], v[92:95]
    s_waitcnt lgkmcnt(15)
    ds_read_b64_tr_b16 v[220:221], v210 offset:61440
    ds_read_b64_tr_b16 v[222:223], v210 offset:61952
    v_mfma_f32_16x16x32_bf16 v[96:99], v[152:155], a[64:67], v[96:99]
    s_add_u32 m0, s45, 0x1f000
    s_mov_b32 s51, 0x240000
    buffer_load_dwordx4 v204, s[16:19], s51 offen lds
    v_mfma_f32_16x16x32_bf16 v[104:107], v[152:155], a[68:71], v[104:107]
    ds_read_b64_tr_b16 v[132:133], v196 offset:61448
    ds_read_b64_tr_b16 v[134:135], v196 offset:62472
    v_mfma_f32_16x16x32_bf16 v[112:115], v[152:155], a[72:75], v[112:115]
    v_mfma_f32_16x16x32_bf16 v[120:123], v[152:155], a[76:79], v[120:123]
    s_waitcnt lgkmcnt(15)
    v_mfma_f32_16x16x32_bf16 v[100:103], v[156:159], a[64:67], v[100:103]
    v_mfma_f32_16x16x32_bf16 v[108:111], v[156:159], a[68:71], v[108:111]
    ds_read_b64_tr_b16 v[136:137], v197 offset:61440
    ds_read_b64_tr_b16 v[138:139], v197 offset:62464
    v_mfma_f32_16x16x32_bf16 v[116:119], v[156:159], a[72:75], v[116:119]
    v_mfma_f32_16x16x32_bf16 v[124:127], v[156:159], a[76:79], v[124:127]
    v_mfma_f32_16x16x32_bf16 a[192:195], v[160:163], a[64:67], a[192:195]
L_it2:
    s_cbranch_execz L_it6
    v_mfma_f32_16x16x32_bf16 a[196:199], v[160:163], a[68:71], a[196:199]
    ds_read_b64_tr_b16 v[140:141], v197 offset:61448
    ds_read_b64_tr_b16 v[142:143], v197 offset:62472
    v_mfma_f32_16x16x32_bf16 a[200:203], v[160:163], a[72:75], a[200:203]
    buffer_load_dwordx4 v205, s[16:19], s51 offen offset:1024 lds
    v_mfma_f32_16x16x32_bf16 a[204:207], v[160:163], a[76:79], a[204:207]
    s_waitcnt lgkmcnt(15)
    v_mfma_f32_16x16x32_bf16 a[208:211], v[164:167], a[64:67], a[208:211]
    v_mfma_f32_16x16x32_bf16 a[212:215], v[164:167], a[68:71], a[212:215]
    ds_read_b64_tr_b16 v[144:145], v198 offset:61440
    ds_read_b64_tr_b16 v[146:147], v198 offset:62464
    v_mfma_f32_16x16x32_bf16 a[216:219], v[164:167], a[72:75], a[216:219]
    v_mfma_f32_16x16x32_bf16 a[220:223], v[164:167], a[76:79], a[220:223]
    s_waitcnt lgkmcnt(8)
    v_mfma_f32_16x16x32_bf16 a[128:131], v[212:215], a[140:143], a[128:131]
    v_mfma_f32_16x16x32_bf16 a[132:135], v[216:219], a[140:143], a[132:135]
    v_mfma_f32_16x16x32_bf16 a[136:139], v[220:223], a[140:143], a[136:139]
    s_add_u32 m0, s46, 0x21000
    s_mov_b32 s51, 0xfc000
    buffer_load_dwordx4 v206, s[20:23], s51 offen lds
    v_mfma_f32_16x16x32_bf16 a[224:227], v[168:171], a[64:67], a[224:227]
    v_mfma_f32_16x16x32_bf16 a[228:231], v[168:171], a[68:71], a[228:231]
    ds_read_b64_tr_b16 v[148:149], v198 offset:61448
    ds_read_b64_tr_b16 v[150:151], v198 offset:62472
    v_mfma_f32_16x16x32_bf16 a[232:235], v[168:171], a[72:75], a[232:235]
    v_mfma_f32_16x16x32_bf16 a[236:239], v[168:171], a[76:79], a[236:239]
    v_mfma_f32_16x16x32_bf16 a[240:243], v[172:175], a[64:67], a[240:243]
    v_mfma_f32_16x16x32_bf16 a[244:247], v[172:175], a[68:71], a[244:247]
    ds_read_b64_tr_b16 v[152:153], v199 offset:61440
    ds_read_b64_tr_b16 v[154:155], v199 offset:62464
    v_mfma_f32_16x16x32_bf16 a[248:251], v[172:175], a[72:75], a[248:251]
    v_mfma_f32_16x16x32_bf16 a[252:255], v[172:175], a[76:79], a[252:255]
    v_mfma_f32_16x16x32_bf16 v[0:3], v[128:131], a[80:83], v[0:3]
    s_waitcnt vmcnt(21)
    ds_read_b128 a[96:99], v176 offset:32768
    v_mfma_f32_16x16x32_bf16 v[8:11], v[128:131], a[84:87], v[8:11]
    ds_read_b64_tr_b16 v[156:157], v199 offset:61448
    ds_read_b64_tr_b16 v[158:159], v199 offset:62472
    v_mfma_f32_16x16x32_bf16 v[16:19], v[128:131], a[88:91], v[16:19]
    ds_read_b128 a[100:103], v176 offset:40960
    v_mfma_f32_16x16x32_bf16 v[24:27], v[128:131], a[92:95], v[24:27]
    s_waitcnt lgkmcnt(14)
    ds_read_b128 a[104:107], v176 offset:49152
    v_mfma_f32_16x16x32_bf16 v[4:7], v[132:135], a[80:83], v[4:7]
    ds_read_b128 a[108:111], v176 offset:57344
    v_mfma_f32_16x16x32_bf16 v[12:15], v[132:135], a[84:87], v[12:15]
    ds_read_b64_tr_b16 v[160:161], v200 offset:61440
    ds_read_b64_tr_b16 v[162:163], v200 offset:61952
    v_mfma_f32_16x16x32_bf16 v[20:23], v[132:135], a[88:91], v[20:23]
    ds_read_b128 a[112:115], v177 offset:32768
    v_mfma_f32_16x16x32_bf16 v[28:31], v[132:135], a[92:95], v[28:31]
    s_waitcnt lgkmcnt(15)
    ds_read_b128 a[116:119], v177 offset:40960
    v_mfma_f32_16x16x32_bf16 v[32:35], v[136:139], a[80:83], v[32:35]
    ds_read_b128 a[120:123], v177 offset:49152
    v_mfma_f32_16x16x32_bf16 v[40:43], v[136:139], a[84:87], v[40:43]
    ds_read_b64_tr_b16 v[164:165], v201 offset:61440
    ds_read_b64_tr_b16 v[166:167], v201 offset:61952
    v_mfma_f32_16x16x32_bf16 v[48:51], v[136:139], a[88:91], v[48:51]
    ds_read_b128 a[124:127], v177 offset:57344
    v_mfma_f32_16x16x32_bf16 v[56:59], v[136:139], a[92:95], v[56:59]
    v_mfma_f32_16x16x32_bf16 v[36:39], v[140:143], a[80:83], v[36:39]
    v_mfma_f32_16x16x32_bf16 v[44:47], v[140:143], a[84:87], v[44:47]
    ds_read_b64_tr_b16 v[168:169], v202 offset:61440
    ds_read_b64_tr_b16 v[170:171], v202 offset:61952
    v_mfma_f32_16x16x32_bf16 v[52:55], v[140:143], a[88:91], v[52:55]
    v_mfma_f32_16x16x32_bf16 v[60:63], v[140:143], a[92:95], v[60:63]
    s_waitcnt lgkmcnt(15)
    v_mfma_f32_16x16x32_bf16 v[64:67], v[144:147], a[80:83], v[64:67]
    v_mfma_f32_16x16x32_bf16 v[72:75], v[144:147], a[84:87], v[72:75]
    ds_read_b64_tr_b16 v[172:173], v203 offset:61440
    ds_read_b64_tr_b16 v[174:175], v203 offset:61952
    v_mfma_f32_16x16x32_bf16 v[80:83], v[144:147], a[88:91], v[80:83]
    v_mfma_f32_16x16x32_bf16 v[88:91], v[144:147], a[92:95], v[88:91]
    s_waitcnt vmcnt(18)
    s_barrier
    v_mfma_f32_16x16x32_bf16 v[68:71], v[148:151], a[80:83], v[68:71]
    ds_read_b64_tr_b16 v[212:213], v209 offset:0
    ds_read_b64_tr_b16 v[214:215], v209 offset:1024
    v_mfma_f32_16x16x32_bf16 v[76:79], v[148:151], a[84:87], v[76:79]
    ds_read_b64_tr_b16 v[128:129], v196 offset:0
    ds_read_b64_tr_b16 v[130:131], v196 offset:1024
    v_mfma_f32_16x16x32_bf16 v[84:87], v[148:151], a[88:91], v[84:87]
    ds_read_b64_tr_b16 v[216:217], v209 offset:8
    ds_read_b64_tr_b16 v[218:219], v209 offset:1032
    v_mfma_f32_16x16x32_bf16 v[92:95], v[148:151], a[92:95], v[92:95]
    ds_read_b64_tr_b16 v[220:221], v210 offset:0
    ds_read_b64_tr_b16 v[222:223], v210 offset:512
    v_mfma_f32_16x16x32_bf16 v[96:99], v[152:155], a[80:83], v[96:99]
    s_waitcnt lgkmcnt(12)
    s_add_u32 m0, s45, 0x8000
    s_mov_b32 s52, 0x280
    buffer_load_dwordx4 v207, s[76:79], s52 offen lds
    v_mfma_f32_16x16x32_bf16 v[104:107], v[152:155], a[84:87], v[104:107]
    ds_read_b64_tr_b16 v[132:133], v196 offset:8
    ds_read_b64_tr_b16 v[134:135], v196 offset:1032
    v_mfma_f32_16x16x32_bf16 v[112:115], v[152:155], a[88:91], v[112:115]
    buffer_load_dwordx4 v208, s[76:79], s52 offen offset:1024 lds
    v_mfma_f32_16x16x32_bf16 v[120:123], v[152:155], a[92:95], v[120:123]
    v_mfma_f32_16x16x32_bf16 v[100:103], v[156:159], a[80:83], v[100:103]
    s_add_u32 m0, s45, 0xa000
    s_mov_b32 s52, 0x4280
    buffer_load_dwordx4 v207, s[76:79], s52 offen lds
    v_mfma_f32_16x16x32_bf16 v[108:111], v[156:159], a[84:87], v[108:111]
    ds_read_b64_tr_b16 v[136:137], v197 offset:0
    ds_read_b64_tr_b16 v[138:139], v197 offset:1024
    v_mfma_f32_16x16x32_bf16 v[116:119], v[156:159], a[88:91], v[116:119]
    v_mfma_f32_16x16x32_bf16 v[124:127], v[156:159], a[92:95], v[124:127]
    buffer_load_dwordx4 v208, s[76:79], s52 offen offset:1024 lds
    v_mfma_f32_16x16x32_bf16 a[192:195], v[160:163], a[80:83], a[192:195]
    v_mfma_f32_16x16x32_bf16 a[196:199], v[160:163], a[84:87], a[196:199]
    ds_read_b64_tr_b16 v[140:141], v197 offset:8
    ds_read_b64_tr_b16 v[142:143], v197 offset:1032
    v_mfma_f32_16x16x32_bf16 a[200:203], v[160:163], a[88:91], a[200:203]
    s_add_u32 m0, s45, 0xc000
    s_mov_b32 s52, 0x8280
    buffer_load_dwordx4 v207, s[76:79], s52 offen lds
    v_mfma_f32_16x16x32_bf16 a[204:207], v[160:163], a[92:95], a[204:207]
    v_mfma_f32_16x16x32_bf16 a[208:211], v[164:167], a[80:83], a[208:211]
    buffer_load_dwordx4 v208, s[76:79], s52 offen offset:1024 lds
    v_mfma_f32_16x16x32_bf16 a[212:215], v[164:167], a[84:87], a[212:215]
    ds_read_b64_tr_b16 v[144:145], v198 offset:0
    ds_read_b64_tr_b16 v[146:147], v198 offset:1024
    v_mfma_f32_16x16x32_bf16 a[216:219], v[164:167], a[88:91], a[216:219]
    v_mfma_f32_16x16x32_bf16 a[220:223], v[164:167], a[92:95], a[220:223]
    s_waitcnt lgkmcnt(15)
    s_add_u32 m0, s45, 0xe000
    s_mov_b32 s52, 0xc280
    buffer_load_dwordx4 v207, s[76:79], s52 offen lds
    s_waitcnt lgkmcnt(8)
    v_mfma_f32_16x16x32_bf16 a[128:131], v[212:215], a[140:143], a[128:131]
    v_mfma_f32_16x16x32_bf16 a[132:135], v[216:219], a[140:143], a[132:135]
    buffer_load_dwordx4 v208, s[76:79], s52 offen offset:1024 lds
    v_mfma_f32_16x16x32_bf16 a[136:139], v[220:223], a[140:143], a[136:139]
    v_mfma_f32_16x16x32_bf16 a[224:227], v[168:171], a[80:83], a[224:227]
    s_add_u32 m0, s45, 0x22000
    s_mov_b32 s51, 0x280000
    buffer_load_dwordx4 v204, s[16:19], s51 offen lds
    v_mfma_f32_16x16x32_bf16 a[228:231], v[168:171], a[84:87], a[228:231]
    ds_read_b64_tr_b16 v[148:149], v198 offset:8
    ds_read_b64_tr_b16 v[150:151], v198 offset:1032
    v_mfma_f32_16x16x32_bf16 a[232:235], v[168:171], a[88:91], a[232:235]
    v_mfma_f32_16x16x32_bf16 a[236:239], v[168:171], a[92:95], a[236:239]
    buffer_load_dwordx4 v205, s[16:19], s51 offen offset:1024 lds
    v_mfma_f32_16x16x32_bf16 a[240:243], v[172:175], a[80:83], a[240:243]
    v_mfma_f32_16x16x32_bf16 a[244:247], v[172:175], a[84:87], a[244:247]
    ds_read_b64_tr_b16 v[152:153], v199 offset:0
    ds_read_b64_tr_b16 v[154:155], v199 offset:1024
    v_mfma_f32_16x16x32_bf16 a[248:251], v[172:175], a[88:91], a[248:251]
    s_add_u32 m0, s46, 0x24000
    s_mov_b32 s51, 0x118000
    buffer_load_dwordx4 v206, s[20:23], s51 offen lds
    v_mfma_f32_16x16x32_bf16 a[252:255], v[172:175], a[92:95], a[252:255]
    v_mfma_f32_16x16x32_bf16 v[0:3], v[128:131], a[96:99], v[0:3]
    v_mfma_f32_16x16x32_bf16 v[8:11], v[128:131], a[100:103], v[8:11]
    ds_read_b64_tr_b16 v[156:157], v199 offset:8
    ds_read_b64_tr_b16 v[158:159], v199 offset:1032
    v_mfma_f32_16x16x32_bf16 v[16:19], v[128:131], a[104:107], v[16:19]
    v_mfma_f32_16x16x32_bf16 v[24:27], v[128:131], a[108:111], v[24:27]
    s_waitcnt lgkmcnt(12)
    v_mfma_f32_16x16x32_bf16 v[4:7], v[132:135], a[96:99], v[4:7]
    v_mfma_f32_16x16x32_bf16 v[12:15], v[132:135], a[100:103], v[12:15]
    ds_read_b64_tr_b16 v[160:161], v200 offset:0
    ds_read_b64_tr_b16 v[162:163], v200 offset:512
    v_mfma_f32_16x16x32_bf16 v[20:23], v[132:135], a[104:107], v[20:23]
    v_mfma_f32_16x16x32_bf16 v[28:31], v[132:135], a[108:111], v[28:31]
    s_waitcnt lgkmcnt(12)
    v_mfma_f32_16x16x32_bf16 v[32:35], v[136:139], a[96:99], v[32:35]
    v_mfma_f32_16x16x32_bf16 v[40:43], v[136:139], a[100:103], v[40:43]
    ds_read_b64_tr_b16 v[164:165], v201 offset:0
    ds_read_b64_tr_b16 v[166:167], v201 offset:512
    v_mfma_f32_16x16x32_bf16 v[48:51], v[136:139], a[104:107], v[48:51]
    v_mfma_f32_16x16x32_bf16 v[56:59], v[136:139], a[108:111], v[56:59]
    s_waitcnt lgkmcnt(12)
    v_mfma_f32_16x16x32_bf16 v[36:39], v[140:143], a[96:99], v[36:39]
    v_mfma_f32_16x16x32_bf16 v[44:47], v[140:143], a[100:103], v[44:47]
    ds_read_b64_tr_b16 v[168:169], v202 offset:0
    ds_read_b64_tr_b16 v[170:171], v202 offset:512
    v_mfma_f32_16x16x32_bf16 v[52:55], v[140:143], a[104:107], v[52:55]
    v_mfma_f32_16x16x32_bf16 v[60:63], v[140:143], a[108:111], v[60:63]
    s_waitcnt lgkmcnt(12)
    v_mfma_f32_16x16x32_bf16 v[64:67], v[144:147], a[96:99], v[64:67]
    v_mfma_f32_16x16x32_bf16 v[72:75], v[144:147], a[100:103], v[72:75]
    ds_read_b64_tr_b16 v[172:173], v203 offset:0
    ds_read_b64_tr_b16 v[174:175], v203 offset:512
    v_mfma_f32_16x16x32_bf16 v[80:83], v[144:147], a[104:107], v[80:83]
    v_mfma_f32_16x16x32_bf16 v[88:91], v[144:147], a[108:111], v[88:91]
    s_waitcnt lgkmcnt(12)
    s_waitcnt vmcnt(26)
    s_barrier
    v_mfma_f32_16x16x32_bf16 v[68:71], v[148:151], a[96:99], v[68:71]
    ds_read_b64_tr_b16 v[212:213], v209 offset:12288
    ds_read_b64_tr_b16 v[214:215], v209 offset:13312
    v_mfma_f32_16x16x32_bf16 v[76:79], v[148:151], a[100:103], v[76:79]
    ds_read_b64_tr_b16 v[128:129], v196 offset:12288
    ds_read_b64_tr_b16 v[130:131], v196 offset:13312
    v_mfma_f32_16x16x32_bf16 v[84:87], v[148:151], a[104:107], v[84:87]
    ds_read_b64_tr_b16 v[216:217], v209 offset:12296
    ds_read_b64_tr_b16 v[218:219], v209 offset:13320
    v_mfma_f32_16x16x32_bf16 v[92:95], v[148:151], a[108:111], v[92:95]
    s_waitcnt lgkmcnt(15)
    ds_read_b64_tr_b16 v[220:221], v210 offset:12288
    ds_read_b64_tr_b16 v[222:223], v210 offset:12800
    v_mfma_f32_16x16x32_bf16 v[96:99], v[152:155], a[96:99], v[96:99]
    s_add_u32 m0, s45, 0x25000
    s_mov_b32 s51, 0x2c0000
    buffer_load_dwordx4 v204, s[16:19], s51 offen lds
    v_mfma_f32_16x16x32_bf16 v[104:107], v[152:155], a[100:103], v[104:107]
    ds_read_b64_tr_b16 v[132:133], v196 offset:12296
    ds_read_b64_tr_b16 v[134:135], v196 offset:13320
    v_mfma_f32_16x16x32_bf16 v[112:115], v[152:155], a[104:107], v[112:115]
    v_mfma_f32_16x16x32_bf16 v[120:123], v[152:155], a[108:111], v[120:123]
    s_waitcnt lgkmcnt(15)
    v_mfma_f32_16x16x32_bf16 v[100:103], v[156:159], a[96:99], v[100:103]
    v_mfma_f32_16x16x32_bf16 v[108:111], v[156:159], a[100:103], v[108:111]
    ds_read_b64_tr_b16 v[136:137], v197 offset:12288
    ds_read_b64_tr_b16 v[138:139], v197 offset:13312
    v_mfma_f32_16x16x32_bf16 v[116:119], v[156:159], a[104:107], v[116:119]
    buffer_load_dwordx4 v205, s[16:19], s51 offen offset:1024 lds
    v_mfma_f32_16x16x32_bf16 v[124:127], v[156:159], a[108:111], v[124:127]
    v_mfma_f32_16x16x32_bf16 a[192:195], v[160:163], a[96:99], a[192:195]
    v_mfma_f32_16x16x32_bf16 a[196:199], v[160:163], a[100:103], a[196:199]
    ds_read_b64_tr_b16 v[140:141], v197 offset:12296
    ds_read_b64_tr_b16 v[142:143], v197 offset:13320
    v_mfma_f32_16x16x32_bf16 a[200:203], v[160:163], a[104:107], a[200:203]
    v_mfma_f32_16x16x32_bf16 a[204:207], v[160:163], a[108:111], a[204:207]
    s_waitcnt lgkmcnt(15)
    s_add_u32 m0, s46, 0x27000
    s_mov_b32 s51, 0x134000
    buffer_load_dwordx4 v206, s[20:23], s51 offen lds
    v_mfma_f32_16x16x32_bf16 a[208:211], v[164:167], a[96:99], a[208:211]
    v_mfma_f32_16x16x32_bf16 a[212:215], v[164:167], a[100:103], a[212:215]
    ds_read_b64_tr_b16 v[144:145], v198 offset:12288
    ds_read_b64_tr_b16 v[146:147], v198 offset:13312
    v_mfma_f32_16x16x32_bf16 a[216:219], v[164:167], a[104:107], a[216:219]
    v_mfma_f32_16x16x32_bf16 a[220:223], v[164:167], a[108:111], a[220:223]
    s_waitcnt lgkmcnt(8)
    v_mfma_f32_16x16x32_bf16 a[128:131], v[212:215], a[140:143], a[128:131]
    s_add_u32 m0, s45, 0x10000
    s_mov_b32 s51, 0x0
    buffer_load_dwordx4 v194, s[12:15], s51 offen lds
    v_mfma_f32_16x16x32_bf16 a[132:135], v[216:219], a[140:143], a[132:135]
    v_mfma_f32_16x16x32_bf16 a[136:139], v[220:223], a[140:143], a[136:139]
    v_mfma_f32_16x16x32_bf16 a[224:227], v[168:171], a[96:99], a[224:227]
    v_mfma_f32_16x16x32_bf16 a[228:231], v[168:171], a[100:103], a[228:231]
    ds_read_b64_tr_b16 v[148:149], v198 offset:12296
    ds_read_b64_tr_b16 v[150:151], v198 offset:13320
    v_mfma_f32_16x16x32_bf16 a[232:235], v[168:171], a[104:107], a[232:235]
    buffer_load_dwordx4 v195, s[12:15], s51 offen offset:1024 lds
    v_mfma_f32_16x16x32_bf16 a[236:239], v[168:171], a[108:111], a[236:239]
    v_mfma_f32_16x16x32_bf16 a[240:243], v[172:175], a[96:99], a[240:243]
    v_mfma_f32_16x16x32_bf16 a[244:247], v[172:175], a[100:103], a[244:247]
    ds_read_b64_tr_b16 v[152:153], v199 offset:12288
    ds_read_b64_tr_b16 v[154:155], v199 offset:13312
    v_mfma_f32_16x16x32_bf16 a[248:251], v[172:175], a[104:107], a[248:251]
    v_mfma_f32_16x16x32_bf16 a[252:255], v[172:175], a[108:111], a[252:255]
    v_mfma_f32_16x16x32_bf16 v[0:3], v[128:131], a[112:115], v[0:3]
    s_waitcnt vmcnt(23)
    ds_read_b128 a[0:3], v176 offset:0
    v_mfma_f32_16x16x32_bf16 v[8:11], v[128:131], a[116:119], v[8:11]
    ds_read_b64_tr_b16 v[156:157], v199 offset:12296
    ds_read_b64_tr_b16 v[158:159], v199 offset:13320
    v_mfma_f32_16x16x32_bf16 v[16:19], v[128:131], a[120:123], v[16:19]
    ds_read_b128 a[4:7], v176 offset:8192
    v_mfma_f32_16x16x32_bf16 v[24:27], v[128:131], a[124:127], v[24:27]
    s_waitcnt lgkmcnt(14)
    ds_read_b128 a[8:11], v176 offset:16384
    v_mfma_f32_16x16x32_bf16 v[4:7], v[132:135], a[112:115], v[4:7]
    ds_read_b128 a[12:15], v176 offset:24576
    v_mfma_f32_16x16x32_bf16 v[12:15], v[132:135], a[116:119], v[12:15]
    ds_read_b64_tr_b16 v[160:161], v200 offset:12288
    ds_read_b64_tr_b16 v[162:163], v200 offset:12800
    v_mfma_f32_16x16x32_bf16 v[20:23], v[132:135], a[120:123], v[20:23]
    ds_read_b128 a[16:19], v177 offset:0
    v_mfma_f32_16x16x32_bf16 v[28:31], v[132:135], a[124:127], v[28:31]
    s_waitcnt lgkmcnt(15)
    ds_read_b128 a[20:23], v177 offset:8192
    v_mfma_f32_16x16x32_bf16 v[32:35], v[136:139], a[112:115], v[32:35]
    ds_read_b128 a[24:27], v177 offset:16384
    v_mfma_f32_16x16x32_bf16 v[40:43], v[136:139], a[116:119], v[40:43]
    ds_read_b64_tr_b16 v[164:165], v201 offset:12288
    ds_read_b64_tr_b16 v[166:167], v201 offset:12800
    v_mfma_f32_16x16x32_bf16 v[48:51], v[136:139], a[120:123], v[48:51]
    ds_read_b128 a[28:31], v177 offset:24576
    v_mfma_f32_16x16x32_bf16 v[56:59], v[136:139], a[124:127], v[56:59]
    v_mfma_f32_16x16x32_bf16 v[36:39], v[140:143], a[112:115], v[36:39]
    v_mfma_f32_16x16x32_bf16 v[44:47], v[140:143], a[116:119], v[44:47]
    ds_read_b64_tr_b16 v[168:169], v202 offset:12288
    ds_read_b64_tr_b16 v[170:171], v202 offset:12800
    v_mfma_f32_16x16x32_bf16 v[52:55], v[140:143], a[120:123], v[52:55]
    v_mfma_f32_16x16x32_bf16 v[60:63], v[140:143], a[124:127], v[60:63]
    s_waitcnt lgkmcnt(15)
    v_mfma_f32_16x16x32_bf16 v[64:67], v[144:147], a[112:115], v[64:67]
    v_mfma_f32_16x16x32_bf16 v[72:75], v[144:147], a[116:119], v[72:75]
    ds_read_b64_tr_b16 v[172:173], v203 offset:12288
    ds_read_b64_tr_b16 v[174:175], v203 offset:12800
    v_mfma_f32_16x16x32_bf16 v[80:83], v[144:147], a[120:123], v[80:83]
    v_mfma_f32_16x16x32_bf16 v[88:91], v[144:147], a[124:127], v[88:91]
    s_waitcnt vmcnt(20)
    s_barrier
    v_mfma_f32_16x16x32_bf16 v[68:71], v[148:151], a[112:115], v[68:71]
    ds_read_b64_tr_b16 v[212:213], v209 offset:24576
    ds_read_b64_tr_b16 v[214:215], v209 offset:25600
    v_mfma_f32_16x16x32_bf16 v[76:79], v[148:151], a[116:119], v[76:79]
    ds_read_b64_tr_b16 v[128:129], v196 offset:24576
    ds_read_b64_tr_b16 v[130:131], v196 offset:25600
    v_mfma_f32_16x16x32_bf16 v[84:87], v[148:151], a[120:123], v[84:87]
    ds_read_b64_tr_b16 v[216:217], v209 offset:24584
    ds_read_b64_tr_b16 v[218:219], v209 offset:25608
    v_mfma_f32_16x16x32_bf16 v[92:95], v[148:151], a[124:127], v[92:95]
    ds_read_b64_tr_b16 v[220:221], v210 offset:24576
    ds_read_b64_tr_b16 v[222:223], v210 offset:25088
    v_mfma_f32_16x16x32_bf16 v[96:99], v[152:155], a[112:115], v[96:99]
    s_waitcnt lgkmcnt(12)
    s_add_u32 m0, s45, 0x0
    s_mov_b32 s52, 0x300
    buffer_load_dwordx4 v207, s[76:79], s52 offen lds
    v_mfma_f32_16x16x32_bf16 v[104:107], v[152:155], a[116:119], v[104:107]
    ds_read_b64_tr_b16 v[132:133], v196 offset:24584
    ds_read_b64_tr_b16 v[134:135], v196 offset:25608
    v_mfma_f32_16x16x32_bf16 v[112:115], v[152:155], a[120:123], v[112:115]
    buffer_load_dwordx4 v208, s[76:79], s52 offen offset:1024 lds
    v_mfma_f32_16x16x32_bf16 v[120:123], v[152:155], a[124:127], v[120:123]
    v_mfma_f32_16x16x32_bf16 v[100:103], v[156:159], a[112:115], v[100:103]
    s_add_u32 m0, s45, 0x2000
    s_mov_b32 s52, 0x4300
    buffer_load_dwordx4 v207, s[76:79], s52 offen lds
    v_mfma_f32_16x16x32_bf16 v[108:111], v[156:159], a[116:119], v[108:111]
    ds_read_b64_tr_b16 v[136:137], v197 offset:24576
    ds_read_b64_tr_b16 v[138:139], v197 offset:25600
    v_mfma_f32_16x16x32_bf16 v[116:119], v[156:159], a[120:123], v[116:119]
    v_mfma_f32_16x16x32_bf16 v[124:127], v[156:159], a[124:127], v[124:127]
    buffer_load_dwordx4 v208, s[76:79], s52 offen offset:1024 lds
    v_mfma_f32_16x16x32_bf16 a[192:195], v[160:163], a[112:115], a[192:195]
    v_mfma_f32_16x16x32_bf16 a[196:199], v[160:163], a[116:119], a[196:199]
    ds_read_b64_tr_b16 v[140:141], v197 offset:24584
    ds_read_b64_tr_b16 v[142:143], v197 offset:25608
    v_mfma_f32_16x16x32_bf16 a[200:203], v[160:163], a[120:123], a[200:203]
    s_add_u32 m0, s45, 0x4000
    s_mov_b32 s52, 0x8300
    buffer_load_dwordx4 v207, s[76:79], s52 offen lds
    v_mfma_f32_16x16x32_bf16 a[204:207], v[160:163], a[124:127], a[204:207]
    v_mfma_f32_16x16x32_bf16 a[208:211], v[164:167], a[112:115], a[208:211]
    buffer_load_dwordx4 v208, s[76:79], s52 offen offset:1024 lds
    v_mfma_f32_16x16x32_bf16 a[212:215], v[164:167], a[116:119], a[212:215]
    ds_read_b64_tr_b16 v[144:145], v198 offset:24576
    ds_read_b64_tr_b16 v[146:147], v198 offset:25600
    v_mfma_f32_16x16x32_bf16 a[216:219], v[164:167], a[120:123], a[216:219]
    v_mfma_f32_16x16x32_bf16 a[220:223], v[164:167], a[124:127], a[220:223]
    s_waitcnt lgkmcnt(15)
    s_add_u32 m0, s45, 0x6000
    s_mov_b32 s52, 0xc300
    buffer_load_dwordx4 v207, s[76:79], s52 offen lds
    s_waitcnt lgkmcnt(8)
    v_mfma_f32_16x16x32_bf16 a[128:131], v[212:215], a[140:143], a[128:131]
    v_mfma_f32_16x16x32_bf16 a[132:135], v[216:219], a[140:143], a[132:135]
    buffer_load_dwordx4 v208, s[76:79], s52 offen offset:1024 lds
    v_mfma_f32_16x16x32_bf16 a[136:139], v[220:223], a[140:143], a[136:139]
    v_mfma_f32_16x16x32_bf16 a[224:227], v[168:171], a[112:115], a[224:227]
    s_add_u32 m0, s45, 0x16000
    s_mov_b32 s51, 0x300000
    buffer_load_dwordx4 v204, s[16:19], s51 offen lds
    v_mfma_f32_16x16x32_bf16 a[228:231], v[168:171], a[116:119], a[228:231]
    ds_read_b64_tr_b16 v[148:149], v198 offset:24584
    ds_read_b64_tr_b16 v[150:151], v198 offset:25608
    v_mfma_f32_16x16x32_bf16 a[232:235], v[168:171], a[120:123], a[232:235]
    v_mfma_f32_16x16x32_bf16 a[236:239], v[168:171], a[124:127], a[236:239]
    buffer_load_dwordx4 v205, s[16:19], s51 offen offset:1024 lds
    v_mfma_f32_16x16x32_bf16 a[240:243], v[172:175], a[112:115], a[240:243]
    v_mfma_f32_16x16x32_bf16 a[244:247], v[172:175], a[116:119], a[244:247]
    ds_read_b64_tr_b16 v[152:153], v199 offset:24576
    ds_read_b64_tr_b16 v[154:155], v199 offset:25600
    v_mfma_f32_16x16x32_bf16 a[248:251], v[172:175], a[120:123], a[248:251]
    s_add_u32 m0, s46, 0x18000
    s_mov_b32 s51, 0x150000
    buffer_load_dwordx4 v206, s[20:23], s51 offen lds
    v_mfma_f32_16x16x32_bf16 a[252:255], v[172:175], a[124:127], a[252:255]
    v_mfma_f32_16x16x32_bf16 v[0:3], v[128:131], a[0:3], v[0:3]
    v_mfma_f32_16x16x32_bf16 v[8:11], v[128:131], a[4:7], v[8:11]
    ds_read_b64_tr_b16 v[156:157], v199 offset:24584
    ds_read_b64_tr_b16 v[158:159], v199 offset:25608
    v_mfma_f32_16x16x32_bf16 v[16:19], v[128:131], a[8:11], v[16:19]
    v_mfma_f32_16x16x32_bf16 v[24:27], v[128:131], a[12:15], v[24:27]
    s_waitcnt lgkmcnt(12)
    v_mfma_f32_16x16x32_bf16 v[4:7], v[132:135], a[0:3], v[4:7]
    v_mfma_f32_16x16x32_bf16 v[12:15], v[132:135], a[4:7], v[12:15]
    ds_read_b64_tr_b16 v[160:161], v200 offset:24576
    ds_read_b64_tr_b16 v[162:163], v200 offset:25088
    v_mfma_f32_16x16x32_bf16 v[20:23], v[132:135], a[8:11], v[20:23]
    v_mfma_f32_16x16x32_bf16 v[28:31], v[132:135], a[12:15], v[28:31]
    s_waitcnt lgkmcnt(12)
    v_mfma_f32_16x16x32_bf16 v[32:35], v[136:139], a[0:3], v[32:35]
    v_mfma_f32_16x16x32_bf16 v[40:43], v[136:139], a[4:7], v[40:43]
    ds_read_b64_tr_b16 v[164:165], v201 offset:24576
    ds_read_b64_tr_b16 v[166:167], v201 offset:25088
    v_mfma_f32_16x16x32_bf16 v[48:51], v[136:139], a[8:11], v[48:51]
    v_mfma_f32_16x16x32_bf16 v[56:59], v[136:139], a[12:15], v[56:59]
    s_waitcnt lgkmcnt(12)
    v_mfma_f32_16x16x32_bf16 v[36:39], v[140:143], a[0:3], v[36:39]
    v_mfma_f32_16x16x32_bf16 v[44:47], v[140:143], a[4:7], v[44:47]
    ds_read_b64_tr_b16 v[168:169], v202 offset:24576
    ds_read_b64_tr_b16 v[170:171], v202 offset:25088
    v_mfma_f32_16x16x32_bf16 v[52:55], v[140:143], a[8:11], v[52:55]
    v_mfma_f32_16x16x32_bf16 v[60:63], v[140:143], a[12:15], v[60:63]
    s_waitcnt lgkmcnt(12)
    v_mfma_f32_16x16x32_bf16 v[64:67], v[144:147], a[0:3], v[64:67]
    v_mfma_f32_16x16x32_bf16 v[72:75], v[144:147], a[4:7], v[72:75]
    ds_read_b64_tr_b16 v[172:173], v203 offset:24576
    ds_read_b64_tr_b16 v[174:175], v203 offset:25088
    v_mfma_f32_16x16x32_bf16 v[80:83], v[144:147], a[8:11], v[80:83]
    v_mfma_f32_16x16x32_bf16 v[88:91], v[144:147], a[12:15], v[88:91]
    s_waitcnt lgkmcnt(12)
    s_waitcnt vmcnt(27)
    s_barrier
    v_mfma_f32_16x16x32_bf16 v[68:71], v[148:151], a[0:3], v[68:71]
    ds_read_b64_tr_b16 v[212:213], v209 offset:36864
    ds_read_b64_tr_b16 v[214:215], v209 offset:37888
    v_mfma_f32_16x16x32_bf16 v[76:79], v[148:151], a[4:7], v[76:79]
    ds_read_b64_tr_b16 v[128:129], v196 offset:36864
    ds_read_b64_tr_b16 v[130:131], v196 offset:37888
    v_mfma_f32_16x16x32_bf16 v[84:87], v[148:151], a[8:11], v[84:87]
    ds_read_b64_tr_b16 v[216:217], v209 offset:36872
    ds_read_b64_tr_b16 v[218:219], v209 offset:37896
    v_mfma_f32_16x16x32_bf16 v[92:95], v[148:151], a[12:15], v[92:95]
    s_waitcnt lgkmcnt(15)
    ds_read_b64_tr_b16 v[220:221], v210 offset:36864
    ds_read_b64_tr_b16 v[222:223], v210 offset:37376
    v_mfma_f32_16x16x32_bf16 v[96:99], v[152:155], a[0:3], v[96:99]
    s_add_u32 m0, s45, 0x19000
    s_mov_b32 s51, 0x340000
    buffer_load_dwordx4 v204, s[16:19], s51 offen lds
    v_mfma_f32_16x16x32_bf16 v[104:107], v[152:155], a[4:7], v[104:107]
    ds_read_b64_tr_b16 v[132:133], v196 offset:36872
    ds_read_b64_tr_b16 v[134:135], v196 offset:37896
    v_mfma_f32_16x16x32_bf16 v[112:115], v[152:155], a[8:11], v[112:115]
    v_mfma_f32_16x16x32_bf16 v[120:123], v[152:155], a[12:15], v[120:123]
    s_waitcnt lgkmcnt(15)
    v_mfma_f32_16x16x32_bf16 v[100:103], v[156:159], a[0:3], v[100:103]
    v_mfma_f32_16x16x32_bf16 v[108:111], v[156:159], a[4:7], v[108:111]
    ds_read_b64_tr_b16 v[136:137], v197 offset:36864
    ds_read_b64_tr_b16 v[138:139], v197 offset:37888
    v_mfma_f32_16x16x32_bf16 v[116:119], v[156:159], a[8:11], v[116:119]
    buffer_load_dwordx4 v205, s[16:19], s51 offen offset:1024 lds
    v_mfma_f32_16x16x32_bf16 v[124:127], v[156:159], a[12:15], v[124:127]
    v_mfma_f32_16x16x32_bf16 a[192:195], v[160:163], a[0:3], a[192:195]
    v_mfma_f32_16x16x32_bf16 a[196:199], v[160:163], a[4:7], a[196:199]
    ds_read_b64_tr_b16 v[140:141], v197 offset:36872
    ds_read_b64_tr_b16 v[142:143], v197 offset:37896
    v_mfma_f32_16x16x32_bf16 a[200:203], v[160:163], a[8:11], a[200:203]
    v_mfma_f32_16x16x32_bf16 a[204:207], v[160:163], a[12:15], a[204:207]
    s_waitcnt lgkmcnt(15)
    s_add_u32 m0, s46, 0x1b000
    s_mov_b32 s51, 0x16c000
    buffer_load_dwordx4 v206, s[20:23], s51 offen lds
    v_mfma_f32_16x16x32_bf16 a[208:211], v[164:167], a[0:3], a[208:211]
    v_mfma_f32_16x16x32_bf16 a[212:215], v[164:167], a[4:7], a[212:215]
    ds_read_b64_tr_b16 v[144:145], v198 offset:36864
    ds_read_b64_tr_b16 v[146:147], v198 offset:37888
    v_mfma_f32_16x16x32_bf16 a[216:219], v[164:167], a[8:11], a[216:219]
    v_mfma_f32_16x16x32_bf16 a[220:223], v[164:167], a[12:15], a[220:223]
    s_waitcnt lgkmcnt(8)
    v_mfma_f32_16x16x32_bf16 a[128:131], v[212:215], a[140:143], a[128:131]
    s_add_u32 m0, s45, 0x12000
    s_mov_b32 s51, 0x2000
    buffer_load_dwordx4 v194, s[12:15], s51 offen lds
    v_mfma_f32_16x16x32_bf16 a[132:135], v[216:219], a[140:143], a[132:135]
    v_mfma_f32_16x16x32_bf16 a[136:139], v[220:223], a[140:143], a[136:139]
    v_mfma_f32_16x16x32_bf16 a[224:227], v[168:171], a[0:3], a[224:227]
    v_mfma_f32_16x16x32_bf16 a[228:231], v[168:171], a[4:7], a[228:231]
    ds_read_b64_tr_b16 v[148:149], v198 offset:36872
    ds_read_b64_tr_b16 v[150:151], v198 offset:37896
    v_mfma_f32_16x16x32_bf16 a[232:235], v[168:171], a[8:11], a[232:235]
    buffer_load_dwordx4 v195, s[12:15], s51 offen offset:1024 lds
    v_mfma_f32_16x16x32_bf16 a[236:239], v[168:171], a[12:15], a[236:239]
    v_mfma_f32_16x16x32_bf16 a[240:243], v[172:175], a[0:3], a[240:243]
    v_mfma_f32_16x16x32_bf16 a[244:247], v[172:175], a[4:7], a[244:247]
    ds_read_b64_tr_b16 v[152:153], v199 offset:36864
    ds_read_b64_tr_b16 v[154:155], v199 offset:37888
    v_mfma_f32_16x16x32_bf16 a[248:251], v[172:175], a[8:11], a[248:251]
    v_mfma_f32_16x16x32_bf16 a[252:255], v[172:175], a[12:15], a[252:255]
    v_mfma_f32_16x16x32_bf16 v[0:3], v[128:131], a[16:19], v[0:3]
    s_waitcnt vmcnt(24)
    ds_read_b128 a[32:35], v176 offset:32768
    v_mfma_f32_16x16x32_bf16 v[8:11], v[128:131], a[20:23], v[8:11]
    ds_read_b64_tr_b16 v[156:157], v199 offset:36872
    ds_read_b64_tr_b16 v[158:159], v199 offset:37896
    v_mfma_f32_16x16x32_bf16 v[16:19], v[128:131], a[24:27], v[16:19]
    ds_read_b128 a[36:39], v176 offset:40960
    v_mfma_f32_16x16x32_bf16 v[24:27], v[128:131], a[28:31], v[24:27]
    s_waitcnt lgkmcnt(14)
    ds_read_b128 a[40:43], v176 offset:49152
    v_mfma_f32_16x16x32_bf16 v[4:7], v[132:135], a[16:19], v[4:7]
    ds_read_b128 a[44:47], v176 offset:57344
    v_mfma_f32_16x16x32_bf16 v[12:15], v[132:135], a[20:23], v[12:15]
    ds_read_b64_tr_b16 v[160:161], v200 offset:36864
    ds_read_b64_tr_b16 v[162:163], v200 offset:37376
    v_mfma_f32_16x16x32_bf16 v[20:23], v[132:135], a[24:27], v[20:23]
    ds_read_b128 a[48:51], v177 offset:32768
    v_mfma_f32_16x16x32_bf16 v[28:31], v[132:135], a[28:31], v[28:31]
    s_waitcnt lgkmcnt(15)
    ds_read_b128 a[52:55], v177 offset:40960
    v_mfma_f32_16x16x32_bf16 v[32:35], v[136:139], a[16:19], v[32:35]
    ds_read_b128 a[56:59], v177 offset:49152
    v_mfma_f32_16x16x32_bf16 v[40:43], v[136:139], a[20:23], v[40:43]
    ds_read_b64_tr_b16 v[164:165], v201 offset:36864
    ds_read_b64_tr_b16 v[166:167], v201 offset:37376
    v_mfma_f32_16x16x32_bf16 v[48:51], v[136:139], a[24:27], v[48:51]
    ds_read_b128 a[60:63], v177 offset:57344
    v_mfma_f32_16x16x32_bf16 v[56:59], v[136:139], a[28:31], v[56:59]
    v_mfma_f32_16x16x32_bf16 v[36:39], v[140:143], a[16:19], v[36:39]
    v_mfma_f32_16x16x32_bf16 v[44:47], v[140:143], a[20:23], v[44:47]
    ds_read_b64_tr_b16 v[168:169], v202 offset:36864
    ds_read_b64_tr_b16 v[170:171], v202 offset:37376
    v_mfma_f32_16x16x32_bf16 v[52:55], v[140:143], a[24:27], v[52:55]
    v_mfma_f32_16x16x32_bf16 v[60:63], v[140:143], a[28:31], v[60:63]
    s_waitcnt lgkmcnt(15)
    v_mfma_f32_16x16x32_bf16 v[64:67], v[144:147], a[16:19], v[64:67]
    v_mfma_f32_16x16x32_bf16 v[72:75], v[144:147], a[20:23], v[72:75]
    ds_read_b64_tr_b16 v[172:173], v203 offset:36864
    ds_read_b64_tr_b16 v[174:175], v203 offset:37376
    v_mfma_f32_16x16x32_bf16 v[80:83], v[144:147], a[24:27], v[80:83]
    v_mfma_f32_16x16x32_bf16 v[88:91], v[144:147], a[28:31], v[88:91]
    s_waitcnt vmcnt(21)
    s_barrier
    v_mfma_f32_16x16x32_bf16 v[68:71], v[148:151], a[16:19], v[68:71]
    ds_read_b64_tr_b16 v[212:213], v209 offset:49152
    ds_read_b64_tr_b16 v[214:215], v209 offset:50176
    v_mfma_f32_16x16x32_bf16 v[76:79], v[148:151], a[20:23], v[76:79]
    ds_read_b64_tr_b16 v[128:129], v196 offset:49152
    ds_read_b64_tr_b16 v[130:131], v196 offset:50176
    v_mfma_f32_16x16x32_bf16 v[84:87], v[148:151], a[24:27], v[84:87]
    ds_read_b64_tr_b16 v[216:217], v209 offset:49160
    ds_read_b64_tr_b16 v[218:219], v209 offset:50184
    v_mfma_f32_16x16x32_bf16 v[92:95], v[148:151], a[28:31], v[92:95]
    ds_read_b64_tr_b16 v[220:221], v210 offset:49152
    ds_read_b64_tr_b16 v[222:223], v210 offset:49664
    v_mfma_f32_16x16x32_bf16 v[96:99], v[152:155], a[16:19], v[96:99]
L_it3:
    s_cbranch_execz L_it7
    s_waitcnt lgkmcnt(12)
    s_add_u32 m0, s45, 0x8000
    s_mov_b32 s52, 0x380
    buffer_load_dwordx4 v207, s[76:79], s52 offen lds
    v_mfma_f32_16x16x32_bf16 v[104:107], v[152:155], a[20:23], v[104:107]
    ds_read_b64_tr_b16 v[132:133], v196 offset:49160
    ds_read_b64_tr_b16 v[134:135], v196 offset:50184
    v_mfma_f32_16x16x32_bf16 v[112:115], v[152:155], a[24:27], v[112:115]
    buffer_load_dwordx4 v208, s[76:79], s52 offen offset:1024 lds
    v_mfma_f32_16x16x32_bf16 v[120:123], v[152:155], a[28:31], v[120:123]
    v_mfma_f32_16x16x32_bf16 v[100:103], v[156:159], a[16:19], v[100:103]
    s_add_u32 m0, s45, 0xa000
    s_mov_b32 s52, 0x4380
    buffer_load_dwordx4 v207, s[76:79], s52 offen lds
    v_mfma_f32_16x16x32_bf16 v[108:111], v[156:159], a[20:23], v[108:111]
    ds_read_b64_tr_b16 v[136:137], v197 offset:49152
    ds_read_b64_tr_b16 v[138:139], v197 offset:50176
    v_mfma_f32_16x16x32_bf16 v[116:119], v[156:159], a[24:27], v[116:119]
    v_mfma_f32_16x16x32_bf16 v[124:127], v[156:159], a[28:31], v[124:127]
    buffer_load_dwordx4 v208, s[76:79], s52 offen offset:1024 lds
    v_mfma_f32_16x16x32_bf16 a[192:195], v[160:163], a[16:19], a[192:195]
    v_mfma_f32_16x16x32_bf16 a[196:199], v[160:163], a[20:23], a[196:199]
    ds_read_b64_tr_b16 v[140:141], v197 offset:49160
    ds_read_b64_tr_b16 v[142:143], v197 offset:50184
    v_mfma_f32_16x16x32_bf16 a[200:203], v[160:163], a[24:27], a[200:203]
    s_add_u32 m0, s45, 0xc000
    s_mov_b32 s52, 0x8380
    buffer_load_dwordx4 v207, s[76:79], s52 offen lds
    v_mfma_f32_16x16x32_bf16 a[204:207], v[160:163], a[28:31], a[204:207]
    v_mfma_f32_16x16x32_bf16 a[208:211], v[164:167], a[16:19], a[208:211]
    buffer_load_dwordx4 v208, s[76:79], s52 offen offset:1024 lds
    v_mfma_f32_16x16x32_bf16 a[212:215], v[164:167], a[20:23], a[212:215]
    ds_read_b64_tr_b16 v[144:145], v198 offset:49152
    ds_read_b64_tr_b16 v[146:147], v198 offset:50176
    v_mfma_f32_16x16x32_bf16 a[216:219], v[164:167], a[24:27], a[216:219]
    v_mfma_f32_16x16x32_bf16 a[220:223], v[164:167], a[28:31], a[220:223]
    s_waitcnt lgkmcnt(15)
    s_add_u32 m0, s45, 0xe000
    s_mov_b32 s52, 0xc380
    buffer_load_dwordx4 v207, s[76:79], s52 offen lds
    s_waitcnt lgkmcnt(8)
    v_mfma_f32_16x16x32_bf16 a[128:131], v[212:215], a[140:143], a[128:131]
    v_mfma_f32_16x16x32_bf16 a[132:135], v[216:219], a[140:143], a[132:135]
    buffer_load_dwordx4 v208, s[76:79], s52 offen offset:1024 lds
    v_mfma_f32_16x16x32_bf16 a[136:139], v[220:223], a[140:143], a[136:139]
    v_mfma_f32_16x16x32_bf16 a[224:227], v[168:171], a[16:19], a[224:227]
    s_add_u32 m0, s45, 0x1c000
    s_mov_b32 s51, 0x380000
    buffer_load_dwordx4 v204, s[16:19], s51 offen lds
    v_mfma_f32_16x16x32_bf16 a[228:231], v[168:171], a[20:23], a[228:231]
    ds_read_b64_tr_b16 v[148:149], v198 offset:49160
    ds_read_b64_tr_b16 v[150:151], v198 offset:50184
    v_mfma_f32_16x16x32_bf16 a[232:235], v[168:171], a[24:27], a[232:235]
    v_mfma_f32_16x16x32_bf16 a[236:239], v[168:171], a[28:31], a[236:239]
    buffer_load_dwordx4 v205, s[16:19], s51 offen offset:1024 lds
    v_mfma_f32_16x16x32_bf16 a[240:243], v[172:175], a[16:19], a[240:243]
    v_mfma_f32_16x16x32_bf16 a[244:247], v[172:175], a[20:23], a[244:247]
    ds_read_b64_tr_b16 v[152:153], v199 offset:49152
    ds_read_b64_tr_b16 v[154:155], v199 offset:50176
    v_mfma_f32_16x16x32_bf16 a[248:251], v[172:175], a[24:27], a[248:251]
    s_add_u32 m0, s46, 0x1e000
    s_mov_b32 s51, 0x188000
    buffer_load_dwordx4 v206, s[20:23], s51 offen lds
    v_mfma_f32_16x16x32_bf16 a[252:255], v[172:175], a[28:31], a[252:255]
    v_mfma_f32_16x16x32_bf16 v[0:3], v[128:131], a[32:35], v[0:3]
    v_mfma_f32_16x16x32_bf16 v[8:11], v[128:131], a[36:39], v[8:11]
    ds_read_b64_tr_b16 v[156:157], v199 offset:49160
    ds_read_b64_tr_b16 v[158:159], v199 offset:50184
    v_mfma_f32_16x16x32_bf16 v[16:19], v[128:131], a[40:43], v[16:19]
    v_mfma_f32_16x16x32_bf16 v[24:27], v[128:131], a[44:47], v[24:27]
    s_waitcnt lgkmcnt(12)
    v_mfma_f32_16x16x32_bf16 v[4:7], v[132:135], a[32:35], v[4:7]
    v_mfma_f32_16x16x32_bf16 v[12:15], v[132:135], a[36:39], v[12:15]
    ds_read_b64_tr_b16 v[160:161], v200 offset:49152
    ds_read_b64_tr_b16 v[162:163], v200 offset:49664
    v_mfma_f32_16x16x32_bf16 v[20:23], v[132:135], a[40:43], v[20:23]
    v_mfma_f32_16x16x32_bf16 v[28:31], v[132:135], a[44:47], v[28:31]
    s_waitcnt lgkmcnt(12)
    v_mfma_f32_16x16x32_bf16 v[32:35], v[136:139], a[32:35], v[32:35]
    v_mfma_f32_16x16x32_bf16 v[40:43], v[136:139], a[36:39], v[40:43]
    ds_read_b64_tr_b16 v[164:165], v201 offset:49152
    ds_read_b64_tr_b16 v[166:167], v201 offset:49664
    v_mfma_f32_16x16x32_bf16 v[48:51], v[136:139], a[40:43], v[48:51]
    v_mfma_f32_16x16x32_bf16 v[56:59], v[136:139], a[44:47], v[56:59]
    s_waitcnt lgkmcnt(12)
    v_mfma_f32_16x16x32_bf16 v[36:39], v[140:143], a[32:35], v[36:39]
    v_mfma_f32_16x16x32_bf16 v[44:47], v[140:143], a[36:39], v[44:47]
    ds_read_b64_tr_b16 v[168:169], v202 offset:49152
    ds_read_b64_tr_b16 v[170:171], v202 offset:49664
    v_mfma_f32_16x16x32_bf16 v[52:55], v[140:143], a[40:43], v[52:55]
    v_mfma_f32_16x16x32_bf16 v[60:63], v[140:143], a[44:47], v[60:63]
    s_waitcnt lgkmcnt(12)
    v_mfma_f32_16x16x32_bf16 v[64:67], v[144:147], a[32:35], v[64:67]
    v_mfma_f32_16x16x32_bf16 v[72:75], v[144:147], a[36:39], v[72:75]
    ds_read_b64_tr_b16 v[172:173], v203 offset:49152
    ds_read_b64_tr_b16 v[174:175], v203 offset:49664
    v_mfma_f32_16x16x32_bf16 v[80:83], v[144:147], a[40:43], v[80:83]
    v_mfma_f32_16x16x32_bf16 v[88:91], v[144:147], a[44:47], v[88:91]
    s_waitcnt lgkmcnt(12)
    s_waitcnt vmcnt(29)
    s_barrier
    v_mfma_f32_16x16x32_bf16 v[68:71], v[148:151], a[32:35], v[68:71]
    ds_read_b64_tr_b16 v[212:213], v209 offset:61440
    ds_read_b64_tr_b16 v[214:215], v209 offset:62464
    v_mfma_f32_16x16x32_bf16 v[76:79], v[148:151], a[36:39], v[76:79]
    ds_read_b64_tr_b16 v[128:129], v196 offset:61440
    ds_read_b64_tr_b16 v[130:131], v196 offset:62464
    v_mfma_f32_16x16x32_bf16 v[84:87], v[148:151], a[40:43], v[84:87]
    ds_read_b64_tr_b16 v[216:217], v209 offset:61448
    ds_read_b64_tr_b16 v[218:219], v209 offset:62472
    v_mfma_f32_16x16x32_bf16 v[92:95], v[148:151], a[44:47], v[92:95]
    s_waitcnt lgkmcnt(15)
    ds_read_b64_tr_b16 v[220:221], v210 offset:61440
    ds_read_b64_tr_b16 v[222:223], v210 offset:61952
    v_mfma_f32_16x16x32_bf16 v[96:99], v[152:155], a[32:35], v[96:99]
    s_lshl_b32 s3, s43, 8
    s_lshl_b32 s53, s44, 6
    s_add_u32 s3, s3, s53
    s_lshl_b32 s53, s3, 3
    v_bfe_u32 v236, v211, 4, 4
    v_lshlrev_b32 v236, 3, v236
    v_add_u32 v236, s53, v236
    v_mfma_f32_16x16x32_bf16 v[104:107], v[152:155], a[36:39], v[104:107]
    ds_read_b64_tr_b16 v[132:133], v196 offset:61448
    ds_read_b64_tr_b16 v[134:135], v196 offset:62472
    v_mfma_f32_16x16x32_bf16 v[112:115], v[152:155], a[40:43], v[112:115]
    v_mfma_f32_16x16x32_bf16 v[120:123], v[152:155], a[44:47], v[120:123]
    s_waitcnt lgkmcnt(15)
    buffer_load_dwordx2 v[228:229], v236, s[24:27], 0 offen offset:0 sc1
    v_mfma_f32_16x16x32_bf16 v[100:103], v[156:159], a[32:35], v[100:103]
    v_mfma_f32_16x16x32_bf16 v[108:111], v[156:159], a[36:39], v[108:111]
    ds_read_b64_tr_b16 v[136:137], v197 offset:61440
    ds_read_b64_tr_b16 v[138:139], v197 offset:62464
    v_mfma_f32_16x16x32_bf16 v[116:119], v[156:159], a[40:43], v[116:119]
    buffer_load_dwordx2 v[230:231], v236, s[24:27], 0 offen offset:128 sc1
    v_mfma_f32_16x16x32_bf16 v[124:127], v[156:159], a[44:47], v[124:127]
    v_mfma_f32_16x16x32_bf16 a[192:195], v[160:163], a[32:35], a[192:195]
    buffer_load_dwordx2 v[232:233], v236, s[24:27], 0 offen offset:256 sc1
    v_mfma_f32_16x16x32_bf16 a[196:199], v[160:163], a[36:39], a[196:199]
    ds_read_b64_tr_b16 v[140:141], v197 offset:61448
    ds_read_b64_tr_b16 v[142:143], v197 offset:62472
    v_mfma_f32_16x16x32_bf16 a[200:203], v[160:163], a[40:43], a[200:203]
    v_mfma_f32_16x16x32_bf16 a[204:207], v[160:163], a[44:47], a[204:207]
    s_waitcnt lgkmcnt(15)
    buffer_load_dwordx2 v[234:235], v236, s[24:27], 0 offen offset:384 sc1
    v_mfma_f32_16x16x32_bf16 a[208:211], v[164:167], a[32:35], a[208:211]
    v_mfma_f32_16x16x32_bf16 a[212:215], v[164:167], a[36:39], a[212:215]
    ds_read_b64_tr_b16 v[144:145], v198 offset:61440
    ds_read_b64_tr_b16 v[146:147], v198 offset:62464
    v_mfma_f32_16x16x32_bf16 a[216:219], v[164:167], a[40:43], a[216:219]
    s_add_u32 m0, s45, 0x1f000
    s_mov_b32 s51, 0x3c0000
    buffer_load_dwordx4 v204, s[16:19], s51 offen lds
    v_mfma_f32_16x16x32_bf16 a[220:223], v[164:167], a[44:47], a[220:223]
    s_waitcnt lgkmcnt(8)
    v_mfma_f32_16x16x32_bf16 a[128:131], v[212:215], a[140:143], a[128:131]
    buffer_load_dwordx4 v205, s[16:19], s51 offen offset:1024 lds
    v_mfma_f32_16x16x32_bf16 a[132:135], v[216:219], a[140:143], a[132:135]
    v_mfma_f32_16x16x32_bf16 a[136:139], v[220:223], a[140:143], a[136:139]
    s_add_u32 m0, s46, 0x21000
    s_mov_b32 s51, 0x1a4000
    buffer_load_dwordx4 v206, s[20:23], s51 offen lds
    v_mfma_f32_16x16x32_bf16 a[224:227], v[168:171], a[32:35], a[224:227]
    v_mfma_f32_16x16x32_bf16 a[228:231], v[168:171], a[36:39], a[228:231]
    ds_read_b64_tr_b16 v[148:149], v198 offset:61448
    ds_read_b64_tr_b16 v[150:151], v198 offset:62472
    v_mfma_f32_16x16x32_bf16 a[232:235], v[168:171], a[40:43], a[232:235]
    s_add_u32 m0, s45, 0x14000
    s_mov_b32 s51, 0x4000
    buffer_load_dwordx4 v194, s[12:15], s51 offen lds
    v_mfma_f32_16x16x32_bf16 a[236:239], v[168:171], a[44:47], a[236:239]
    v_mfma_f32_16x16x32_bf16 a[240:243], v[172:175], a[32:35], a[240:243]
    buffer_load_dwordx4 v195, s[12:15], s51 offen offset:1024 lds
    v_mfma_f32_16x16x32_bf16 a[244:247], v[172:175], a[36:39], a[244:247]
    ds_read_b64_tr_b16 v[152:153], v199 offset:61440
    ds_read_b64_tr_b16 v[154:155], v199 offset:62464
    v_mfma_f32_16x16x32_bf16 a[248:251], v[172:175], a[40:43], a[248:251]
    v_mfma_f32_16x16x32_bf16 a[252:255], v[172:175], a[44:47], a[252:255]
    v_mfma_f32_16x16x32_bf16 v[0:3], v[128:131], a[48:51], v[0:3]
    s_waitcnt vmcnt(28)
    ds_read_b128 a[64:67], v176 offset:0
    v_mfma_f32_16x16x32_bf16 v[8:11], v[128:131], a[52:55], v[8:11]
    ds_read_b64_tr_b16 v[156:157], v199 offset:61448
    ds_read_b64_tr_b16 v[158:159], v199 offset:62472
    v_mfma_f32_16x16x32_bf16 v[16:19], v[128:131], a[56:59], v[16:19]
    ds_read_b128 a[68:71], v176 offset:8192
    v_mfma_f32_16x16x32_bf16 v[24:27], v[128:131], a[60:63], v[24:27]
    s_waitcnt lgkmcnt(14)
    ds_read_b128 a[72:75], v176 offset:16384
    v_mfma_f32_16x16x32_bf16 v[4:7], v[132:135], a[48:51], v[4:7]
    ds_read_b128 a[76:79], v176 offset:24576
    v_mfma_f32_16x16x32_bf16 v[12:15], v[132:135], a[52:55], v[12:15]
    ds_read_b64_tr_b16 v[160:161], v200 offset:61440
    ds_read_b64_tr_b16 v[162:163], v200 offset:61952
    v_mfma_f32_16x16x32_bf16 v[20:23], v[132:135], a[56:59], v[20:23]
    ds_read_b128 a[80:83], v177 offset:0
    v_mfma_f32_16x16x32_bf16 v[28:31], v[132:135], a[60:63], v[28:31]
    s_waitcnt lgkmcnt(15)
    ds_read_b128 a[84:87], v177 offset:8192
    v_mfma_f32_16x16x32_bf16 v[32:35], v[136:139], a[48:51], v[32:35]
    ds_read_b128 a[88:91], v177 offset:16384
    v_mfma_f32_16x16x32_bf16 v[40:43], v[136:139], a[52:55], v[40:43]
    ds_read_b64_tr_b16 v[164:165], v201 offset:61440
    ds_read_b64_tr_b16 v[166:167], v201 offset:61952
    v_mfma_f32_16x16x32_bf16 v[48:51], v[136:139], a[56:59], v[48:51]
    ds_read_b128 a[92:95], v177 offset:24576
    v_mfma_f32_16x16x32_bf16 v[56:59], v[136:139], a[60:63], v[56:59]
    v_mfma_f32_16x16x32_bf16 v[36:39], v[140:143], a[48:51], v[36:39]
    v_mfma_f32_16x16x32_bf16 v[44:47], v[140:143], a[52:55], v[44:47]
    ds_read_b64_tr_b16 v[168:169], v202 offset:61440
    ds_read_b64_tr_b16 v[170:171], v202 offset:61952
    v_mfma_f32_16x16x32_bf16 v[52:55], v[140:143], a[56:59], v[52:55]
    v_mfma_f32_16x16x32_bf16 v[60:63], v[140:143], a[60:63], v[60:63]
    s_waitcnt lgkmcnt(15)
    v_mfma_f32_16x16x32_bf16 v[64:67], v[144:147], a[48:51], v[64:67]
    v_mfma_f32_16x16x32_bf16 v[72:75], v[144:147], a[52:55], v[72:75]
    ds_read_b64_tr_b16 v[172:173], v203 offset:61440
    ds_read_b64_tr_b16 v[174:175], v203 offset:61952
    v_mfma_f32_16x16x32_bf16 v[80:83], v[144:147], a[56:59], v[80:83]
    v_mfma_f32_16x16x32_bf16 v[88:91], v[144:147], a[60:63], v[88:91]
    s_waitcnt vmcnt(25)
    s_barrier
    v_mfma_f32_16x16x32_bf16 v[68:71], v[148:151], a[48:51], v[68:71]
    ds_read_b64_tr_b16 v[212:213], v209 offset:0
    ds_read_b64_tr_b16 v[214:215], v209 offset:1024
    v_mfma_f32_16x16x32_bf16 v[76:79], v[148:151], a[52:55], v[76:79]
    ds_read_b64_tr_b16 v[128:129], v196 offset:0
    ds_read_b64_tr_b16 v[130:131], v196 offset:1024
    v_mfma_f32_16x16x32_bf16 v[84:87], v[148:151], a[56:59], v[84:87]
    ds_read_b64_tr_b16 v[216:217], v209 offset:8
    ds_read_b64_tr_b16 v[218:219], v209 offset:1032
    v_mfma_f32_16x16x32_bf16 v[92:95], v[148:151], a[60:63], v[92:95]
    ds_read_b64_tr_b16 v[220:221], v210 offset:0
    ds_read_b64_tr_b16 v[222:223], v210 offset:512
    v_mfma_f32_16x16x32_bf16 v[96:99], v[152:155], a[48:51], v[96:99]
    s_waitcnt lgkmcnt(12)
    s_add_u32 m0, s45, 0x0
    s_mov_b32 s51, 0x0
    buffer_load_dwordx4 v192, s[8:11], s51 offen lds
    v_mfma_f32_16x16x32_bf16 v[104:107], v[152:155], a[52:55], v[104:107]
    ds_read_b64_tr_b16 v[132:133], v196 offset:8
    ds_read_b64_tr_b16 v[134:135], v196 offset:1032
    v_mfma_f32_16x16x32_bf16 v[112:115], v[152:155], a[56:59], v[112:115]
    v_mfma_f32_16x16x32_bf16 v[120:123], v[152:155], a[60:63], v[120:123]
    buffer_load_dwordx4 v193, s[8:11], s51 offen offset:1024 lds
    v_mfma_f32_16x16x32_bf16 v[100:103], v[156:159], a[48:51], v[100:103]
    v_mfma_f32_16x16x32_bf16 v[108:111], v[156:159], a[52:55], v[108:111]
    ds_read_b64_tr_b16 v[136:137], v197 offset:0
    ds_read_b64_tr_b16 v[138:139], v197 offset:1024
    v_mfma_f32_16x16x32_bf16 v[116:119], v[156:159], a[56:59], v[116:119]
    v_mfma_f32_16x16x32_bf16 v[124:127], v[156:159], a[60:63], v[124:127]
    s_add_u32 m0, s45, 0x2000
    s_mov_b32 s51, 0x2000
    buffer_load_dwordx4 v192, s[8:11], s51 offen lds
    v_mfma_f32_16x16x32_bf16 a[192:195], v[160:163], a[48:51], a[192:195]
    v_mfma_f32_16x16x32_bf16 a[196:199], v[160:163], a[52:55], a[196:199]
    ds_read_b64_tr_b16 v[140:141], v197 offset:8
    ds_read_b64_tr_b16 v[142:143], v197 offset:1032
    v_mfma_f32_16x16x32_bf16 a[200:203], v[160:163], a[56:59], a[200:203]
    buffer_load_dwordx4 v193, s[8:11], s51 offen offset:1024 lds
    v_mfma_f32_16x16x32_bf16 a[204:207], v[160:163], a[60:63], a[204:207]
    v_mfma_f32_16x16x32_bf16 a[208:211], v[164:167], a[48:51], a[208:211]
    v_mfma_f32_16x16x32_bf16 a[212:215], v[164:167], a[52:55], a[212:215]
    ds_read_b64_tr_b16 v[144:145], v198 offset:0
    ds_read_b64_tr_b16 v[146:147], v198 offset:1024
    v_mfma_f32_16x16x32_bf16 a[216:219], v[164:167], a[56:59], a[216:219]
    s_add_u32 m0, s45, 0x4000
    s_mov_b32 s51, 0x4000
    buffer_load_dwordx4 v192, s[8:11], s51 offen lds
    v_mfma_f32_16x16x32_bf16 a[220:223], v[164:167], a[60:63], a[220:223]
    s_waitcnt lgkmcnt(15)
    s_waitcnt lgkmcnt(8)
    v_mfma_f32_16x16x32_bf16 a[128:131], v[212:215], a[140:143], a[128:131]
    v_mfma_f32_16x16x32_bf16 a[132:135], v[216:219], a[140:143], a[132:135]
    buffer_load_dwordx4 v193, s[8:11], s51 offen offset:1024 lds
    v_mfma_f32_16x16x32_bf16 a[136:139], v[220:223], a[140:143], a[136:139]
    v_mfma_f32_16x16x32_bf16 a[224:227], v[168:171], a[48:51], a[224:227]
    s_add_u32 m0, s45, 0x6000
    s_mov_b32 s51, 0x6000
    buffer_load_dwordx4 v192, s[8:11], s51 offen lds
    v_mfma_f32_16x16x32_bf16 a[228:231], v[168:171], a[52:55], a[228:231]
    ds_read_b64_tr_b16 v[148:149], v198 offset:8
    ds_read_b64_tr_b16 v[150:151], v198 offset:1032
    v_mfma_f32_16x16x32_bf16 a[232:235], v[168:171], a[56:59], a[232:235]
    v_mfma_f32_16x16x32_bf16 a[236:239], v[168:171], a[60:63], a[236:239]
    v_mfma_f32_16x16x32_bf16 a[240:243], v[172:175], a[48:51], a[240:243]
    buffer_load_dwordx4 v193, s[8:11], s51 offen offset:1024 lds
    v_mfma_f32_16x16x32_bf16 a[244:247], v[172:175], a[52:55], a[244:247]
    ds_read_b64_tr_b16 v[152:153], v199 offset:0
    ds_read_b64_tr_b16 v[154:155], v199 offset:1024
    v_mfma_f32_16x16x32_bf16 a[248:251], v[172:175], a[56:59], a[248:251]
    v_mfma_f32_16x16x32_bf16 a[252:255], v[172:175], a[60:63], a[252:255]
    v_mfma_f32_16x16x32_bf16 v[0:3], v[128:131], a[64:67], v[0:3]
    v_mfma_f32_16x16x32_bf16 v[8:11], v[128:131], a[68:71], v[8:11]
    ds_read_b64_tr_b16 v[156:157], v199 offset:8
    ds_read_b64_tr_b16 v[158:159], v199 offset:1032
    v_mfma_f32_16x16x32_bf16 v[16:19], v[128:131], a[72:75], v[16:19]
    v_mfma_f32_16x16x32_bf16 v[24:27], v[128:131], a[76:79], v[24:27]
    s_waitcnt lgkmcnt(12)
    v_mfma_f32_16x16x32_bf16 v[4:7], v[132:135], a[64:67], v[4:7]
    v_mfma_f32_16x16x32_bf16 v[12:15], v[132:135], a[68:71], v[12:15]
    ds_read_b64_tr_b16 v[160:161], v200 offset:0
    ds_read_b64_tr_b16 v[162:163], v200 offset:512
    v_mfma_f32_16x16x32_bf16 v[20:23], v[132:135], a[72:75], v[20:23]
    v_mfma_f32_16x16x32_bf16 v[28:31], v[132:135], a[76:79], v[28:31]
    s_waitcnt lgkmcnt(12)
    v_mfma_f32_16x16x32_bf16 v[32:35], v[136:139], a[64:67], v[32:35]
    v_mfma_f32_16x16x32_bf16 v[40:43], v[136:139], a[68:71], v[40:43]
    ds_read_b64_tr_b16 v[164:165], v201 offset:0
    ds_read_b64_tr_b16 v[166:167], v201 offset:512
    v_mfma_f32_16x16x32_bf16 v[48:51], v[136:139], a[72:75], v[48:51]
    v_mfma_f32_16x16x32_bf16 v[56:59], v[136:139], a[76:79], v[56:59]
    s_waitcnt lgkmcnt(12)
    v_mfma_f32_16x16x32_bf16 v[36:39], v[140:143], a[64:67], v[36:39]
    v_mfma_f32_16x16x32_bf16 v[44:47], v[140:143], a[68:71], v[44:47]
    ds_read_b64_tr_b16 v[168:169], v202 offset:0
    ds_read_b64_tr_b16 v[170:171], v202 offset:512
    v_mfma_f32_16x16x32_bf16 v[52:55], v[140:143], a[72:75], v[52:55]
    v_mfma_f32_16x16x32_bf16 v[60:63], v[140:143], a[76:79], v[60:63]
    s_waitcnt lgkmcnt(12)
    v_mfma_f32_16x16x32_bf16 v[64:67], v[144:147], a[64:67], v[64:67]
    v_mfma_f32_16x16x32_bf16 v[72:75], v[144:147], a[68:71], v[72:75]
    ds_read_b64_tr_b16 v[172:173], v203 offset:0
    ds_read_b64_tr_b16 v[174:175], v203 offset:512
    v_mfma_f32_16x16x32_bf16 v[80:83], v[144:147], a[72:75], v[80:83]
    v_mfma_f32_16x16x32_bf16 v[88:91], v[144:147], a[76:79], v[88:91]
    s_waitcnt lgkmcnt(12)
    s_waitcnt vmcnt(30)
    s_barrier
    v_mfma_f32_16x16x32_bf16 v[68:71], v[148:151], a[64:67], v[68:71]
    ds_read_b64_tr_b16 v[212:213], v209 offset:12288
    ds_read_b64_tr_b16 v[214:215], v209 offset:13312
    v_mfma_f32_16x16x32_bf16 v[76:79], v[148:151], a[68:71], v[76:79]
    ds_read_b64_tr_b16 v[128:129], v196 offset:12288
    ds_read_b64_tr_b16 v[130:131], v196 offset:13312
    v_mfma_f32_16x16x32_bf16 v[84:87], v[148:151], a[72:75], v[84:87]
    ds_read_b64_tr_b16 v[216:217], v209 offset:12296
    ds_read_b64_tr_b16 v[218:219], v209 offset:13320
    v_mfma_f32_16x16x32_bf16 v[92:95], v[148:151], a[76:79], v[92:95]
    s_waitcnt lgkmcnt(15)
    ds_read_b64_tr_b16 v[220:221], v210 offset:12288
    ds_read_b64_tr_b16 v[222:223], v210 offset:12800
    v_mfma_f32_16x16x32_bf16 v[96:99], v[152:155], a[64:67], v[96:99]
    v_mfma_f32_16x16x32_bf16 v[104:107], v[152:155], a[68:71], v[104:107]
    ds_read_b64_tr_b16 v[132:133], v196 offset:12296
    ds_read_b64_tr_b16 v[134:135], v196 offset:13320
    v_mfma_f32_16x16x32_bf16 v[112:115], v[152:155], a[72:75], v[112:115]
    v_mfma_f32_16x16x32_bf16 v[120:123], v[152:155], a[76:79], v[120:123]
    s_waitcnt lgkmcnt(15)
    v_mfma_f32_16x16x32_bf16 v[100:103], v[156:159], a[64:67], v[100:103]
    v_mfma_f32_16x16x32_bf16 v[108:111], v[156:159], a[68:71], v[108:111]
    ds_read_b64_tr_b16 v[136:137], v197 offset:12288
    ds_read_b64_tr_b16 v[138:139], v197 offset:13312
    v_mfma_f32_16x16x32_bf16 v[116:119], v[156:159], a[72:75], v[116:119]
    v_mfma_f32_16x16x32_bf16 v[124:127], v[156:159], a[76:79], v[124:127]
    v_mfma_f32_16x16x32_bf16 a[192:195], v[160:163], a[64:67], a[192:195]
    v_mfma_f32_16x16x32_bf16 a[196:199], v[160:163], a[68:71], a[196:199]
    ds_read_b64_tr_b16 v[140:141], v197 offset:12296
    ds_read_b64_tr_b16 v[142:143], v197 offset:13320
    v_mfma_f32_16x16x32_bf16 a[200:203], v[160:163], a[72:75], a[200:203]
    v_mfma_f32_16x16x32_bf16 a[204:207], v[160:163], a[76:79], a[204:207]
    s_waitcnt lgkmcnt(15)
    v_mfma_f32_16x16x32_bf16 a[208:211], v[164:167], a[64:67], a[208:211]
    v_mfma_f32_16x16x32_bf16 a[212:215], v[164:167], a[68:71], a[212:215]
    ds_read_b64_tr_b16 v[144:145], v198 offset:12288
    ds_read_b64_tr_b16 v[146:147], v198 offset:13312
    v_mfma_f32_16x16x32_bf16 a[216:219], v[164:167], a[72:75], a[216:219]
    v_mfma_f32_16x16x32_bf16 a[220:223], v[164:167], a[76:79], a[220:223]
    s_waitcnt lgkmcnt(8)
    v_mfma_f32_16x16x32_bf16 a[128:131], v[212:215], a[140:143], a[128:131]
    v_mfma_f32_16x16x32_bf16 a[132:135], v[216:219], a[140:143], a[132:135]
    v_mfma_f32_16x16x32_bf16 a[136:139], v[220:223], a[140:143], a[136:139]
    v_mfma_f32_16x16x32_bf16 a[224:227], v[168:171], a[64:67], a[224:227]
    v_mfma_f32_16x16x32_bf16 a[228:231], v[168:171], a[68:71], a[228:231]
    ds_read_b64_tr_b16 v[148:149], v198 offset:12296
    ds_read_b64_tr_b16 v[150:151], v198 offset:13320
    v_mfma_f32_16x16x32_bf16 a[232:235], v[168:171], a[72:75], a[232:235]
    v_mfma_f32_16x16x32_bf16 a[236:239], v[168:171], a[76:79], a[236:239]
    v_mfma_f32_16x16x32_bf16 a[240:243], v[172:175], a[64:67], a[240:243]
    v_mfma_f32_16x16x32_bf16 a[244:247], v[172:175], a[68:71], a[244:247]
    ds_read_b64_tr_b16 v[152:153], v199 offset:12288
    ds_read_b64_tr_b16 v[154:155], v199 offset:13312
    v_mfma_f32_16x16x32_bf16 a[248:251], v[172:175], a[72:75], a[248:251]
    v_mfma_f32_16x16x32_bf16 a[252:255], v[172:175], a[76:79], a[252:255]
    v_mfma_f32_16x16x32_bf16 v[0:3], v[128:131], a[80:83], v[0:3]
    s_waitcnt vmcnt(20)
    ds_read_b128 a[96:99], v176 offset:32768
    v_mfma_f32_16x16x32_bf16 v[8:11], v[128:131], a[84:87], v[8:11]
    ds_read_b64_tr_b16 v[156:157], v199 offset:12296
    ds_read_b64_tr_b16 v[158:159], v199 offset:13320
    v_mfma_f32_16x16x32_bf16 v[16:19], v[128:131], a[88:91], v[16:19]
    ds_read_b128 a[100:103], v176 offset:40960
    v_mfma_f32_16x16x32_bf16 v[24:27], v[128:131], a[92:95], v[24:27]
    s_waitcnt lgkmcnt(14)
    ds_read_b128 a[104:107], v176 offset:49152
    v_mfma_f32_16x16x32_bf16 v[4:7], v[132:135], a[80:83], v[4:7]
    ds_read_b128 a[108:111], v176 offset:57344
    v_mfma_f32_16x16x32_bf16 v[12:15], v[132:135], a[84:87], v[12:15]
    ds_read_b64_tr_b16 v[160:161], v200 offset:12288
    ds_read_b64_tr_b16 v[162:163], v200 offset:12800
    v_mfma_f32_16x16x32_bf16 v[20:23], v[132:135], a[88:91], v[20:23]
    ds_read_b128 a[112:115], v177 offset:32768
    v_mfma_f32_16x16x32_bf16 v[28:31], v[132:135], a[92:95], v[28:31]
    s_waitcnt lgkmcnt(15)
    ds_read_b128 a[116:119], v177 offset:40960
    v_mfma_f32_16x16x32_bf16 v[32:35], v[136:139], a[80:83], v[32:35]
    ds_read_b128 a[120:123], v177 offset:49152
    v_mfma_f32_16x16x32_bf16 v[40:43], v[136:139], a[84:87], v[40:43]
    ds_read_b64_tr_b16 v[164:165], v201 offset:12288
    ds_read_b64_tr_b16 v[166:167], v201 offset:12800
    v_mfma_f32_16x16x32_bf16 v[48:51], v[136:139], a[88:91], v[48:51]
    ds_read_b128 a[124:127], v177 offset:57344
    v_mfma_f32_16x16x32_bf16 v[56:59], v[136:139], a[92:95], v[56:59]
    v_mfma_f32_16x16x32_bf16 v[36:39], v[140:143], a[80:83], v[36:39]
    v_mfma_f32_16x16x32_bf16 v[44:47], v[140:143], a[84:87], v[44:47]
    ds_read_b64_tr_b16 v[168:169], v202 offset:12288
    ds_read_b64_tr_b16 v[170:171], v202 offset:12800
    v_mfma_f32_16x16x32_bf16 v[52:55], v[140:143], a[88:91], v[52:55]
    v_mfma_f32_16x16x32_bf16 v[60:63], v[140:143], a[92:95], v[60:63]
    s_waitcnt lgkmcnt(15)
    v_mfma_f32_16x16x32_bf16 v[64:67], v[144:147], a[80:83], v[64:67]
    v_mfma_f32_16x16x32_bf16 v[72:75], v[144:147], a[84:87], v[72:75]
    ds_read_b64_tr_b16 v[172:173], v203 offset:12288
    ds_read_b64_tr_b16 v[174:175], v203 offset:12800
    v_mfma_f32_16x16x32_bf16 v[80:83], v[144:147], a[88:91], v[80:83]
    v_mfma_f32_16x16x32_bf16 v[88:91], v[144:147], a[92:95], v[88:91]
    s_waitcnt vmcnt(17)
    s_barrier
    v_mfma_f32_16x16x32_bf16 v[68:71], v[148:151], a[80:83], v[68:71]
    ds_read_b64_tr_b16 v[212:213], v209 offset:24576
    ds_read_b64_tr_b16 v[214:215], v209 offset:25600
    v_mfma_f32_16x16x32_bf16 v[76:79], v[148:151], a[84:87], v[76:79]
    ds_read_b64_tr_b16 v[128:129], v196 offset:24576
    ds_read_b64_tr_b16 v[130:131], v196 offset:25600
    v_mfma_f32_16x16x32_bf16 v[84:87], v[148:151], a[88:91], v[84:87]
    ds_read_b64_tr_b16 v[216:217], v209 offset:24584
    ds_read_b64_tr_b16 v[218:219], v209 offset:25608
    v_mfma_f32_16x16x32_bf16 v[92:95], v[148:151], a[92:95], v[92:95]
    ds_read_b64_tr_b16 v[220:221], v210 offset:24576
    ds_read_b64_tr_b16 v[222:223], v210 offset:25088
    v_mfma_f32_16x16x32_bf16 v[96:99], v[152:155], a[80:83], v[96:99]
    s_add_u32 m0, s45, 0x16000
    s_mov_b32 s51, 0x6000
    buffer_load_dwordx4 v194, s[12:15], s51 offen lds
    v_mfma_f32_16x16x32_bf16 v[104:107], v[152:155], a[84:87], v[104:107]
    ds_read_b64_tr_b16 v[132:133], v196 offset:24584
    ds_read_b64_tr_b16 v[134:135], v196 offset:25608
    v_mfma_f32_16x16x32_bf16 v[112:115], v[152:155], a[88:91], v[112:115]
    v_mfma_f32_16x16x32_bf16 v[120:123], v[152:155], a[92:95], v[120:123]
    s_waitcnt lgkmcnt(15)
    buffer_load_dwordx4 v195, s[12:15], s51 offen offset:1024 lds
    v_mfma_f32_16x16x32_bf16 v[100:103], v[156:159], a[80:83], v[100:103]
    v_mfma_f32_16x16x32_bf16 v[108:111], v[156:159], a[84:87], v[108:111]
    ds_read_b64_tr_b16 v[136:137], v197 offset:24576
    ds_read_b64_tr_b16 v[138:139], v197 offset:25600
    v_mfma_f32_16x16x32_bf16 v[116:119], v[156:159], a[88:91], v[116:119]
    s_waitcnt lgkmcnt(15)
    s_add_u32 m0, s45, 0x8000
    s_mov_b32 s51, 0x8000
    buffer_load_dwordx4 v192, s[8:11], s51 offen lds
    v_mfma_f32_16x16x32_bf16 v[124:127], v[156:159], a[92:95], v[124:127]
    v_mfma_f32_16x16x32_bf16 a[192:195], v[160:163], a[80:83], a[192:195]
    buffer_load_dwordx4 v193, s[8:11], s51 offen offset:1024 lds
    v_mfma_f32_16x16x32_bf16 a[196:199], v[160:163], a[84:87], a[196:199]
    ds_read_b64_tr_b16 v[140:141], v197 offset:24584
    ds_read_b64_tr_b16 v[142:143], v197 offset:25608
    v_mfma_f32_16x16x32_bf16 a[200:203], v[160:163], a[88:91], a[200:203]
    v_mfma_f32_16x16x32_bf16 a[204:207], v[160:163], a[92:95], a[204:207]
    s_add_u32 m0, s45, 0xa000
    s_mov_b32 s51, 0xa000
    buffer_load_dwordx4 v192, s[8:11], s51 offen lds
    v_mfma_f32_16x16x32_bf16 a[208:211], v[164:167], a[80:83], a[208:211]
    v_mfma_f32_16x16x32_bf16 a[212:215], v[164:167], a[84:87], a[212:215]
    ds_read_b64_tr_b16 v[144:145], v198 offset:24576
    ds_read_b64_tr_b16 v[146:147], v198 offset:25600
    v_mfma_f32_16x16x32_bf16 a[216:219], v[164:167], a[88:91], a[216:219]
    buffer_load_dwordx4 v193, s[8:11], s51 offen offset:1024 lds
    v_mfma_f32_16x16x32_bf16 a[220:223], v[164:167], a[92:95], a[220:223]
    s_waitcnt lgkmcnt(15)
    s_waitcnt lgkmcnt(8)
    v_mfma_f32_16x16x32_bf16 a[128:131], v[212:215], a[140:143], a[128:131]
    s_add_u32 m0, s45, 0xc000
    s_mov_b32 s51, 0xc000
    buffer_load_dwordx4 v192, s[8:11], s51 offen lds
    v_mfma_f32_16x16x32_bf16 a[132:135], v[216:219], a[140:143], a[132:135]
    v_mfma_f32_16x16x32_bf16 a[136:139], v[220:223], a[140:143], a[136:139]
    buffer_load_dwordx4 v193, s[8:11], s51 offen offset:1024 lds
    v_mfma_f32_16x16x32_bf16 a[224:227], v[168:171], a[80:83], a[224:227]
    v_mfma_f32_16x16x32_bf16 a[228:231], v[168:171], a[84:87], a[228:231]
    ds_read_b64_tr_b16 v[148:149], v198 offset:24584
    ds_read_b64_tr_b16 v[150:151], v198 offset:25608
    v_mfma_f32_16x16x32_bf16 a[232:235], v[168:171], a[88:91], a[232:235]
    s_add_u32 m0, s45, 0xe000
    s_mov_b32 s51, 0xe000
    buffer_load_dwordx4 v192, s[8:11], s51 offen lds
    v_mfma_f32_16x16x32_bf16 a[236:239], v[168:171], a[92:95], a[236:239]
    v_mfma_f32_16x16x32_bf16 a[240:243], v[172:175], a[80:83], a[240:243]
    buffer_load_dwordx4 v193, s[8:11], s51 offen offset:1024 lds
    v_mfma_f32_16x16x32_bf16 a[244:247], v[172:175], a[84:87], a[244:247]
    ds_read_b64_tr_b16 v[152:153], v199 offset:24576
    ds_read_b64_tr_b16 v[154:155], v199 offset:25600
    v_mfma_f32_16x16x32_bf16 a[248:251], v[172:175], a[88:91], a[248:251]
    v_mfma_f32_16x16x32_bf16 a[252:255], v[172:175], a[92:95], a[252:255]
    v_mfma_f32_16x16x32_bf16 v[0:3], v[128:131], a[96:99], v[0:3]
    s_waitcnt vmcnt(23)
    v_cmp_eq_u32 vcc, s72, v229
    v_mfma_f32_16x16x32_bf16 v[8:11], v[128:131], a[100:103], v[8:11]
    ds_read_b64_tr_b16 v[156:157], v199 offset:24584
    ds_read_b64_tr_b16 v[158:159], v199 offset:25608
    v_mfma_f32_16x16x32_bf16 v[16:19], v[128:131], a[104:107], v[16:19]
    v_cmp_eq_u32 s[88:89], s72, v231
    v_cmp_eq_u32 s[90:91], s72, v233
    v_mfma_f32_16x16x32_bf16 v[24:27], v[128:131], a[108:111], v[24:27]
    s_waitcnt lgkmcnt(12)
    v_cmp_eq_u32 s[92:93], s72, v235
    s_and_b64 vcc, vcc, s[88:89]
    s_nop 2
    s_and_b64 s[90:91], s[90:91], s[92:93]
    s_and_b64 vcc, vcc, s[90:91]
    s_cmp_eq_u64 vcc, -1
    s_cbranch_scc0 L2_dost
L2_retst:
    v_mfma_f32_16x16x32_bf16 v[4:7], v[132:135], a[96:99], v[4:7]
    v_and_b32 v229, 0xffff0000, v228
    v_lshlrev_b32 v228, 16, v228
    v_mfma_f32_16x16x32_bf16 v[12:15], v[132:135], a[100:103], v[12:15]
    ds_read_b64_tr_b16 v[160:161], v200 offset:24576
    ds_read_b64_tr_b16 v[162:163], v200 offset:25088
    v_mfma_f32_16x16x32_bf16 v[20:23], v[132:135], a[104:107], v[20:23]
    v_and_b32 v231, 0xffff0000, v230
    v_lshlrev_b32 v230, 16, v230
    v_mfma_f32_16x16x32_bf16 v[28:31], v[132:135], a[108:111], v[28:31]
    s_waitcnt lgkmcnt(12)
    v_and_b32 v233, 0xffff0000, v232
    v_lshlrev_b32 v232, 16, v232
    v_mfma_f32_16x16x32_bf16 v[32:35], v[136:139], a[96:99], v[32:35]
    v_and_b32 v235, 0xffff0000, v234
    v_lshlrev_b32 v234, 16, v234
    v_mfma_f32_16x16x32_bf16 v[40:43], v[136:139], a[100:103], v[40:43]
    ds_read_b64_tr_b16 v[164:165], v201 offset:24576
    ds_read_b64_tr_b16 v[166:167], v201 offset:25088
    v_mfma_f32_16x16x32_bf16 v[48:51], v[136:139], a[104:107], v[48:51]
    v_rcp_f32 v237, v229
    v_mfma_f32_16x16x32_bf16 v[56:59], v[136:139], a[108:111], v[56:59]
    s_waitcnt lgkmcnt(12)
    v_rcp_f32 v239, v231
    v_mfma_f32_16x16x32_bf16 v[36:39], v[140:143], a[96:99], v[36:39]
L_it4:
    s_cbranch_execz L_it8
    v_rcp_f32 v241, v233
    v_mfma_f32_16x16x32_bf16 v[44:47], v[140:143], a[100:103], v[44:47]
    ds_read_b64_tr_b16 v[168:169], v202 offset:24576
    ds_read_b64_tr_b16 v[170:171], v202 offset:25088
    v_mfma_f32_16x16x32_bf16 v[52:55], v[140:143], a[104:107], v[52:55]
    v_rcp_f32 v243, v235
    v_mfma_f32_16x16x32_bf16 v[60:63], v[140:143], a[108:111], v[60:63]
    s_waitcnt lgkmcnt(12)
    v_mul_f32 v236, 0x3e0293ee, v237
    v_mul_f32 v238, 0x3e0293ee, v239
    v_mfma_f32_16x16x32_bf16 v[64:67], v[144:147], a[96:99], v[64:67]
    v_mul_f32 v240, 0x3e0293ee, v241
    v_mul_f32 v242, 0x3e0293ee, v243
    v_mfma_f32_16x16x32_bf16 v[72:75], v[144:147], a[100:103], v[72:75]
    ds_read_b64_tr_b16 v[172:173], v203 offset:24576
    ds_read_b64_tr_b16 v[174:175], v203 offset:25088
    v_mfma_f32_16x16x32_bf16 v[80:83], v[144:147], a[104:107], v[80:83]
    v_mul_f32 v237, 0xbfb8aa3b, v237
    v_mul_f32 v239, 0xbfb8aa3b, v239
    v_mfma_f32_16x16x32_bf16 v[88:91], v[144:147], a[108:111], v[88:91]
    s_waitcnt lgkmcnt(12)
    s_waitcnt vmcnt(20)
    s_barrier
    v_mfma_f32_16x16x32_bf16 v[68:71], v[148:151], a[96:99], v[68:71]
    ds_read_b64_tr_b16 v[212:213], v209 offset:36864
    ds_read_b64_tr_b16 v[214:215], v209 offset:37888
    v_mfma_f32_16x16x32_bf16 v[76:79], v[148:151], a[100:103], v[76:79]
    ds_read_b64_tr_b16 v[128:129], v196 offset:36864
    ds_read_b64_tr_b16 v[130:131], v196 offset:37888
    v_mfma_f32_16x16x32_bf16 v[84:87], v[148:151], a[104:107], v[84:87]
    ds_read_b64_tr_b16 v[216:217], v209 offset:36872
    ds_read_b64_tr_b16 v[218:219], v209 offset:37896
    v_mfma_f32_16x16x32_bf16 v[92:95], v[148:151], a[108:111], v[92:95]
    s_waitcnt lgkmcnt(15)
    ds_read_b64_tr_b16 v[220:221], v210 offset:36864
    ds_read_b64_tr_b16 v[222:223], v210 offset:37376
    v_mfma_f32_16x16x32_bf16 v[96:99], v[152:155], a[96:99], v[96:99]
    v_mul_f32 v241, 0xbfb8aa3b, v241
    v_mul_f32 v243, 0xbfb8aa3b, v243
    v_mfma_f32_16x16x32_bf16 v[104:107], v[152:155], a[100:103], v[104:107]
    ds_read_b64_tr_b16 v[132:133], v196 offset:36872
    ds_read_b64_tr_b16 v[134:135], v196 offset:37896
    v_mfma_f32_16x16x32_bf16 v[112:115], v[152:155], a[104:107], v[112:115]
    v_mfma_f32_16x16x32_bf16 v[120:123], v[152:155], a[108:111], v[120:123]
    s_waitcnt lgkmcnt(15)
    v_mfma_f32_16x16x32_bf16 v[100:103], v[156:159], a[96:99], v[100:103]
    v_mfma_f32_16x16x32_bf16 v[108:111], v[156:159], a[100:103], v[108:111]
    ds_read_b64_tr_b16 v[136:137], v197 offset:36864
    ds_read_b64_tr_b16 v[138:139], v197 offset:37888
    v_mfma_f32_16x16x32_bf16 v[116:119], v[156:159], a[104:107], v[116:119]
    v_mfma_f32_16x16x32_bf16 v[124:127], v[156:159], a[108:111], v[124:127]
    v_mfma_f32_16x16x32_bf16 a[192:195], v[160:163], a[96:99], a[192:195]
    v_mfma_f32_16x16x32_bf16 a[196:199], v[160:163], a[100:103], a[196:199]
    ds_read_b64_tr_b16 v[140:141], v197 offset:36872
    ds_read_b64_tr_b16 v[142:143], v197 offset:37896
    v_mfma_f32_16x16x32_bf16 a[200:203], v[160:163], a[104:107], a[200:203]
    v_mfma_f32_16x16x32_bf16 a[204:207], v[160:163], a[108:111], a[204:207]
    s_waitcnt lgkmcnt(15)
    v_mfma_f32_16x16x32_bf16 a[208:211], v[164:167], a[96:99], a[208:211]
    v_mfma_f32_16x16x32_bf16 a[212:215], v[164:167], a[100:103], a[212:215]
    ds_read_b64_tr_b16 v[144:145], v198 offset:36864
    ds_read_b64_tr_b16 v[146:147], v198 offset:37888
    v_mfma_f32_16x16x32_bf16 a[216:219], v[164:167], a[104:107], a[216:219]
    v_mfma_f32_16x16x32_bf16 a[220:223], v[164:167], a[108:111], a[220:223]
    s_waitcnt lgkmcnt(8)
    v_mfma_f32_16x16x32_bf16 a[128:131], v[212:215], a[140:143], a[128:131]
    v_mfma_f32_16x16x32_bf16 a[132:135], v[216:219], a[140:143], a[132:135]
    v_mfma_f32_16x16x32_bf16 a[136:139], v[220:223], a[140:143], a[136:139]
    v_mfma_f32_16x16x32_bf16 a[224:227], v[168:171], a[96:99], a[224:227]
    v_mfma_f32_16x16x32_bf16 a[228:231], v[168:171], a[100:103], a[228:231]
    ds_read_b64_tr_b16 v[148:149], v198 offset:36872
    ds_read_b64_tr_b16 v[150:151], v198 offset:37896
    v_mfma_f32_16x16x32_bf16 a[232:235], v[168:171], a[104:107], a[232:235]
    v_mfma_f32_16x16x32_bf16 a[236:239], v[168:171], a[108:111], a[236:239]
    v_mfma_f32_16x16x32_bf16 a[240:243], v[172:175], a[96:99], a[240:243]
    v_mfma_f32_16x16x32_bf16 a[244:247], v[172:175], a[100:103], a[244:247]
    ds_read_b64_tr_b16 v[152:153], v199 offset:36864
    ds_read_b64_tr_b16 v[154:155], v199 offset:37888
    v_mfma_f32_16x16x32_bf16 a[248:251], v[172:175], a[104:107], a[248:251]
    v_mfma_f32_16x16x32_bf16 a[252:255], v[172:175], a[108:111], a[252:255]
    v_lshrrev_b32 v212, 8, v211
    s_mul_i32 s3, s44, 192
    s_add_u32 s3, s3, 0x27c00
    v_lshl_add_u32 v212, v212, 4, s3
    ds_write_b128 v212, a[128:131] offset:0
    ds_write_b128 v212, a[132:135] offset:64
    ds_write_b128 v212, a[136:139] offset:128
    v_mfma_f32_16x16x32_bf16 v[0:3], v[128:131], a[112:115], v[0:3]
    v_mfma_f32_16x16x32_bf16 v[8:11], v[128:131], a[116:119], v[8:11]
    ds_read_b64_tr_b16 v[156:157], v199 offset:36872
    ds_read_b64_tr_b16 v[158:159], v199 offset:37896
    v_mfma_f32_16x16x32_bf16 v[16:19], v[128:131], a[120:123], v[16:19]
    v_mfma_f32_16x16x32_bf16 v[24:27], v[128:131], a[124:127], v[24:27]
    s_waitcnt lgkmcnt(15)
    s_waitcnt lgkmcnt(2)
    s_barrier
    v_lshrrev_b32 v209, 8, v211
    v_lshlrev_b32 v209, 4, v209
    v_add_u32 v209, 0x27c00, v209
    ds_read_b128 v[212:215], v209 offset:0
    ds_read_b128 v[216:219], v209 offset:64
    ds_read_b128 v[220:223], v209 offset:192
    ds_read_b128 v[224:227], v209 offset:256
    v_mfma_f32_16x16x32_bf16 v[4:7], v[132:135], a[112:115], v[4:7]
    s_add_u32 m0, s45, 0x18000
    s_mov_b32 s51, 0x8000
    buffer_load_dwordx4 v194, s[12:15], s51 offen lds
    v_mfma_f32_16x16x32_bf16 v[12:15], v[132:135], a[116:119], v[12:15]
    ds_read_b64_tr_b16 v[160:161], v200 offset:36864
    ds_read_b64_tr_b16 v[162:163], v200 offset:37376
    v_mfma_f32_16x16x32_bf16 v[20:23], v[132:135], a[120:123], v[20:23]
    v_mfma_f32_16x16x32_bf16 v[28:31], v[132:135], a[124:127], v[28:31]
    v_mfma_f32_16x16x32_bf16 v[32:35], v[136:139], a[112:115], v[32:35]
    v_mfma_f32_16x16x32_bf16 v[40:43], v[136:139], a[116:119], v[40:43]
    ds_read_b64_tr_b16 v[164:165], v201 offset:36864
    ds_read_b64_tr_b16 v[166:167], v201 offset:37376
    s_waitcnt lgkmcnt(6)
    v_fma_f32 v0, v212, -v228, v0
    v_fma_f32 v1, v213, -v228, v1
    v_mfma_f32_16x16x32_bf16 v[48:51], v[136:139], a[120:123], v[48:51]
    v_fma_f32 v2, v214, -v228, v2
    v_fma_f32 v3, v215, -v228, v3
    v_mfma_f32_16x16x32_bf16 v[56:59], v[136:139], a[124:127], v[56:59]
    v_fma_f32 v4, v216, -v228, v4
    v_fma_f32 v5, v217, -v228, v5
    v_mfma_f32_16x16x32_bf16 v[36:39], v[140:143], a[112:115], v[36:39]
    buffer_load_dwordx4 v195, s[12:15], s51 offen offset:1024 lds
    v_mfma_f32_16x16x32_bf16 v[44:47], v[140:143], a[116:119], v[44:47]
    ds_read_b64_tr_b16 v[168:169], v202 offset:36864
    ds_read_b64_tr_b16 v[170:171], v202 offset:37376
    v_fma_f32 v6, v218, -v228, v6
    v_fma_f32 v7, v219, -v228, v7
    v_mfma_f32_16x16x32_bf16 v[52:55], v[140:143], a[120:123], v[52:55]
    v_mul_f32 v0, v0, v236
    v_mul_f32 v1, v1, v236
    v_mfma_f32_16x16x32_bf16 v[60:63], v[140:143], a[124:127], v[60:63]
    v_mul_f32 v2, v2, v236
    v_mul_f32 v3, v3, v236
    v_mfma_f32_16x16x32_bf16 v[64:67], v[144:147], a[112:115], v[64:67]
    v_mul_f32 v4, v4, v236
    v_mul_f32 v5, v5, v236
    v_mfma_f32_16x16x32_bf16 v[72:75], v[144:147], a[116:119], v[72:75]
    ds_read_b64_tr_b16 v[172:173], v203 offset:36864
    ds_read_b64_tr_b16 v[174:175], v203 offset:37376
    v_mul_f32 v6, v6, v236
    v_mul_f32 v7, v7, v236
    v_mfma_f32_16x16x32_bf16 v[80:83], v[144:147], a[120:123], v[80:83]
    v_cvt_pk_bf16_f32 v0, v0, v1
    v_cvt_pk_bf16_f32 v1, v2, v3
    v_mfma_f32_16x16x32_bf16 v[88:91], v[144:147], a[124:127], v[88:91]
    v_cvt_pk_bf16_f32 v2, v4, v5
    v_cvt_pk_bf16_f32 v3, v6, v7
    v_mfma_f32_16x16x32_bf16 v[68:71], v[148:151], a[112:115], v[68:71]
    v_fma_f32 v8, v212, -v230, v8
    v_fma_f32 v9, v213, -v230, v9
    v_mfma_f32_16x16x32_bf16 v[76:79], v[148:151], a[116:119], v[76:79]
    v_fma_f32 v10, v214, -v230, v10
    v_fma_f32 v11, v215, -v230, v11
    v_mfma_f32_16x16x32_bf16 v[84:87], v[148:151], a[120:123], v[84:87]
    v_fma_f32 v12, v216, -v230, v12
    v_fma_f32 v13, v217, -v230, v13
    v_mfma_f32_16x16x32_bf16 v[92:95], v[148:151], a[124:127], v[92:95]
    v_fma_f32 v14, v218, -v230, v14
    v_fma_f32 v15, v219, -v230, v15
    v_mfma_f32_16x16x32_bf16 v[96:99], v[152:155], a[112:115], v[96:99]
    v_mul_f32 v8, v8, v238
    v_mul_f32 v9, v9, v238
    v_mfma_f32_16x16x32_bf16 v[104:107], v[152:155], a[116:119], v[104:107]
    v_mul_f32 v10, v10, v238
    v_mul_f32 v11, v11, v238
    v_mfma_f32_16x16x32_bf16 v[112:115], v[152:155], a[120:123], v[112:115]
    v_mul_f32 v12, v12, v238
    v_mul_f32 v13, v13, v238
    v_mfma_f32_16x16x32_bf16 v[120:123], v[152:155], a[124:127], v[120:123]
    v_mul_f32 v14, v14, v238
    v_mul_f32 v15, v15, v238
    v_mfma_f32_16x16x32_bf16 v[100:103], v[156:159], a[112:115], v[100:103]
    v_cvt_pk_bf16_f32 v4, v8, v9
    v_cvt_pk_bf16_f32 v5, v10, v11
    v_mfma_f32_16x16x32_bf16 v[108:111], v[156:159], a[116:119], v[108:111]
    v_cvt_pk_bf16_f32 v6, v12, v13
    v_cvt_pk_bf16_f32 v7, v14, v15
    v_mfma_f32_16x16x32_bf16 v[116:119], v[156:159], a[120:123], v[116:119]
    v_fma_f32 v16, v212, -v232, v16
    v_fma_f32 v17, v213, -v232, v17
    v_mfma_f32_16x16x32_bf16 v[124:127], v[156:159], a[124:127], v[124:127]
    s_waitcnt lgkmcnt(6)
    v_fma_f32 v18, v214, -v232, v18
    v_fma_f32 v19, v215, -v232, v19
    v_mfma_f32_16x16x32_bf16 a[192:195], v[160:163], a[112:115], a[192:195]
    v_fma_f32 v20, v216, -v232, v20
    v_fma_f32 v21, v217, -v232, v21
    v_mfma_f32_16x16x32_bf16 a[196:199], v[160:163], a[116:119], a[196:199]
    v_fma_f32 v22, v218, -v232, v22
    v_fma_f32 v23, v219, -v232, v23
    v_mfma_f32_16x16x32_bf16 a[200:203], v[160:163], a[120:123], a[200:203]
    v_mul_f32 v16, v16, v240
    v_mul_f32 v17, v17, v240
    v_mfma_f32_16x16x32_bf16 a[204:207], v[160:163], a[124:127], a[204:207]
    s_waitcnt lgkmcnt(4)
    v_mul_f32 v18, v18, v240
    v_mul_f32 v19, v19, v240
    v_mfma_f32_16x16x32_bf16 a[208:211], v[164:167], a[112:115], a[208:211]
    v_mul_f32 v20, v20, v240
    v_mul_f32 v21, v21, v240
    v_mfma_f32_16x16x32_bf16 a[212:215], v[164:167], a[116:119], a[212:215]
    v_mul_f32 v22, v22, v240
    v_mul_f32 v23, v23, v240
    v_mfma_f32_16x16x32_bf16 a[216:219], v[164:167], a[120:123], a[216:219]
    v_cvt_pk_bf16_f32 v8, v16, v17
    v_cvt_pk_bf16_f32 v9, v18, v19
    v_mfma_f32_16x16x32_bf16 a[220:223], v[164:167], a[124:127], a[220:223]
    s_waitcnt lgkmcnt(2)
    v_cvt_pk_bf16_f32 v10, v20, v21
    v_cvt_pk_bf16_f32 v11, v22, v23
    v_mfma_f32_16x16x32_bf16 a[224:227], v[168:171], a[112:115], a[224:227]
    v_fma_f32 v24, v212, -v234, v24
    v_fma_f32 v25, v213, -v234, v25
    v_mfma_f32_16x16x32_bf16 a[228:231], v[168:171], a[116:119], a[228:231]
    v_fma_f32 v26, v214, -v234, v26
    v_fma_f32 v27, v215, -v234, v27
    v_mfma_f32_16x16x32_bf16 a[232:235], v[168:171], a[120:123], a[232:235]
    v_fma_f32 v28, v216, -v234, v28
    v_fma_f32 v29, v217, -v234, v29
    v_mfma_f32_16x16x32_bf16 a[236:239], v[168:171], a[124:127], a[236:239]
    s_waitcnt lgkmcnt(0)
    v_fma_f32 v30, v218, -v234, v30
    v_fma_f32 v31, v219, -v234, v31
    v_mfma_f32_16x16x32_bf16 a[240:243], v[172:175], a[112:115], a[240:243]
    v_mul_f32 v24, v24, v242
    v_mul_f32 v25, v25, v242
    v_mfma_f32_16x16x32_bf16 a[244:247], v[172:175], a[116:119], a[244:247]
    v_mul_f32 v26, v26, v242
    v_mul_f32 v27, v27, v242
    v_mfma_f32_16x16x32_bf16 a[248:251], v[172:175], a[120:123], a[248:251]
    v_mul_f32 v28, v28, v242
    v_mul_f32 v29, v29, v242
    v_mfma_f32_16x16x32_bf16 a[252:255], v[172:175], a[124:127], a[252:255]
    v_mul_f32 v30, v30, v242
    v_mul_f32 v31, v31, v242
    v_cvt_pk_bf16_f32 v12, v24, v25
    v_cvt_pk_bf16_f32 v13, v26, v27
    v_cvt_pk_bf16_f32 v14, v28, v29
    v_cvt_pk_bf16_f32 v15, v30, v31
    ds_read_b128 v[212:215], v209 offset:384
    ds_read_b128 v[216:219], v209 offset:448
    v_pk_fma_f32 v[32:33], v[220:221], v[228:229], v[32:33] op_sel:[0,0,0] op_sel_hi:[1,0,1] neg_lo:[0,1,0] neg_hi:[0,1,0]
    v_pk_fma_f32 v[34:35], v[222:223], v[228:229], v[34:35] op_sel:[0,0,0] op_sel_hi:[1,0,1] neg_lo:[0,1,0] neg_hi:[0,1,0]
    v_pk_fma_f32 v[36:37], v[224:225], v[228:229], v[36:37] op_sel:[0,0,0] op_sel_hi:[1,0,1] neg_lo:[0,1,0] neg_hi:[0,1,0]
    v_pk_fma_f32 v[38:39], v[226:227], v[228:229], v[38:39] op_sel:[0,0,0] op_sel_hi:[1,0,1] neg_lo:[0,1,0] neg_hi:[0,1,0]
    v_pk_mul_f32 v[32:33], v[32:33], v[236:237] op_sel:[0,0] op_sel_hi:[1,0]
    v_pk_mul_f32 v[34:35], v[34:35], v[236:237] op_sel:[0,0] op_sel_hi:[1,0]
    v_pk_mul_f32 v[36:37], v[36:37], v[236:237] op_sel:[0,0] op_sel_hi:[1,0]
    v_pk_mul_f32 v[38:39], v[38:39], v[236:237] op_sel:[0,0] op_sel_hi:[1,0]
    v_cvt_pk_bf16_f32 v16, v32, v33
    v_cvt_pk_bf16_f32 v17, v34, v35
    v_cvt_pk_bf16_f32 v18, v36, v37
    v_cvt_pk_bf16_f32 v19, v38, v39
    v_pk_fma_f32 v[40:41], v[220:221], v[230:231], v[40:41] op_sel:[0,0,0] op_sel_hi:[1,0,1] neg_lo:[0,1,0] neg_hi:[0,1,0]
    v_pk_fma_f32 v[42:43], v[222:223], v[230:231], v[42:43] op_sel:[0,0,0] op_sel_hi:[1,0,1] neg_lo:[0,1,0] neg_hi:[0,1,0]
    v_pk_fma_f32 v[44:45], v[224:225], v[230:231], v[44:45] op_sel:[0,0,0] op_sel_hi:[1,0,1] neg_lo:[0,1,0] neg_hi:[0,1,0]
    v_pk_fma_f32 v[46:47], v[226:227], v[230:231], v[46:47] op_sel:[0,0,0] op_sel_hi:[1,0,1] neg_lo:[0,1,0] neg_hi:[0,1,0]
    v_pk_mul_f32 v[40:41], v[40:41], v[238:239] op_sel:[0,0] op_sel_hi:[1,0]
    v_pk_mul_f32 v[42:43], v[42:43], v[238:239] op_sel:[0,0] op_sel_hi:[1,0]
    v_pk_mul_f32 v[44:45], v[44:45], v[238:239] op_sel:[0,0] op_sel_hi:[1,0]
    v_pk_mul_f32 v[46:47], v[46:47], v[238:239] op_sel:[0,0] op_sel_hi:[1,0]
    v_cvt_pk_bf16_f32 v20, v40, v41
    v_cvt_pk_bf16_f32 v21, v42, v43
    v_cvt_pk_bf16_f32 v22, v44, v45
    v_cvt_pk_bf16_f32 v23, v46, v47
    v_pk_fma_f32 v[48:49], v[220:221], v[232:233], v[48:49] op_sel:[0,0,0] op_sel_hi:[1,0,1] neg_lo:[0,1,0] neg_hi:[0,1,0]
    v_pk_fma_f32 v[50:51], v[222:223], v[232:233], v[50:51] op_sel:[0,0,0] op_sel_hi:[1,0,1] neg_lo:[0,1,0] neg_hi:[0,1,0]
    v_pk_fma_f32 v[52:53], v[224:225], v[232:233], v[52:53] op_sel:[0,0,0] op_sel_hi:[1,0,1] neg_lo:[0,1,0] neg_hi:[0,1,0]
    v_pk_fma_f32 v[54:55], v[226:227], v[232:233], v[54:55] op_sel:[0,0,0] op_sel_hi:[1,0,1] neg_lo:[0,1,0] neg_hi:[0,1,0]
    v_pk_mul_f32 v[48:49], v[48:49], v[240:241] op_sel:[0,0] op_sel_hi:[1,0]
    v_pk_mul_f32 v[50:51], v[50:51], v[240:241] op_sel:[0,0] op_sel_hi:[1,0]
    v_pk_mul_f32 v[52:53], v[52:53], v[240:241] op_sel:[0,0] op_sel_hi:[1,0]
    v_pk_mul_f32 v[54:55], v[54:55], v[240:241] op_sel:[0,0] op_sel_hi:[1,0]
    v_cvt_pk_bf16_f32 v24, v48, v49
    v_cvt_pk_bf16_f32 v25, v50, v51
    v_cvt_pk_bf16_f32 v26, v52, v53
    v_cvt_pk_bf16_f32 v27, v54, v55
    v_pk_fma_f32 v[56:57], v[220:221], v[234:235], v[56:57] op_sel:[0,0,0] op_sel_hi:[1,0,1] neg_lo:[0,1,0] neg_hi:[0,1,0]
    v_pk_fma_f32 v[58:59], v[222:223], v[234:235], v[58:59] op_sel:[0,0,0] op_sel_hi:[1,0,1] neg_lo:[0,1,0] neg_hi:[0,1,0]
    v_pk_fma_f32 v[60:61], v[224:225], v[234:235], v[60:61] op_sel:[0,0,0] op_sel_hi:[1,0,1] neg_lo:[0,1,0] neg_hi:[0,1,0]
    v_pk_fma_f32 v[62:63], v[226:227], v[234:235], v[62:63] op_sel:[0,0,0] op_sel_hi:[1,0,1] neg_lo:[0,1,0] neg_hi:[0,1,0]
    v_pk_mul_f32 v[56:57], v[56:57], v[242:243] op_sel:[0,0] op_sel_hi:[1,0]
    v_pk_mul_f32 v[58:59], v[58:59], v[242:243] op_sel:[0,0] op_sel_hi:[1,0]
    v_pk_mul_f32 v[60:61], v[60:61], v[242:243] op_sel:[0,0] op_sel_hi:[1,0]
    v_pk_mul_f32 v[62:63], v[62:63], v[242:243] op_sel:[0,0] op_sel_hi:[1,0]
    v_cvt_pk_bf16_f32 v28, v56, v57
    v_cvt_pk_bf16_f32 v29, v58, v59
    v_cvt_pk_bf16_f32 v30, v60, v61
    v_cvt_pk_bf16_f32 v31, v62, v63
    ds_read_b128 v[220:223], v209 offset:576
    ds_read_b128 v[224:227], v209 offset:640
    s_waitcnt lgkmcnt(2)
    v_pk_fma_f32 v[64:65], v[212:213], v[228:229], v[64:65] op_sel:[0,0,0] op_sel_hi:[1,0,1] neg_lo:[0,1,0] neg_hi:[0,1,0]
    v_pk_fma_f32 v[66:67], v[214:215], v[228:229], v[66:67] op_sel:[0,0,0] op_sel_hi:[1,0,1] neg_lo:[0,1,0] neg_hi:[0,1,0]
    v_pk_fma_f32 v[68:69], v[216:217], v[228:229], v[68:69] op_sel:[0,0,0] op_sel_hi:[1,0,1] neg_lo:[0,1,0] neg_hi:[0,1,0]
    v_pk_fma_f32 v[70:71], v[218:219], v[228:229], v[70:71] op_sel:[0,0,0] op_sel_hi:[1,0,1] neg_lo:[0,1,0] neg_hi:[0,1,0]
    v_pk_mul_f32 v[64:65], v[64:65], v[236:237] op_sel:[0,0] op_sel_hi:[1,0]
    v_pk_mul_f32 v[66:67], v[66:67], v[236:237] op_sel:[0,0] op_sel_hi:[1,0]
    v_pk_mul_f32 v[68:69], v[68:69], v[236:237] op_sel:[0,0] op_sel_hi:[1,0]
    v_pk_mul_f32 v[70:71], v[70:71], v[236:237] op_sel:[0,0] op_sel_hi:[1,0]
    v_cvt_pk_bf16_f32 v32, v64, v65
    v_cvt_pk_bf16_f32 v33, v66, v67
    v_cvt_pk_bf16_f32 v34, v68, v69
    v_cvt_pk_bf16_f32 v35, v70, v71
    v_pk_fma_f32 v[72:73], v[212:213], v[230:231], v[72:73] op_sel:[0,0,0] op_sel_hi:[1,0,1] neg_lo:[0,1,0] neg_hi:[0,1,0]
    v_pk_fma_f32 v[74:75], v[214:215], v[230:231], v[74:75] op_sel:[0,0,0] op_sel_hi:[1,0,1] neg_lo:[0,1,0] neg_hi:[0,1,0]
    v_pk_fma_f32 v[76:77], v[216:217], v[230:231], v[76:77] op_sel:[0,0,0] op_sel_hi:[1,0,1] neg_lo:[0,1,0] neg_hi:[0,1,0]
    v_pk_fma_f32 v[78:79], v[218:219], v[230:231], v[78:79] op_sel:[0,0,0] op_sel_hi:[1,0,1] neg_lo:[0,1,0] neg_hi:[0,1,0]
    v_pk_mul_f32 v[72:73], v[72:73], v[238:239] op_sel:[0,0] op_sel_hi:[1,0]
    v_pk_mul_f32 v[74:75], v[74:75], v[238:239] op_sel:[0,0] op_sel_hi:[1,0]
    v_pk_mul_f32 v[76:77], v[76:77], v[238:239] op_sel:[0,0] op_sel_hi:[1,0]
    v_pk_mul_f32 v[78:79], v[78:79], v[238:239] op_sel:[0,0] op_sel_hi:[1,0]
    v_cvt_pk_bf16_f32 v36, v72, v73
    v_cvt_pk_bf16_f32 v37, v74, v75
    v_cvt_pk_bf16_f32 v38, v76, v77
    v_cvt_pk_bf16_f32 v39, v78, v79
    v_pk_fma_f32 v[80:81], v[212:213], v[232:233], v[80:81] op_sel:[0,0,0] op_sel_hi:[1,0,1] neg_lo:[0,1,0] neg_hi:[0,1,0]
    v_pk_fma_f32 v[82:83], v[214:215], v[232:233], v[82:83] op_sel:[0,0,0] op_sel_hi:[1,0,1] neg_lo:[0,1,0] neg_hi:[0,1,0]
    v_pk_fma_f32 v[84:85], v[216:217], v[232:233], v[84:85] op_sel:[0,0,0] op_sel_hi:[1,0,1] neg_lo:[0,1,0] neg_hi:[0,1,0]
    v_pk_fma_f32 v[86:87], v[218:219], v[232:233], v[86:87] op_sel:[0,0,0] op_sel_hi:[1,0,1] neg_lo:[0,1,0] neg_hi:[0,1,0]
    v_pk_mul_f32 v[80:81], v[80:81], v[240:241] op_sel:[0,0] op_sel_hi:[1,0]
    v_pk_mul_f32 v[82:83], v[82:83], v[240:241] op_sel:[0,0] op_sel_hi:[1,0]
    v_pk_mul_f32 v[84:85], v[84:85], v[240:241] op_sel:[0,0] op_sel_hi:[1,0]
    v_pk_mul_f32 v[86:87], v[86:87], v[240:241] op_sel:[0,0] op_sel_hi:[1,0]
    v_cvt_pk_bf16_f32 v40, v80, v81
    v_cvt_pk_bf16_f32 v41, v82, v83
    v_cvt_pk_bf16_f32 v42, v84, v85
    v_cvt_pk_bf16_f32 v43, v86, v87
    v_pk_fma_f32 v[88:89], v[212:213], v[234:235], v[88:89] op_sel:[0,0,0] op_sel_hi:[1,0,1] neg_lo:[0,1,0] neg_hi:[0,1,0]
    v_pk_fma_f32 v[90:91], v[214:215], v[234:235], v[90:91] op_sel:[0,0,0] op_sel_hi:[1,0,1] neg_lo:[0,1,0] neg_hi:[0,1,0]
    v_pk_fma_f32 v[92:93], v[216:217], v[234:235], v[92:93] op_sel:[0,0,0] op_sel_hi:[1,0,1] neg_lo:[0,1,0] neg_hi:[0,1,0]
    v_pk_fma_f32 v[94:95], v[218:219], v[234:235], v[94:95] op_sel:[0,0,0] op_sel_hi:[1,0,1] neg_lo:[0,1,0] neg_hi:[0,1,0]
    v_pk_mul_f32 v[88:89], v[88:89], v[242:243] op_sel:[0,0] op_sel_hi:[1,0]
    v_pk_mul_f32 v[90:91], v[90:91], v[242:243] op_sel:[0,0] op_sel_hi:[1,0]
    v_pk_mul_f32 v[92:93], v[92:93], v[242:243] op_sel:[0,0] op_sel_hi:[1,0]
    v_pk_mul_f32 v[94:95], v[94:95], v[242:243] op_sel:[0,0] op_sel_hi:[1,0]
    v_cvt_pk_bf16_f32 v44, v88, v89
    v_cvt_pk_bf16_f32 v45, v90, v91
    v_cvt_pk_bf16_f32 v46, v92, v93
    v_cvt_pk_bf16_f32 v47, v94, v95
    s_waitcnt lgkmcnt(0)
    v_pk_fma_f32 v[96:97], v[220:221], v[228:229], v[96:97] op_sel:[0,0,0] op_sel_hi:[1,0,1] neg_lo:[0,1,0] neg_hi:[0,1,0]
    v_pk_fma_f32 v[98:99], v[222:223], v[228:229], v[98:99] op_sel:[0,0,0] op_sel_hi:[1,0,1] neg_lo:[0,1,0] neg_hi:[0,1,0]
    v_pk_fma_f32 v[100:101], v[224:225], v[228:229], v[100:101] op_sel:[0,0,0] op_sel_hi:[1,0,1] neg_lo:[0,1,0] neg_hi:[0,1,0]
    v_pk_fma_f32 v[102:103], v[226:227], v[228:229], v[102:103] op_sel:[0,0,0] op_sel_hi:[1,0,1] neg_lo:[0,1,0] neg_hi:[0,1,0]
    v_pk_mul_f32 v[96:97], v[96:97], v[236:237] op_sel:[0,0] op_sel_hi:[1,0]
    v_pk_mul_f32 v[98:99], v[98:99], v[236:237] op_sel:[0,0] op_sel_hi:[1,0]
    v_pk_mul_f32 v[100:101], v[100:101], v[236:237] op_sel:[0,0] op_sel_hi:[1,0]
    v_pk_mul_f32 v[102:103], v[102:103], v[236:237] op_sel:[0,0] op_sel_hi:[1,0]
    v_cvt_pk_bf16_f32 v48, v96, v97
    v_cvt_pk_bf16_f32 v49, v98, v99
    v_cvt_pk_bf16_f32 v50, v100, v101
    v_cvt_pk_bf16_f32 v51, v102, v103
    v_pk_fma_f32 v[104:105], v[220:221], v[230:231], v[104:105] op_sel:[0,0,0] op_sel_hi:[1,0,1] neg_lo:[0,1,0] neg_hi:[0,1,0]
    v_pk_fma_f32 v[106:107], v[222:223], v[230:231], v[106:107] op_sel:[0,0,0] op_sel_hi:[1,0,1] neg_lo:[0,1,0] neg_hi:[0,1,0]
    v_pk_fma_f32 v[108:109], v[224:225], v[230:231], v[108:109] op_sel:[0,0,0] op_sel_hi:[1,0,1] neg_lo:[0,1,0] neg_hi:[0,1,0]
    v_pk_fma_f32 v[110:111], v[226:227], v[230:231], v[110:111] op_sel:[0,0,0] op_sel_hi:[1,0,1] neg_lo:[0,1,0] neg_hi:[0,1,0]
    v_pk_mul_f32 v[104:105], v[104:105], v[238:239] op_sel:[0,0] op_sel_hi:[1,0]
    v_pk_mul_f32 v[106:107], v[106:107], v[238:239] op_sel:[0,0] op_sel_hi:[1,0]
    v_pk_mul_f32 v[108:109], v[108:109], v[238:239] op_sel:[0,0] op_sel_hi:[1,0]
    v_pk_mul_f32 v[110:111], v[110:111], v[238:239] op_sel:[0,0] op_sel_hi:[1,0]
    v_cvt_pk_bf16_f32 v52, v104, v105
    v_cvt_pk_bf16_f32 v53, v106, v107
    v_cvt_pk_bf16_f32 v54, v108, v109
    v_cvt_pk_bf16_f32 v55, v110, v111
    v_pk_fma_f32 v[112:113], v[220:221], v[232:233], v[112:113] op_sel:[0,0,0] op_sel_hi:[1,0,1] neg_lo:[0,1,0] neg_hi:[0,1,0]
    v_pk_fma_f32 v[114:115], v[222:223], v[232:233], v[114:115] op_sel:[0,0,0] op_sel_hi:[1,0,1] neg_lo:[0,1,0] neg_hi:[0,1,0]
    v_pk_fma_f32 v[116:117], v[224:225], v[232:233], v[116:117] op_sel:[0,0,0] op_sel_hi:[1,0,1] neg_lo:[0,1,0] neg_hi:[0,1,0]
    v_pk_fma_f32 v[118:119], v[226:227], v[232:233], v[118:119] op_sel:[0,0,0] op_sel_hi:[1,0,1] neg_lo:[0,1,0] neg_hi:[0,1,0]
    v_pk_mul_f32 v[112:113], v[112:113], v[240:241] op_sel:[0,0] op_sel_hi:[1,0]
    v_pk_mul_f32 v[114:115], v[114:115], v[240:241] op_sel:[0,0] op_sel_hi:[1,0]
    v_pk_mul_f32 v[116:117], v[116:117], v[240:241] op_sel:[0,0] op_sel_hi:[1,0]
    v_pk_mul_f32 v[118:119], v[118:119], v[240:241] op_sel:[0,0] op_sel_hi:[1,0]
    v_cvt_pk_bf16_f32 v56, v112, v113
    v_cvt_pk_bf16_f32 v57, v114, v115
    v_cvt_pk_bf16_f32 v58, v116, v117
    v_cvt_pk_bf16_f32 v59, v118, v119
    v_pk_fma_f32 v[120:121], v[220:221], v[234:235], v[120:121] op_sel:[0,0,0] op_sel_hi:[1,0,1] neg_lo:[0,1,0] neg_hi:[0,1,0]
    v_pk_fma_f32 v[122:123], v[222:223], v[234:235], v[122:123] op_sel:[0,0,0] op_sel_hi:[1,0,1] neg_lo:[0,1,0] neg_hi:[0,1,0]
    v_pk_fma_f32 v[124:125], v[224:225], v[234:235], v[124:125] op_sel:[0,0,0] op_sel_hi:[1,0,1] neg_lo:[0,1,0] neg_hi:[0,1,0]
    v_pk_fma_f32 v[126:127], v[226:227], v[234:235], v[126:127] op_sel:[0,0,0] op_sel_hi:[1,0,1] neg_lo:[0,1,0] neg_hi:[0,1,0]
    v_pk_mul_f32 v[120:121], v[120:121], v[242:243] op_sel:[0,0] op_sel_hi:[1,0]
    v_pk_mul_f32 v[122:123], v[122:123], v[242:243] op_sel:[0,0] op_sel_hi:[1,0]
    v_pk_mul_f32 v[124:125], v[124:125], v[242:243] op_sel:[0,0] op_sel_hi:[1,0]
    v_pk_mul_f32 v[126:127], v[126:127], v[242:243] op_sel:[0,0] op_sel_hi:[1,0]
    v_cvt_pk_bf16_f32 v60, v120, v121
    v_cvt_pk_bf16_f32 v61, v122, v123
    v_cvt_pk_bf16_f32 v62, v124, v125
    v_cvt_pk_bf16_f32 v63, v126, v127
    ds_read_b128 v[212:215], v209 offset:128
    ds_read_b128 v[216:219], v209 offset:320
    ds_read_b128 v[220:223], v209 offset:512
    ds_read_b128 v[224:227], v209 offset:704
    s_waitcnt lgkmcnt(0)
    s_mov_b32 s53, 0xbfb8aa3b
    s_lshl_b32 s51, s42, 11
    s_add_u32 s51, s51, s54
    v_accvgpr_read_b32 v64, a192
    v_accvgpr_read_b32 v65, a193
    v_accvgpr_read_b32 v66, a194
    v_accvgpr_read_b32 v67, a195
    v_accvgpr_read_b32 v68, a208
    v_accvgpr_read_b32 v69, a209
    v_accvgpr_read_b32 v70, a210
    v_accvgpr_read_b32 v71, a211
    v_pk_fma_f32 v[64:65], v[212:213], v[228:229], v[64:65] op_sel:[0,0,0] op_sel_hi:[1,0,1] neg_lo:[0,1,0] neg_hi:[0,1,0]
    v_pk_fma_f32 v[66:67], v[214:215], v[228:229], v[66:67] op_sel:[0,0,0] op_sel_hi:[1,0,1] neg_lo:[0,1,0] neg_hi:[0,1,0]
    v_pk_fma_f32 v[68:69], v[216:217], v[228:229], v[68:69] op_sel:[0,0,0] op_sel_hi:[1,0,1] neg_lo:[0,1,0] neg_hi:[0,1,0]
    v_pk_fma_f32 v[70:71], v[218:219], v[228:229], v[70:71] op_sel:[0,0,0] op_sel_hi:[1,0,1] neg_lo:[0,1,0] neg_hi:[0,1,0]
    v_pk_mul_f32 v[72:73], v[64:65], v[236:237] op_sel:[0,1] op_sel_hi:[1,1]
    v_pk_mul_f32 v[74:75], v[66:67], v[236:237] op_sel:[0,1] op_sel_hi:[1,1]
    v_pk_mul_f32 v[76:77], v[68:69], v[236:237] op_sel:[0,1] op_sel_hi:[1,1]
    v_pk_mul_f32 v[78:79], v[70:71], v[236:237] op_sel:[0,1] op_sel_hi:[1,1]
    v_exp_f32 v72, v72
    v_exp_f32 v73, v73
    v_exp_f32 v74, v74
    v_exp_f32 v75, v75
    v_exp_f32 v76, v76
    v_exp_f32 v77, v77
    v_exp_f32 v78, v78
    v_exp_f32 v79, v79
    v_pk_fma_f32 v[72:73], v[72:73], v[228:229], v[228:229] op_sel:[0,1,1] op_sel_hi:[1,1,1]
    v_pk_fma_f32 v[74:75], v[74:75], v[228:229], v[228:229] op_sel:[0,1,1] op_sel_hi:[1,1,1]
    v_pk_fma_f32 v[76:77], v[76:77], v[228:229], v[228:229] op_sel:[0,1,1] op_sel_hi:[1,1,1]
    v_pk_fma_f32 v[78:79], v[78:79], v[228:229], v[228:229] op_sel:[0,1,1] op_sel_hi:[1,1,1]
    v_rcp_f32 v72, v72
    v_rcp_f32 v73, v73
    v_rcp_f32 v74, v74
    v_rcp_f32 v75, v75
    v_rcp_f32 v76, v76
    v_rcp_f32 v77, v77
    v_rcp_f32 v78, v78
    v_rcp_f32 v79, v79
    v_pk_mul_f32 v[64:65], v[64:65], v[72:73]
    v_pk_mul_f32 v[66:67], v[66:67], v[74:75]
    v_pk_mul_f32 v[68:69], v[68:69], v[76:77]
    v_pk_mul_f32 v[70:71], v[70:71], v[78:79]
    v_cvt_pk_bf16_f32 v80, v64, v65
    v_cvt_pk_bf16_f32 v81, v66, v67
    v_cvt_pk_bf16_f32 v82, v68, v69
    v_cvt_pk_bf16_f32 v83, v70, v71
    buffer_store_dwordx4 v[80:83], v211, s[28:31], s51 offen offset:0 sc1
    v_accvgpr_read_b32 v88, a224
    v_accvgpr_read_b32 v89, a225
    v_accvgpr_read_b32 v90, a226
    v_accvgpr_read_b32 v91, a227
    v_accvgpr_read_b32 v92, a240
    v_accvgpr_read_b32 v93, a241
    v_accvgpr_read_b32 v94, a242
    v_accvgpr_read_b32 v95, a243
    v_pk_fma_f32 v[88:89], v[220:221], v[228:229], v[88:89] op_sel:[0,0,0] op_sel_hi:[1,0,1] neg_lo:[0,1,0] neg_hi:[0,1,0]
    v_pk_fma_f32 v[90:91], v[222:223], v[228:229], v[90:91] op_sel:[0,0,0] op_sel_hi:[1,0,1] neg_lo:[0,1,0] neg_hi:[0,1,0]
    v_pk_fma_f32 v[92:93], v[224:225], v[228:229], v[92:93] op_sel:[0,0,0] op_sel_hi:[1,0,1] neg_lo:[0,1,0] neg_hi:[0,1,0]
    v_pk_fma_f32 v[94:95], v[226:227], v[228:229], v[94:95] op_sel:[0,0,0] op_sel_hi:[1,0,1] neg_lo:[0,1,0] neg_hi:[0,1,0]
    v_pk_mul_f32 v[96:97], v[88:89], v[236:237] op_sel:[0,1] op_sel_hi:[1,1]
    v_pk_mul_f32 v[98:99], v[90:91], v[236:237] op_sel:[0,1] op_sel_hi:[1,1]
    v_pk_mul_f32 v[100:101], v[92:93], v[236:237] op_sel:[0,1] op_sel_hi:[1,1]
    v_pk_mul_f32 v[102:103], v[94:95], v[236:237] op_sel:[0,1] op_sel_hi:[1,1]
    v_exp_f32 v96, v96
    v_exp_f32 v97, v97
    v_exp_f32 v98, v98
    v_exp_f32 v99, v99
    v_exp_f32 v100, v100
    v_exp_f32 v101, v101
    v_exp_f32 v102, v102
    v_exp_f32 v103, v103
    v_pk_fma_f32 v[96:97], v[96:97], v[228:229], v[228:229] op_sel:[0,1,1] op_sel_hi:[1,1,1]
    v_pk_fma_f32 v[98:99], v[98:99], v[228:229], v[228:229] op_sel:[0,1,1] op_sel_hi:[1,1,1]
    v_pk_fma_f32 v[100:101], v[100:101], v[228:229], v[228:229] op_sel:[0,1,1] op_sel_hi:[1,1,1]
    v_pk_fma_f32 v[102:103], v[102:103], v[228:229], v[228:229] op_sel:[0,1,1] op_sel_hi:[1,1,1]
    v_rcp_f32 v96, v96
    v_rcp_f32 v97, v97
    v_rcp_f32 v98, v98
    v_rcp_f32 v99, v99
    v_rcp_f32 v100, v100
    v_rcp_f32 v101, v101
    v_rcp_f32 v102, v102
    v_rcp_f32 v103, v103
    v_pk_mul_f32 v[88:89], v[88:89], v[96:97]
    v_pk_mul_f32 v[90:91], v[90:91], v[98:99]
    v_pk_mul_f32 v[92:93], v[92:93], v[100:101]
    v_pk_mul_f32 v[94:95], v[94:95], v[102:103]
    v_cvt_pk_bf16_f32 v104, v88, v89
    v_cvt_pk_bf16_f32 v105, v90, v91
    v_cvt_pk_bf16_f32 v106, v92, v93
    v_cvt_pk_bf16_f32 v107, v94, v95
    buffer_store_dwordx4 v[104:107], v211, s[28:31], s51 offen offset:1024 sc1
    s_add_u32 s51, s51, 57344
    v_accvgpr_read_b32 v64, a196
    v_accvgpr_read_b32 v65, a197
    v_accvgpr_read_b32 v66, a198
    v_accvgpr_read_b32 v67, a199
    v_accvgpr_read_b32 v68, a212
    v_accvgpr_read_b32 v69, a213
    v_accvgpr_read_b32 v70, a214
    v_accvgpr_read_b32 v71, a215
    v_pk_fma_f32 v[64:65], v[212:213], v[230:231], v[64:65] op_sel:[0,0,0] op_sel_hi:[1,0,1] neg_lo:[0,1,0] neg_hi:[0,1,0]
    v_pk_fma_f32 v[66:67], v[214:215], v[230:231], v[66:67] op_sel:[0,0,0] op_sel_hi:[1,0,1] neg_lo:[0,1,0] neg_hi:[0,1,0]
    v_pk_fma_f32 v[68:69], v[216:217], v[230:231], v[68:69] op_sel:[0,0,0] op_sel_hi:[1,0,1] neg_lo:[0,1,0] neg_hi:[0,1,0]
    v_pk_fma_f32 v[70:71], v[218:219], v[230:231], v[70:71] op_sel:[0,0,0] op_sel_hi:[1,0,1] neg_lo:[0,1,0] neg_hi:[0,1,0]
    v_pk_mul_f32 v[72:73], v[64:65], v[238:239] op_sel:[0,1] op_sel_hi:[1,1]
    v_pk_mul_f32 v[74:75], v[66:67], v[238:239] op_sel:[0,1] op_sel_hi:[1,1]
    v_pk_mul_f32 v[76:77], v[68:69], v[238:239] op_sel:[0,1] op_sel_hi:[1,1]
    v_pk_mul_f32 v[78:79], v[70:71], v[238:239] op_sel:[0,1] op_sel_hi:[1,1]
    v_exp_f32 v72, v72
    v_exp_f32 v73, v73
    v_exp_f32 v74, v74
    v_exp_f32 v75, v75
    v_exp_f32 v76, v76
    v_exp_f32 v77, v77
    v_exp_f32 v78, v78
    v_exp_f32 v79, v79
    v_pk_fma_f32 v[72:73], v[72:73], v[230:231], v[230:231] op_sel:[0,1,1] op_sel_hi:[1,1,1]
    v_pk_fma_f32 v[74:75], v[74:75], v[230:231], v[230:231] op_sel:[0,1,1] op_sel_hi:[1,1,1]
    v_pk_fma_f32 v[76:77], v[76:77], v[230:231], v[230:231] op_sel:[0,1,1] op_sel_hi:[1,1,1]
    v_pk_fma_f32 v[78:79], v[78:79], v[230:231], v[230:231] op_sel:[0,1,1] op_sel_hi:[1,1,1]
    v_rcp_f32 v72, v72
    v_rcp_f32 v73, v73
    v_rcp_f32 v74, v74
    v_rcp_f32 v75, v75
    v_rcp_f32 v76, v76
    v_rcp_f32 v77, v77
    v_rcp_f32 v78, v78
    v_rcp_f32 v79, v79
    v_pk_mul_f32 v[64:65], v[64:65], v[72:73]
    v_pk_mul_f32 v[66:67], v[66:67], v[74:75]
    v_pk_mul_f32 v[68:69], v[68:69], v[76:77]
    v_pk_mul_f32 v[70:71], v[70:71], v[78:79]
    v_cvt_pk_bf16_f32 v80, v64, v65
    v_cvt_pk_bf16_f32 v81, v66, v67
    v_cvt_pk_bf16_f32 v82, v68, v69
    v_cvt_pk_bf16_f32 v83, v70, v71
    buffer_store_dwordx4 v[80:83], v211, s[28:31], s51 offen offset:0 sc1
    v_accvgpr_read_b32 v88, a228
    v_accvgpr_read_b32 v89, a229
    v_accvgpr_read_b32 v90, a230
    v_accvgpr_read_b32 v91, a231
    v_accvgpr_read_b32 v92, a244
    v_accvgpr_read_b32 v93, a245
    v_accvgpr_read_b32 v94, a246
    v_accvgpr_read_b32 v95, a247
    v_pk_fma_f32 v[88:89], v[220:221], v[230:231], v[88:89] op_sel:[0,0,0] op_sel_hi:[1,0,1] neg_lo:[0,1,0] neg_hi:[0,1,0]
    v_pk_fma_f32 v[90:91], v[222:223], v[230:231], v[90:91] op_sel:[0,0,0] op_sel_hi:[1,0,1] neg_lo:[0,1,0] neg_hi:[0,1,0]
    v_pk_fma_f32 v[92:93], v[224:225], v[230:231], v[92:93] op_sel:[0,0,0] op_sel_hi:[1,0,1] neg_lo:[0,1,0] neg_hi:[0,1,0]
    v_pk_fma_f32 v[94:95], v[226:227], v[230:231], v[94:95] op_sel:[0,0,0] op_sel_hi:[1,0,1] neg_lo:[0,1,0] neg_hi:[0,1,0]
    v_pk_mul_f32 v[96:97], v[88:89], v[238:239] op_sel:[0,1] op_sel_hi:[1,1]
    v_pk_mul_f32 v[98:99], v[90:91], v[238:239] op_sel:[0,1] op_sel_hi:[1,1]
    v_pk_mul_f32 v[100:101], v[92:93], v[238:239] op_sel:[0,1] op_sel_hi:[1,1]
    v_pk_mul_f32 v[102:103], v[94:95], v[238:239] op_sel:[0,1] op_sel_hi:[1,1]
    v_exp_f32 v96, v96
    v_exp_f32 v97, v97
    v_exp_f32 v98, v98
    v_exp_f32 v99, v99
    v_exp_f32 v100, v100
    v_exp_f32 v101, v101
    v_exp_f32 v102, v102
    v_exp_f32 v103, v103
    v_pk_fma_f32 v[96:97], v[96:97], v[230:231], v[230:231] op_sel:[0,1,1] op_sel_hi:[1,1,1]
    v_pk_fma_f32 v[98:99], v[98:99], v[230:231], v[230:231] op_sel:[0,1,1] op_sel_hi:[1,1,1]
    v_pk_fma_f32 v[100:101], v[100:101], v[230:231], v[230:231] op_sel:[0,1,1] op_sel_hi:[1,1,1]
    v_pk_fma_f32 v[102:103], v[102:103], v[230:231], v[230:231] op_sel:[0,1,1] op_sel_hi:[1,1,1]
    v_rcp_f32 v96, v96
    v_rcp_f32 v97, v97
    v_rcp_f32 v98, v98
    v_rcp_f32 v99, v99
L_it5:
    s_cbranch_execz L_it9
    v_rcp_f32 v100, v100
    v_rcp_f32 v101, v101
    v_rcp_f32 v102, v102
    v_rcp_f32 v103, v103
    v_pk_mul_f32 v[88:89], v[88:89], v[96:97]
    v_pk_mul_f32 v[90:91], v[90:91], v[98:99]
    v_pk_mul_f32 v[92:93], v[92:93], v[100:101]
    v_pk_mul_f32 v[94:95], v[94:95], v[102:103]
    v_cvt_pk_bf16_f32 v104, v88, v89
    v_cvt_pk_bf16_f32 v105, v90, v91
    v_cvt_pk_bf16_f32 v106, v92, v93
    v_cvt_pk_bf16_f32 v107, v94, v95
    buffer_store_dwordx4 v[104:107], v211, s[28:31], s51 offen offset:1024 sc1
    s_add_u32 s51, s51, 57344
    v_accvgpr_read_b32 v64, a200
    v_accvgpr_read_b32 v65, a201
    v_accvgpr_read_b32 v66, a202
    v_accvgpr_read_b32 v67, a203
    v_accvgpr_read_b32 v68, a216
    v_accvgpr_read_b32 v69, a217
    v_accvgpr_read_b32 v70, a218
    v_accvgpr_read_b32 v71, a219
    v_pk_fma_f32 v[64:65], v[212:213], v[232:233], v[64:65] op_sel:[0,0,0] op_sel_hi:[1,0,1] neg_lo:[0,1,0] neg_hi:[0,1,0]
    v_pk_fma_f32 v[66:67], v[214:215], v[232:233], v[66:67] op_sel:[0,0,0] op_sel_hi:[1,0,1] neg_lo:[0,1,0] neg_hi:[0,1,0]
    v_pk_fma_f32 v[68:69], v[216:217], v[232:233], v[68:69] op_sel:[0,0,0] op_sel_hi:[1,0,1] neg_lo:[0,1,0] neg_hi:[0,1,0]
    v_pk_fma_f32 v[70:71], v[218:219], v[232:233], v[70:71] op_sel:[0,0,0] op_sel_hi:[1,0,1] neg_lo:[0,1,0] neg_hi:[0,1,0]
    v_pk_mul_f32 v[72:73], v[64:65], v[240:241] op_sel:[0,1] op_sel_hi:[1,1]
    v_pk_mul_f32 v[74:75], v[66:67], v[240:241] op_sel:[0,1] op_sel_hi:[1,1]
    v_pk_mul_f32 v[76:77], v[68:69], v[240:241] op_sel:[0,1] op_sel_hi:[1,1]
    v_pk_mul_f32 v[78:79], v[70:71], v[240:241] op_sel:[0,1] op_sel_hi:[1,1]
    v_exp_f32 v72, v72
    v_exp_f32 v73, v73
    v_exp_f32 v74, v74
    v_exp_f32 v75, v75
    v_exp_f32 v76, v76
    v_exp_f32 v77, v77
    v_exp_f32 v78, v78
    v_exp_f32 v79, v79
    v_pk_fma_f32 v[72:73], v[72:73], v[232:233], v[232:233] op_sel:[0,1,1] op_sel_hi:[1,1,1]
    v_pk_fma_f32 v[74:75], v[74:75], v[232:233], v[232:233] op_sel:[0,1,1] op_sel_hi:[1,1,1]
    v_pk_fma_f32 v[76:77], v[76:77], v[232:233], v[232:233] op_sel:[0,1,1] op_sel_hi:[1,1,1]
    v_pk_fma_f32 v[78:79], v[78:79], v[232:233], v[232:233] op_sel:[0,1,1] op_sel_hi:[1,1,1]
    v_rcp_f32 v72, v72
    v_rcp_f32 v73, v73
    v_rcp_f32 v74, v74
    v_rcp_f32 v75, v75
    v_rcp_f32 v76, v76
    v_rcp_f32 v77, v77
    v_rcp_f32 v78, v78
    v_rcp_f32 v79, v79
    v_pk_mul_f32 v[64:65], v[64:65], v[72:73]
    v_pk_mul_f32 v[66:67], v[66:67], v[74:75]
    v_pk_mul_f32 v[68:69], v[68:69], v[76:77]
    v_pk_mul_f32 v[70:71], v[70:71], v[78:79]
    v_cvt_pk_bf16_f32 v80, v64, v65
    v_cvt_pk_bf16_f32 v81, v66, v67
    v_cvt_pk_bf16_f32 v82, v68, v69
    v_cvt_pk_bf16_f32 v83, v70, v71
    buffer_store_dwordx4 v[80:83], v211, s[28:31], s51 offen offset:0 sc1
    v_accvgpr_read_b32 v88, a232
    v_accvgpr_read_b32 v89, a233
    v_accvgpr_read_b32 v90, a234
    v_accvgpr_read_b32 v91, a235
    v_accvgpr_read_b32 v92, a248
    v_accvgpr_read_b32 v93, a249
    v_accvgpr_read_b32 v94, a250
    v_accvgpr_read_b32 v95, a251
    v_pk_fma_f32 v[88:89], v[220:221], v[232:233], v[88:89] op_sel:[0,0,0] op_sel_hi:[1,0,1] neg_lo:[0,1,0] neg_hi:[0,1,0]
    v_pk_fma_f32 v[90:91], v[222:223], v[232:233], v[90:91] op_sel:[0,0,0] op_sel_hi:[1,0,1] neg_lo:[0,1,0] neg_hi:[0,1,0]
    v_pk_fma_f32 v[92:93], v[224:225], v[232:233], v[92:93] op_sel:[0,0,0] op_sel_hi:[1,0,1] neg_lo:[0,1,0] neg_hi:[0,1,0]
    v_pk_fma_f32 v[94:95], v[226:227], v[232:233], v[94:95] op_sel:[0,0,0] op_sel_hi:[1,0,1] neg_lo:[0,1,0] neg_hi:[0,1,0]
    v_pk_mul_f32 v[96:97], v[88:89], v[240:241] op_sel:[0,1] op_sel_hi:[1,1]
    v_pk_mul_f32 v[98:99], v[90:91], v[240:241] op_sel:[0,1] op_sel_hi:[1,1]
    v_pk_mul_f32 v[100:101], v[92:93], v[240:241] op_sel:[0,1] op_sel_hi:[1,1]
    v_pk_mul_f32 v[102:103], v[94:95], v[240:241] op_sel:[0,1] op_sel_hi:[1,1]
    v_exp_f32 v96, v96
    v_exp_f32 v97, v97
    v_exp_f32 v98, v98
    v_exp_f32 v99, v99
    v_exp_f32 v100, v100
    v_exp_f32 v101, v101
    v_exp_f32 v102, v102
    v_exp_f32 v103, v103
    v_pk_fma_f32 v[96:97], v[96:97], v[232:233], v[232:233] op_sel:[0,1,1] op_sel_hi:[1,1,1]
    v_pk_fma_f32 v[98:99], v[98:99], v[232:233], v[232:233] op_sel:[0,1,1] op_sel_hi:[1,1,1]
    v_pk_fma_f32 v[100:101], v[100:101], v[232:233], v[232:233] op_sel:[0,1,1] op_sel_hi:[1,1,1]
    v_pk_fma_f32 v[102:103], v[102:103], v[232:233], v[232:233] op_sel:[0,1,1] op_sel_hi:[1,1,1]
    v_rcp_f32 v96, v96
    v_rcp_f32 v97, v97
    v_rcp_f32 v98, v98
    v_rcp_f32 v99, v99
    v_rcp_f32 v100, v100
    v_rcp_f32 v101, v101
    v_rcp_f32 v102, v102
    v_rcp_f32 v103, v103
    v_pk_mul_f32 v[88:89], v[88:89], v[96:97]
    v_pk_mul_f32 v[90:91], v[90:91], v[98:99]
    v_pk_mul_f32 v[92:93], v[92:93], v[100:101]
    v_pk_mul_f32 v[94:95], v[94:95], v[102:103]
    v_cvt_pk_bf16_f32 v104, v88, v89
    v_cvt_pk_bf16_f32 v105, v90, v91
    v_cvt_pk_bf16_f32 v106, v92, v93
    v_cvt_pk_bf16_f32 v107, v94, v95
    buffer_store_dwordx4 v[104:107], v211, s[28:31], s51 offen offset:1024 sc1
    s_add_u32 s51, s51, 57344
    v_accvgpr_read_b32 v64, a204
    v_accvgpr_read_b32 v65, a205
    v_accvgpr_read_b32 v66, a206
    v_accvgpr_read_b32 v67, a207
    v_accvgpr_read_b32 v68, a220
    v_accvgpr_read_b32 v69, a221
    v_accvgpr_read_b32 v70, a222
    v_accvgpr_read_b32 v71, a223
    v_pk_fma_f32 v[64:65], v[212:213], v[234:235], v[64:65] op_sel:[0,0,0] op_sel_hi:[1,0,1] neg_lo:[0,1,0] neg_hi:[0,1,0]
    v_pk_fma_f32 v[66:67], v[214:215], v[234:235], v[66:67] op_sel:[0,0,0] op_sel_hi:[1,0,1] neg_lo:[0,1,0] neg_hi:[0,1,0]
    v_pk_fma_f32 v[68:69], v[216:217], v[234:235], v[68:69] op_sel:[0,0,0] op_sel_hi:[1,0,1] neg_lo:[0,1,0] neg_hi:[0,1,0]
    v_pk_fma_f32 v[70:71], v[218:219], v[234:235], v[70:71] op_sel:[0,0,0] op_sel_hi:[1,0,1] neg_lo:[0,1,0] neg_hi:[0,1,0]
    v_pk_mul_f32 v[72:73], v[64:65], v[242:243] op_sel:[0,1] op_sel_hi:[1,1]
    v_pk_mul_f32 v[74:75], v[66:67], v[242:243] op_sel:[0,1] op_sel_hi:[1,1]
    v_pk_mul_f32 v[76:77], v[68:69], v[242:243] op_sel:[0,1] op_sel_hi:[1,1]
    v_pk_mul_f32 v[78:79], v[70:71], v[242:243] op_sel:[0,1] op_sel_hi:[1,1]
    v_exp_f32 v72, v72
    v_exp_f32 v73, v73
    v_exp_f32 v74, v74
    v_exp_f32 v75, v75
    v_exp_f32 v76, v76
    v_exp_f32 v77, v77
    v_exp_f32 v78, v78
    v_exp_f32 v79, v79
    v_pk_fma_f32 v[72:73], v[72:73], v[234:235], v[234:235] op_sel:[0,1,1] op_sel_hi:[1,1,1]
    v_pk_fma_f32 v[74:75], v[74:75], v[234:235], v[234:235] op_sel:[0,1,1] op_sel_hi:[1,1,1]
    v_pk_fma_f32 v[76:77], v[76:77], v[234:235], v[234:235] op_sel:[0,1,1] op_sel_hi:[1,1,1]
    v_pk_fma_f32 v[78:79], v[78:79], v[234:235], v[234:235] op_sel:[0,1,1] op_sel_hi:[1,1,1]
    v_rcp_f32 v72, v72
    v_rcp_f32 v73, v73
    v_rcp_f32 v74, v74
    v_rcp_f32 v75, v75
    v_rcp_f32 v76, v76
    v_rcp_f32 v77, v77
    v_rcp_f32 v78, v78
    v_rcp_f32 v79, v79
    v_pk_mul_f32 v[64:65], v[64:65], v[72:73]
    v_pk_mul_f32 v[66:67], v[66:67], v[74:75]
    v_pk_mul_f32 v[68:69], v[68:69], v[76:77]
    v_pk_mul_f32 v[70:71], v[70:71], v[78:79]
    v_cvt_pk_bf16_f32 v80, v64, v65
    v_cvt_pk_bf16_f32 v81, v66, v67
    v_cvt_pk_bf16_f32 v82, v68, v69
    v_cvt_pk_bf16_f32 v83, v70, v71
    buffer_store_dwordx4 v[80:83], v211, s[28:31], s51 offen offset:0 sc1
    v_accvgpr_read_b32 v88, a236
    v_accvgpr_read_b32 v89, a237
    v_accvgpr_read_b32 v90, a238
    v_accvgpr_read_b32 v91, a239
    v_accvgpr_read_b32 v92, a252
    v_accvgpr_read_b32 v93, a253
    v_accvgpr_read_b32 v94, a254
    v_accvgpr_read_b32 v95, a255
    v_pk_fma_f32 v[88:89], v[220:221], v[234:235], v[88:89] op_sel:[0,0,0] op_sel_hi:[1,0,1] neg_lo:[0,1,0] neg_hi:[0,1,0]
    v_pk_fma_f32 v[90:91], v[222:223], v[234:235], v[90:91] op_sel:[0,0,0] op_sel_hi:[1,0,1] neg_lo:[0,1,0] neg_hi:[0,1,0]
    v_pk_fma_f32 v[92:93], v[224:225], v[234:235], v[92:93] op_sel:[0,0,0] op_sel_hi:[1,0,1] neg_lo:[0,1,0] neg_hi:[0,1,0]
    v_pk_fma_f32 v[94:95], v[226:227], v[234:235], v[94:95] op_sel:[0,0,0] op_sel_hi:[1,0,1] neg_lo:[0,1,0] neg_hi:[0,1,0]
    v_pk_mul_f32 v[96:97], v[88:89], v[242:243] op_sel:[0,1] op_sel_hi:[1,1]
    v_pk_mul_f32 v[98:99], v[90:91], v[242:243] op_sel:[0,1] op_sel_hi:[1,1]
    v_pk_mul_f32 v[100:101], v[92:93], v[242:243] op_sel:[0,1] op_sel_hi:[1,1]
    v_pk_mul_f32 v[102:103], v[94:95], v[242:243] op_sel:[0,1] op_sel_hi:[1,1]
    v_exp_f32 v96, v96
    v_exp_f32 v97, v97
    v_exp_f32 v98, v98
    v_exp_f32 v99, v99
    v_exp_f32 v100, v100
    v_exp_f32 v101, v101
    v_exp_f32 v102, v102
    v_exp_f32 v103, v103
    v_pk_fma_f32 v[96:97], v[96:97], v[234:235], v[234:235] op_sel:[0,1,1] op_sel_hi:[1,1,1]
    v_pk_fma_f32 v[98:99], v[98:99], v[234:235], v[234:235] op_sel:[0,1,1] op_sel_hi:[1,1,1]
    v_pk_fma_f32 v[100:101], v[100:101], v[234:235], v[234:235] op_sel:[0,1,1] op_sel_hi:[1,1,1]
    v_pk_fma_f32 v[102:103], v[102:103], v[234:235], v[234:235] op_sel:[0,1,1] op_sel_hi:[1,1,1]
    v_rcp_f32 v96, v96
    v_rcp_f32 v97, v97
    v_rcp_f32 v98, v98
    v_rcp_f32 v99, v99
    v_rcp_f32 v100, v100
    v_rcp_f32 v101, v101
    v_rcp_f32 v102, v102
    v_rcp_f32 v103, v103
    v_pk_mul_f32 v[88:89], v[88:89], v[96:97]
    v_pk_mul_f32 v[90:91], v[90:91], v[98:99]
    v_pk_mul_f32 v[92:93], v[92:93], v[100:101]
    v_pk_mul_f32 v[94:95], v[94:95], v[102:103]
    v_cvt_pk_bf16_f32 v104, v88, v89
    v_cvt_pk_bf16_f32 v105, v90, v91
    v_cvt_pk_bf16_f32 v106, v92, v93
    v_cvt_pk_bf16_f32 v107, v94, v95
    buffer_store_dwordx4 v[104:107], v211, s[28:31], s51 offen offset:1024 sc1
    s_waitcnt vmcnt(10)
    s_barrier
    s_mov_b32 s6, 0x67
    s_mov_b32 s7, 0x6f
L2_att:
    v_lshrrev_b32 v239, 4, v211
    v_xor_b32 v239, v239, v211
    v_and_b32 v239, 32, v239
    v_cmp_eq_u32 vcc, 0, v239
    v_mov_b32 v240, 0x3f803f80
    s_nop 0
    v_cndmask_b32 v176, 0, v240, vcc
    v_cndmask_b32 v177, 0, v240, vcc
    v_cndmask_b32 v178, 0, v240, vcc
    v_cndmask_b32 v179, 0, v240, vcc
    v_and_b32 v239, 16, v211
    v_cmp_eq_u32 vcc, 0, v239
    v_mov_b32 v239, 0xeeeeeeee
    v_mov_b32 v240, 0x44444444
    v_cndmask_b32 v238, v239, v240, vcc
    v_mov_b32 v228, 0
    v_mov_b32 v229, 0
    v_mov_b32 v230, 0
    v_mov_b32 v231, 0
    v_mov_b32 v232, 0
    v_mov_b32 v233, 0
    v_mov_b32 v234, 0
    v_mov_b32 v235, 0
    ds_read_b128 a[128:131], v180 offset:0
    ds_read_b128 a[132:135], v180 offset:4096
    ds_read_b128 a[136:139], v181 offset:0
    ds_read_b128 a[140:143], v181 offset:4096
    ds_read_b128 a[144:147], v182 offset:0
    ds_read_b128 a[148:151], v182 offset:4096
    ds_read_b128 a[152:155], v183 offset:0
    ds_read_b128 a[156:159], v183 offset:4096
    s_mov_b32 s47, 0x10000
    s_mov_b32 s48, 0xa000
    s_waitcnt lgkmcnt(0)
    v_mfma_f32_16x16x32_bf16 v[64:67], a[128:131], v[0:3], 0
    v_mfma_f32_16x16x32_bf16 v[68:71], a[128:131], v[4:7], 0
    v_mfma_f32_16x16x32_bf16 v[72:75], a[128:131], v[8:11], 0
    v_mfma_f32_16x16x32_bf16 v[76:79], a[128:131], v[12:15], 0
    v_mfma_f32_16x16x32_bf16 v[80:83], a[132:135], v[0:3], 0
    v_mfma_f32_16x16x32_bf16 v[84:87], a[132:135], v[4:7], 0
    v_mfma_f32_16x16x32_bf16 v[88:91], a[132:135], v[8:11], 0
    v_mfma_f32_16x16x32_bf16 v[92:95], a[132:135], v[12:15], 0
    v_mfma_f32_16x16x32_bf16 v[64:67], a[136:139], v[16:19], v[64:67]
    v_mfma_f32_16x16x32_bf16 v[68:71], a[136:139], v[20:23], v[68:71]
    v_mfma_f32_16x16x32_bf16 v[72:75], a[136:139], v[24:27], v[72:75]
    v_mfma_f32_16x16x32_bf16 v[76:79], a[136:139], v[28:31], v[76:79]
    v_mfma_f32_16x16x32_bf16 v[80:83], a[140:143], v[16:19], v[80:83]
    v_mfma_f32_16x16x32_bf16 v[84:87], a[140:143], v[20:23], v[84:87]
    v_mfma_f32_16x16x32_bf16 v[88:91], a[140:143], v[24:27], v[88:91]
    v_mfma_f32_16x16x32_bf16 v[92:95], a[140:143], v[28:31], v[92:95]
    v_mfma_f32_16x16x32_bf16 v[64:67], a[144:147], v[32:35], v[64:67]
    v_mfma_f32_16x16x32_bf16 v[68:71], a[144:147], v[36:39], v[68:71]
    v_mfma_f32_16x16x32_bf16 v[72:75], a[144:147], v[40:43], v[72:75]
    v_mfma_f32_16x16x32_bf16 v[76:79], a[144:147], v[44:47], v[76:79]
    v_mfma_f32_16x16x32_bf16 v[80:83], a[148:151], v[32:35], v[80:83]
    v_mfma_f32_16x16x32_bf16 v[84:87], a[148:151], v[36:39], v[84:87]
    v_mfma_f32_16x16x32_bf16 v[88:91], a[148:151], v[40:43], v[88:91]
    v_mfma_f32_16x16x32_bf16 v[92:95], a[148:151], v[44:47], v[92:95]
    v_mfma_f32_16x16x32_bf16 v[64:67], a[152:155], v[48:51], v[64:67]
    v_mfma_f32_16x16x32_bf16 v[68:71], a[152:155], v[52:55], v[68:71]
    v_mfma_f32_16x16x32_bf16 v[72:75], a[152:155], v[56:59], v[72:75]
    v_mfma_f32_16x16x32_bf16 v[76:79], a[152:155], v[60:63], v[76:79]
    v_mfma_f32_16x16x32_bf16 v[80:83], a[156:159], v[48:51], v[80:83]
    v_mfma_f32_16x16x32_bf16 v[84:87], a[156:159], v[52:55], v[84:87]
    v_mfma_f32_16x16x32_bf16 v[88:91], a[156:159], v[56:59], v[88:91]
    v_mfma_f32_16x16x32_bf16 v[92:95], a[156:159], v[60:63], v[92:95]
    ds_read_b128 a[128:131], v180 offset:8192
    ds_read_b128 a[132:135], v180 offset:12288
    ds_read_b128 a[136:139], v181 offset:8192
    ds_read_b128 a[140:143], v181 offset:12288
    ds_read_b128 a[144:147], v182 offset:8192
    ds_read_b128 a[148:151], v182 offset:12288
    ds_read_b128 a[152:155], v183 offset:8192
    ds_read_b128 a[156:159], v183 offset:12288
    s_cmp_lg_u32 s50, 0
    s_cbranch_scc1 L2_havem
    v_max3_f32 v212, v64, v65, v66
    v_max3_f32 v212, v212, v67, v80
    v_max3_f32 v212, v212, v81, v82
    v_max_f32 v212, v212, v83
    v_max3_f32 v213, v68, v69, v70
    v_max3_f32 v213, v213, v71, v84
    v_max3_f32 v213, v213, v85, v86
    v_max_f32 v213, v213, v87
    v_max3_f32 v214, v72, v73, v74
    v_max3_f32 v214, v214, v75, v88
    v_max3_f32 v214, v214, v89, v90
    v_max_f32 v214, v214, v91
    v_max3_f32 v215, v76, v77, v78
    v_max3_f32 v215, v215, v79, v92
    v_max3_f32 v215, v215, v93, v94
    v_max_f32 v215, v215, v95
    v_mov_b32 v220, v212
    s_nop 1
    v_permlane16_swap_b32 v212, v220
    v_max_f32 v212, v212, v220
    v_mov_b32 v220, v212
    s_nop 1
    v_permlane32_swap_b32 v212, v220
    v_max_f32 v212, v212, v220
    v_mov_b32 v221, v213
    s_nop 1
    v_permlane16_swap_b32 v213, v221
    v_max_f32 v213, v213, v221
    v_mov_b32 v221, v213
    s_nop 1
    v_permlane32_swap_b32 v213, v221
    v_max_f32 v213, v213, v221
    v_mov_b32 v222, v214
    s_nop 1
    v_permlane16_swap_b32 v214, v222
    v_max_f32 v214, v214, v222
    v_mov_b32 v222, v214
    s_nop 1
    v_permlane32_swap_b32 v214, v222
    v_max_f32 v214, v214, v222
    v_mov_b32 v223, v215
    s_nop 1
    v_permlane16_swap_b32 v215, v223
    v_max_f32 v215, v215, v223
    v_mov_b32 v223, v215
    s_nop 1
    v_permlane32_swap_b32 v215, v223
    v_max_f32 v215, v215, v223
    v_sub_f32 v160, 0xc2b60000, v212
    v_sub_f32 v161, 0xc2b60000, v212
    v_sub_f32 v162, 0xc2b60000, v212
    v_sub_f32 v163, 0xc2b60000, v212
    v_sub_f32 v164, 0xc2b60000, v213
    v_sub_f32 v165, 0xc2b60000, v213
    v_sub_f32 v166, 0xc2b60000, v213
    v_sub_f32 v167, 0xc2b60000, v213
    v_sub_f32 v168, 0xc2b60000, v214
    v_sub_f32 v169, 0xc2b60000, v214
    v_sub_f32 v170, 0xc2b60000, v214
    v_sub_f32 v171, 0xc2b60000, v214
    v_sub_f32 v172, 0xc2b60000, v215
    v_sub_f32 v173, 0xc2b60000, v215
    v_sub_f32 v174, 0xc2b60000, v215
    v_sub_f32 v175, 0xc2b60000, v215
L2_havem:
    v_mov_b32 v220, 0x40000000
    s_nop 6
    v_add_f32 v64, v64, v160
    v_add_f32 v65, v65, v161
    v_add_f32 v66, v66, v162
    v_add_f32 v67, v67, v163
    v_add_f32 v80, v80, v160
    v_add_f32 v81, v81, v161
    v_add_f32 v82, v82, v162
    v_add_f32 v83, v83, v163
    v_add_f32 v68, v68, v164
    v_add_f32 v69, v69, v165
    v_add_f32 v70, v70, v166
    v_add_f32 v71, v71, v167
    v_add_f32 v84, v84, v164
    v_add_f32 v85, v85, v165
    v_add_f32 v86, v86, v166
    v_add_f32 v87, v87, v167
    v_add_f32 v72, v72, v168
    v_add_f32 v73, v73, v169
    v_add_f32 v74, v74, v170
    v_add_f32 v75, v75, v171
    v_add_f32 v88, v88, v168
    v_add_f32 v89, v89, v169
    v_add_f32 v90, v90, v170
    v_add_f32 v91, v91, v171
    v_add_f32 v76, v76, v172
    v_add_f32 v77, v77, v173
    v_add_f32 v78, v78, v174
    v_add_f32 v79, v79, v175
    v_add_f32 v92, v92, v172
    v_add_f32 v93, v93, v173
    v_add_f32 v94, v94, v174
    v_add_f32 v95, v95, v175
    s_waitcnt lgkmcnt(0)
    s_barrier
    v_mfma_f32_16x16x32_bf16 v[96:99], a[128:131], v[0:3], v[160:163]
    v_exp_f32 v64, v64
    v_exp_f32 v65, v65
    v_mfma_f32_16x16x32_bf16 v[100:103], a[128:131], v[4:7], v[164:167]
    v_exp_f32 v66, v66
    v_mfma_f32_16x16x32_bf16 v[104:107], a[128:131], v[8:11], v[168:171]
    v_cvt_pk_bf16_f32 v128, v64, v65
    v_exp_f32 v67, v67
    v_mfma_f32_16x16x32_bf16 v[108:111], a[128:131], v[12:15], v[172:175]
    ds_read_b128 a[128:131], v180 offset:16384
    v_exp_f32 v80, v80
    v_mfma_f32_16x16x32_bf16 v[112:115], a[132:135], v[0:3], v[160:163]
    v_cvt_pk_bf16_f32 v129, v66, v67
    v_exp_f32 v81, v81
    v_mfma_f32_16x16x32_bf16 v[116:119], a[132:135], v[4:7], v[164:167]
    v_exp_f32 v82, v82
    v_cvt_pk_bf16_f32 v130, v80, v81
    v_mfma_f32_16x16x32_bf16 v[120:123], a[132:135], v[8:11], v[168:171]
    v_exp_f32 v83, v83
    v_exp_f32 v68, v68
    v_mfma_f32_16x16x32_bf16 v[124:127], a[132:135], v[12:15], v[172:175]
    ds_read_b128 a[132:135], v180 offset:20480
    v_cvt_pk_bf16_f32 v131, v82, v83
    v_mfma_f32_16x16x32_bf16 v[96:99], a[136:139], v[16:19], v[96:99]
    v_exp_f32 v69, v69
    v_exp_f32 v70, v70
    v_mfma_f32_16x16x32_bf16 v[100:103], a[136:139], v[20:23], v[100:103]
    v_cvt_pk_bf16_f32 v132, v68, v69
    v_exp_f32 v71, v71
    v_mfma_f32_16x16x32_bf16 v[104:107], a[136:139], v[24:27], v[104:107]
    v_exp_f32 v84, v84
    v_mfma_f32_16x16x32_bf16 v[108:111], a[136:139], v[28:31], v[108:111]
    ds_read_b128 a[136:139], v181 offset:16384
    v_cvt_pk_bf16_f32 v133, v70, v71
    v_exp_f32 v85, v85
    v_mfma_f32_16x16x32_bf16 v[112:115], a[140:143], v[16:19], v[112:115]
    v_exp_f32 v86, v86
    v_mfma_f32_16x16x32_bf16 v[116:119], a[140:143], v[20:23], v[116:119]
    v_cvt_pk_bf16_f32 v134, v84, v85
    v_exp_f32 v87, v87
    v_mfma_f32_16x16x32_bf16 v[120:123], a[140:143], v[24:27], v[120:123]
    v_exp_f32 v72, v72
    v_cvt_pk_bf16_f32 v135, v86, v87
    v_mfma_f32_16x16x32_bf16 v[124:127], a[140:143], v[28:31], v[124:127]
    ds_read_b128 a[140:143], v181 offset:20480
    v_exp_f32 v73, v73
    v_mfma_f32_16x16x32_bf16 v[96:99], a[144:147], v[32:35], v[96:99]
    v_exp_f32 v74, v74
    v_cvt_pk_bf16_f32 v136, v72, v73
    v_mfma_f32_16x16x32_bf16 v[100:103], a[144:147], v[36:39], v[100:103]
    s_add_u32 m0, s45, 0x1a000
    s_nop 0
    buffer_load_dwordx4 v194, s[12:15], s48 offen lds
    v_exp_f32 v75, v75
    v_mfma_f32_16x16x32_bf16 v[104:107], a[144:147], v[40:43], v[104:107]
    v_exp_f32 v88, v88
    v_mfma_f32_16x16x32_bf16 v[108:111], a[144:147], v[44:47], v[108:111]
    ds_read_b128 a[144:147], v182 offset:16384
    buffer_load_dwordx4 v195, s[12:15], s48 offen offset:1024 lds
    s_add_u32 s48, s48, 8192
    v_mfma_f32_16x16x32_bf16 v[112:115], a[148:151], v[32:35], v[112:115]
    v_cvt_pk_bf16_f32 v137, v74, v75
    v_exp_f32 v89, v89
    v_mfma_f32_16x16x32_bf16 v[116:119], a[148:151], v[36:39], v[116:119]
    v_exp_f32 v90, v90
    v_cvt_pk_bf16_f32 v138, v88, v89
    v_mfma_f32_16x16x32_bf16 v[120:123], a[148:151], v[40:43], v[120:123]
    v_exp_f32 v91, v91
    v_exp_f32 v76, v76
    v_mfma_f32_16x16x32_bf16 v[124:127], a[148:151], v[44:47], v[124:127]
    ds_read_b128 a[148:151], v182 offset:20480
    v_cvt_pk_bf16_f32 v139, v90, v91
    v_mfma_f32_16x16x32_bf16 v[96:99], a[152:155], v[48:51], v[96:99]
    v_exp_f32 v77, v77
    v_exp_f32 v78, v78
    v_mfma_f32_16x16x32_bf16 v[100:103], a[152:155], v[52:55], v[100:103]
    s_add_u32 m0, s45, 0x0
    s_nop 0
    buffer_load_dwordx4 v192, s[8:11], s47 offen lds
    v_mfma_f32_16x16x32_bf16 v[104:107], a[152:155], v[56:59], v[104:107]
    v_cvt_pk_bf16_f32 v140, v76, v77
    v_exp_f32 v79, v79
    v_mfma_f32_16x16x32_bf16 v[108:111], a[152:155], v[60:63], v[108:111]
    ds_read_b128 a[152:155], v183 offset:16384
    buffer_load_dwordx4 v193, s[8:11], s47 offen offset:1024 lds
    s_add_u32 s47, s47, 8192
    v_mfma_f32_16x16x32_bf16 v[112:115], a[156:159], v[48:51], v[112:115]
    v_exp_f32 v92, v92
    v_cvt_pk_bf16_f32 v141, v78, v79
    v_mfma_f32_16x16x32_bf16 v[116:119], a[156:159], v[52:55], v[116:119]
    v_exp_f32 v93, v93
    v_exp_f32 v94, v94
    v_mfma_f32_16x16x32_bf16 v[120:123], a[156:159], v[56:59], v[120:123]
    v_cvt_pk_bf16_f32 v142, v92, v93
    v_exp_f32 v95, v95
    v_mfma_f32_16x16x32_bf16 v[124:127], a[156:159], v[60:63], v[124:127]
    ds_read_b128 a[156:159], v183 offset:20480
    v_cvt_pk_bf16_f32 v143, v94, v95
    s_waitcnt lgkmcnt(0)
    s_mov_b32 s49, 0
    v_mfma_f32_16x16x32_bf16 v[64:67], a[128:131], v[0:3], v[160:163]
    v_exp_f32 v96, v96
    v_mfma_f32_16x16x32_bf16 v[64:67], a[136:139], v[16:19], v[64:67]
    ds_read_b64_tr_b16 a[160:161], v184 offset:0
    ds_read_b64_tr_b16 a[162:163], v184 offset:4096
    v_mfma_f32_16x16x32_bf16 v[64:67], a[144:147], v[32:35], v[64:67]
    v_exp_f32 v97, v97
    v_mfma_f32_16x16x32_bf16 v[64:67], a[152:155], v[48:51], v[64:67]
    ds_read_b64_tr_b16 a[164:165], v185 offset:0
    ds_read_b64_tr_b16 a[166:167], v185 offset:4096
    v_mfma_f32_16x16x32_bf16 v[68:71], a[128:131], v[4:7], v[164:167]
    v_exp_f32 v98, v98
    v_mfma_f32_16x16x32_bf16 v[68:71], a[136:139], v[20:23], v[68:71]
    ds_read_b64_tr_b16 a[168:169], v186 offset:0
    ds_read_b64_tr_b16 a[170:171], v186 offset:4096
    v_mfma_f32_16x16x32_bf16 v[68:71], a[144:147], v[36:39], v[68:71]
    v_exp_f32 v99, v99
    v_mfma_f32_16x16x32_bf16 v[68:71], a[152:155], v[52:55], v[68:71]
    ds_read_b64_tr_b16 a[172:173], v187 offset:0
    ds_read_b64_tr_b16 a[174:175], v187 offset:4096
    v_mfma_f32_16x16x32_bf16 v[72:75], a[128:131], v[8:11], v[168:171]
    v_exp_f32 v112, v112
    v_mfma_f32_16x16x32_bf16 v[72:75], a[136:139], v[24:27], v[72:75]
    ds_read_b64_tr_b16 a[176:177], v188 offset:0
    ds_read_b64_tr_b16 a[178:179], v188 offset:4096
    v_mfma_f32_16x16x32_bf16 v[72:75], a[144:147], v[40:43], v[72:75]
    v_exp_f32 v113, v113
    v_mfma_f32_16x16x32_bf16 v[72:75], a[152:155], v[56:59], v[72:75]
    ds_read_b64_tr_b16 a[180:181], v189 offset:0
    ds_read_b64_tr_b16 a[182:183], v189 offset:4096
    v_mfma_f32_16x16x32_bf16 v[76:79], a[128:131], v[12:15], v[172:175]
    v_exp_f32 v114, v114
    v_mfma_f32_16x16x32_bf16 v[76:79], a[136:139], v[28:31], v[76:79]
    ds_read_b64_tr_b16 a[184:185], v190 offset:0
    ds_read_b64_tr_b16 a[186:187], v190 offset:4096
    v_mfma_f32_16x16x32_bf16 v[76:79], a[144:147], v[44:47], v[76:79]
    v_exp_f32 v115, v115
    v_mfma_f32_16x16x32_bf16 v[76:79], a[152:155], v[60:63], v[76:79]
    ds_read_b64_tr_b16 a[188:189], v191 offset:0
    ds_read_b64_tr_b16 a[190:191], v191 offset:4096
    v_mfma_f32_16x16x32_bf16 v[80:83], a[132:135], v[0:3], v[160:163]
    v_exp_f32 v100, v100
    v_mfma_f32_16x16x32_bf16 v[80:83], a[140:143], v[16:19], v[80:83]
    v_cvt_pk_bf16_f32 v144, v96, v97
    v_cvt_pk_bf16_f32 v145, v98, v99
    v_mfma_f32_16x16x32_bf16 v[80:83], a[148:151], v[32:35], v[80:83]
    v_exp_f32 v101, v101
    v_mfma_f32_16x16x32_bf16 v[80:83], a[156:159], v[48:51], v[80:83]
    v_cvt_pk_bf16_f32 v146, v112, v113
    v_cvt_pk_bf16_f32 v147, v114, v115
    v_mfma_f32_16x16x32_bf16 v[84:87], a[132:135], v[4:7], v[164:167]
    v_exp_f32 v102, v102
    v_mfma_f32_16x16x32_bf16 v[84:87], a[140:143], v[20:23], v[84:87]
    v_cvt_pk_bf16_f32 v148, v100, v101
    v_mfma_f32_16x16x32_bf16 v[84:87], a[148:151], v[36:39], v[84:87]
    s_add_u32 m0, s45, 0x1c000
    v_exp_f32 v103, v103
    v_mfma_f32_16x16x32_bf16 v[84:87], a[156:159], v[52:55], v[84:87]
    v_cvt_pk_bf16_f32 v149, v102, v103
    v_mfma_f32_16x16x32_bf16 v[88:91], a[132:135], v[8:11], v[168:171]
    v_exp_f32 v116, v116
    v_mfma_f32_16x16x32_bf16 v[88:91], a[140:143], v[24:27], v[88:91]
    buffer_load_dwordx4 v194, s[12:15], s48 offen lds
    v_mfma_f32_16x16x32_bf16 v[88:91], a[148:151], v[40:43], v[88:91]
    v_exp_f32 v117, v117
    v_mfma_f32_16x16x32_bf16 v[88:91], a[156:159], v[56:59], v[88:91]
    v_cvt_pk_bf16_f32 v150, v116, v117
    v_mfma_f32_16x16x32_bf16 v[92:95], a[132:135], v[12:15], v[172:175]
    v_exp_f32 v118, v118
    v_mfma_f32_16x16x32_bf16 v[92:95], a[140:143], v[28:31], v[92:95]
    buffer_load_dwordx4 v195, s[12:15], s48 offen offset:1024 lds
    v_mfma_f32_16x16x32_bf16 v[92:95], a[148:151], v[44:47], v[92:95]
    s_add_u32 s48, s48, 8192
    v_exp_f32 v119, v119
    v_mfma_f32_16x16x32_bf16 v[92:95], a[156:159], v[60:63], v[92:95]
    v_cvt_pk_bf16_f32 v151, v118, v119
    v_smfmac_f32_16x16x64_bf16 v[228:231], v[176:179], v[128:135], v238
    v_exp_f32 v104, v104
    v_smfmac_f32_16x16x64_bf16 v[232:235], v[176:179], v[136:143], v238
    s_waitcnt lgkmcnt(0)
    v_mfma_f32_16x16x32_bf16 a[0:3], a[160:163], v[128:131], 0
    v_exp_f32 v105, v105
    v_mfma_f32_16x16x32_bf16 a[16:19], a[164:167], v[128:131], 0
    ds_read_b128 a[128:131], v180 offset:24576
    ds_read_b128 a[132:135], v180 offset:28672
    v_mfma_f32_16x16x32_bf16 a[4:7], a[160:163], v[132:135], 0
    v_exp_f32 v106, v106
    v_mfma_f32_16x16x32_bf16 a[20:23], a[164:167], v[132:135], 0
    ds_read_b128 a[136:139], v181 offset:24576
    ds_read_b128 a[140:143], v181 offset:28672
    v_mfma_f32_16x16x32_bf16 a[8:11], a[160:163], v[136:139], 0
    v_exp_f32 v107, v107
    v_mfma_f32_16x16x32_bf16 a[24:27], a[164:167], v[136:139], 0
    ds_read_b128 a[144:147], v182 offset:24576
    ds_read_b128 a[148:151], v182 offset:28672
    v_mfma_f32_16x16x32_bf16 a[12:15], a[160:163], v[140:143], 0
    v_exp_f32 v120, v120
    v_mfma_f32_16x16x32_bf16 a[28:31], a[164:167], v[140:143], 0
    ds_read_b128 a[152:155], v183 offset:24576
    ds_read_b128 a[156:159], v183 offset:28672
    v_mfma_f32_16x16x32_bf16 a[32:35], a[168:171], v[128:131], 0
    v_exp_f32 v121, v121
    v_mfma_f32_16x16x32_bf16 a[48:51], a[172:175], v[128:131], 0
    v_cvt_pk_bf16_f32 v152, v104, v105
    v_cvt_pk_bf16_f32 v153, v106, v107
    v_mfma_f32_16x16x32_bf16 a[36:39], a[168:171], v[132:135], 0
    v_exp_f32 v122, v122
    v_mfma_f32_16x16x32_bf16 a[52:55], a[172:175], v[132:135], 0
    v_cvt_pk_bf16_f32 v154, v120, v121
    v_mfma_f32_16x16x32_bf16 a[40:43], a[168:171], v[136:139], 0
    s_add_u32 m0, s45, 0x2000
    v_exp_f32 v123, v123
    v_mfma_f32_16x16x32_bf16 a[56:59], a[172:175], v[136:139], 0
    v_cvt_pk_bf16_f32 v155, v122, v123
    v_mfma_f32_16x16x32_bf16 a[44:47], a[168:171], v[140:143], 0
    v_exp_f32 v108, v108
    v_mfma_f32_16x16x32_bf16 a[60:63], a[172:175], v[140:143], 0
    buffer_load_dwordx4 v192, s[8:11], s47 offen lds
    v_mfma_f32_16x16x32_bf16 a[64:67], a[176:179], v[128:131], 0
    v_exp_f32 v109, v109
    v_mfma_f32_16x16x32_bf16 a[80:83], a[180:183], v[128:131], 0
    v_cvt_pk_bf16_f32 v156, v108, v109
    v_mfma_f32_16x16x32_bf16 a[68:71], a[176:179], v[132:135], 0
    v_exp_f32 v110, v110
    v_mfma_f32_16x16x32_bf16 a[84:87], a[180:183], v[132:135], 0
    buffer_load_dwordx4 v193, s[8:11], s47 offen offset:1024 lds
    v_mfma_f32_16x16x32_bf16 a[72:75], a[176:179], v[136:139], 0
    s_add_u32 s47, s47, 8192
    v_exp_f32 v111, v111
    v_mfma_f32_16x16x32_bf16 a[88:91], a[180:183], v[136:139], 0
    v_cvt_pk_bf16_f32 v157, v110, v111
    v_mfma_f32_16x16x32_bf16 a[76:79], a[176:179], v[140:143], 0
    v_exp_f32 v124, v124
    v_mfma_f32_16x16x32_bf16 a[92:95], a[180:183], v[140:143], 0
    v_mfma_f32_16x16x32_bf16 a[96:99], a[184:187], v[128:131], 0
    v_exp_f32 v125, v125
    v_mfma_f32_16x16x32_bf16 a[112:115], a[188:191], v[128:131], 0
    v_cvt_pk_bf16_f32 v158, v124, v125
    v_mfma_f32_16x16x32_bf16 a[100:103], a[184:187], v[132:135], 0
    v_exp_f32 v126, v126
    v_mfma_f32_16x16x32_bf16 a[116:119], a[188:191], v[132:135], 0
    v_mfma_f32_16x16x32_bf16 a[104:107], a[184:187], v[136:139], 0
    v_exp_f32 v127, v127
    v_mfma_f32_16x16x32_bf16 a[120:123], a[188:191], v[136:139], 0
    v_cvt_pk_bf16_f32 v159, v126, v127
    v_mfma_f32_16x16x32_bf16 a[108:111], a[184:187], v[140:143], 0
    v_mfma_f32_16x16x32_bf16 a[124:127], a[188:191], v[140:143], 0
    s_waitcnt vmcnt(16) lgkmcnt(0)
    s_barrier
    s_branch L2_loop2
L2_loop:
    v_mfma_f32_16x16x32_bf16 v[64:67], a[128:131], v[0:3], v[160:163]
    v_exp_f32 v96, v96
    v_mfma_f32_16x16x32_bf16 v[64:67], a[136:139], v[16:19], v[64:67]
    ds_read_b64_tr_b16 a[160:161], v184 offset:0
    ds_read_b64_tr_b16 a[162:163], v184 offset:4096
    v_mfma_f32_16x16x32_bf16 v[64:67], a[144:147], v[32:35], v[64:67]
L_it6:
    s_cbranch_execz L_it10
    v_exp_f32 v97, v97
    v_mfma_f32_16x16x32_bf16 v[64:67], a[152:155], v[48:51], v[64:67]
    ds_read_b64_tr_b16 a[164:165], v185 offset:0
    ds_read_b64_tr_b16 a[166:167], v185 offset:4096
    v_mfma_f32_16x16x32_bf16 v[68:71], a[128:131], v[4:7], v[164:167]
    v_exp_f32 v98, v98
    v_mfma_f32_16x16x32_bf16 v[68:71], a[136:139], v[20:23], v[68:71]
    ds_read_b64_tr_b16 a[168:169], v186 offset:0
    ds_read_b64_tr_b16 a[170:171], v186 offset:4096
    v_mfma_f32_16x16x32_bf16 v[68:71], a[144:147], v[36:39], v[68:71]
    v_exp_f32 v99, v99
    v_mfma_f32_16x16x32_bf16 v[68:71], a[152:155], v[52:55], v[68:71]
    ds_read_b64_tr_b16 a[172:173], v187 offset:0
    ds_read_b64_tr_b16 a[174:175], v187 offset:4096
    v_mfma_f32_16x16x32_bf16 v[72:75], a[128:131], v[8:11], v[168:171]
    v_exp_f32 v112, v112
    v_mfma_f32_16x16x32_bf16 v[72:75], a[136:139], v[24:27], v[72:75]
    ds_read_b64_tr_b16 a[176:177], v188 offset:0
    ds_read_b64_tr_b16 a[178:179], v188 offset:4096
    v_mfma_f32_16x16x32_bf16 v[72:75], a[144:147], v[40:43], v[72:75]
    v_exp_f32 v113, v113
    v_mfma_f32_16x16x32_bf16 v[72:75], a[152:155], v[56:59], v[72:75]
    ds_read_b64_tr_b16 a[180:181], v189 offset:0
    ds_read_b64_tr_b16 a[182:183], v189 offset:4096
    v_mfma_f32_16x16x32_bf16 v[76:79], a[128:131], v[12:15], v[172:175]
    v_exp_f32 v114, v114
    v_mfma_f32_16x16x32_bf16 v[76:79], a[136:139], v[28:31], v[76:79]
    ds_read_b64_tr_b16 a[184:185], v190 offset:0
    ds_read_b64_tr_b16 a[186:187], v190 offset:4096
    v_mfma_f32_16x16x32_bf16 v[76:79], a[144:147], v[44:47], v[76:79]
    v_exp_f32 v115, v115
    v_mfma_f32_16x16x32_bf16 v[76:79], a[152:155], v[60:63], v[76:79]
    ds_read_b64_tr_b16 a[188:189], v191 offset:0
    ds_read_b64_tr_b16 a[190:191], v191 offset:4096
    v_mfma_f32_16x16x32_bf16 v[80:83], a[132:135], v[0:3], v[160:163]
    v_exp_f32 v100, v100
    v_mfma_f32_16x16x32_bf16 v[80:83], a[140:143], v[16:19], v[80:83]
    v_cvt_pk_bf16_f32 v144, v96, v97
    v_cvt_pk_bf16_f32 v145, v98, v99
    v_mfma_f32_16x16x32_bf16 v[80:83], a[148:151], v[32:35], v[80:83]
    v_exp_f32 v101, v101
    v_mfma_f32_16x16x32_bf16 v[80:83], a[156:159], v[48:51], v[80:83]
    v_cvt_pk_bf16_f32 v146, v112, v113
    v_cvt_pk_bf16_f32 v147, v114, v115
    v_mfma_f32_16x16x32_bf16 v[84:87], a[132:135], v[4:7], v[164:167]
    v_exp_f32 v102, v102
    v_mfma_f32_16x16x32_bf16 v[84:87], a[140:143], v[20:23], v[84:87]
    v_cvt_pk_bf16_f32 v148, v100, v101
    v_mfma_f32_16x16x32_bf16 v[84:87], a[148:151], v[36:39], v[84:87]
    s_add_u32 m0, s45, 0x1c000
    v_exp_f32 v103, v103
    v_mfma_f32_16x16x32_bf16 v[84:87], a[156:159], v[52:55], v[84:87]
    v_cvt_pk_bf16_f32 v149, v102, v103
    v_mfma_f32_16x16x32_bf16 v[88:91], a[132:135], v[8:11], v[168:171]
    v_exp_f32 v116, v116
    v_mfma_f32_16x16x32_bf16 v[88:91], a[140:143], v[24:27], v[88:91]
    buffer_load_dwordx4 v194, s[12:15], s48 offen lds
    v_mfma_f32_16x16x32_bf16 v[88:91], a[148:151], v[40:43], v[88:91]
    v_exp_f32 v117, v117
    v_mfma_f32_16x16x32_bf16 v[88:91], a[156:159], v[56:59], v[88:91]
    v_cvt_pk_bf16_f32 v150, v116, v117
    v_mfma_f32_16x16x32_bf16 v[92:95], a[132:135], v[12:15], v[172:175]
    v_exp_f32 v118, v118
    v_mfma_f32_16x16x32_bf16 v[92:95], a[140:143], v[28:31], v[92:95]
    buffer_load_dwordx4 v195, s[12:15], s48 offen offset:1024 lds
    v_mfma_f32_16x16x32_bf16 v[92:95], a[148:151], v[44:47], v[92:95]
    s_add_u32 s48, s48, 8192
    v_exp_f32 v119, v119
    v_mfma_f32_16x16x32_bf16 v[92:95], a[156:159], v[60:63], v[92:95]
    v_cvt_pk_bf16_f32 v151, v118, v119
    v_smfmac_f32_16x16x64_bf16 v[228:231], v[176:179], v[128:135], v238
    v_exp_f32 v104, v104
    v_smfmac_f32_16x16x64_bf16 v[232:235], v[176:179], v[136:143], v238
    s_waitcnt lgkmcnt(0)
    v_mfma_f32_16x16x32_bf16 a[0:3], a[160:163], v[128:131], a[0:3]
    v_exp_f32 v105, v105
    v_mfma_f32_16x16x32_bf16 a[16:19], a[164:167], v[128:131], a[16:19]
    ds_read_b128 a[128:131], v180 offset:24576
    ds_read_b128 a[132:135], v180 offset:28672
    v_mfma_f32_16x16x32_bf16 a[4:7], a[160:163], v[132:135], a[4:7]
    v_exp_f32 v106, v106
    v_mfma_f32_16x16x32_bf16 a[20:23], a[164:167], v[132:135], a[20:23]
    ds_read_b128 a[136:139], v181 offset:24576
    ds_read_b128 a[140:143], v181 offset:28672
    v_mfma_f32_16x16x32_bf16 a[8:11], a[160:163], v[136:139], a[8:11]
    v_exp_f32 v107, v107
    v_mfma_f32_16x16x32_bf16 a[24:27], a[164:167], v[136:139], a[24:27]
    ds_read_b128 a[144:147], v182 offset:24576
    ds_read_b128 a[148:151], v182 offset:28672
    v_mfma_f32_16x16x32_bf16 a[12:15], a[160:163], v[140:143], a[12:15]
    v_exp_f32 v120, v120
    v_mfma_f32_16x16x32_bf16 a[28:31], a[164:167], v[140:143], a[28:31]
    ds_read_b128 a[152:155], v183 offset:24576
    ds_read_b128 a[156:159], v183 offset:28672
    v_mfma_f32_16x16x32_bf16 a[32:35], a[168:171], v[128:131], a[32:35]
    v_exp_f32 v121, v121
    v_mfma_f32_16x16x32_bf16 a[48:51], a[172:175], v[128:131], a[48:51]
    v_cvt_pk_bf16_f32 v152, v104, v105
    v_cvt_pk_bf16_f32 v153, v106, v107
    v_mfma_f32_16x16x32_bf16 a[36:39], a[168:171], v[132:135], a[36:39]
    v_exp_f32 v122, v122
    v_mfma_f32_16x16x32_bf16 a[52:55], a[172:175], v[132:135], a[52:55]
    v_cvt_pk_bf16_f32 v154, v120, v121
    v_mfma_f32_16x16x32_bf16 a[40:43], a[168:171], v[136:139], a[40:43]
    s_add_u32 m0, s45, 0x2000
    v_exp_f32 v123, v123
    v_mfma_f32_16x16x32_bf16 a[56:59], a[172:175], v[136:139], a[56:59]
    v_cvt_pk_bf16_f32 v155, v122, v123
    v_mfma_f32_16x16x32_bf16 a[44:47], a[168:171], v[140:143], a[44:47]
    v_exp_f32 v108, v108
    v_mfma_f32_16x16x32_bf16 a[60:63], a[172:175], v[140:143], a[60:63]
    buffer_load_dwordx4 v192, s[8:11], s47 offen lds
    v_mfma_f32_16x16x32_bf16 a[64:67], a[176:179], v[128:131], a[64:67]
    v_exp_f32 v109, v109
    v_mfma_f32_16x16x32_bf16 a[80:83], a[180:183], v[128:131], a[80:83]
    v_cvt_pk_bf16_f32 v156, v108, v109
    v_mfma_f32_16x16x32_bf16 a[68:71], a[176:179], v[132:135], a[68:71]
    v_exp_f32 v110, v110
    v_mfma_f32_16x16x32_bf16 a[84:87], a[180:183], v[132:135], a[84:87]
    buffer_load_dwordx4 v193, s[8:11], s47 offen offset:1024 lds
    v_mfma_f32_16x16x32_bf16 a[72:75], a[176:179], v[136:139], a[72:75]
    s_add_u32 s47, s47, 8192
    v_exp_f32 v111, v111
    v_mfma_f32_16x16x32_bf16 a[88:91], a[180:183], v[136:139], a[88:91]
    v_cvt_pk_bf16_f32 v157, v110, v111
    v_mfma_f32_16x16x32_bf16 a[76:79], a[176:179], v[140:143], a[76:79]
    v_exp_f32 v124, v124
    v_mfma_f32_16x16x32_bf16 a[92:95], a[180:183], v[140:143], a[92:95]
    v_mfma_f32_16x16x32_bf16 a[96:99], a[184:187], v[128:131], a[96:99]
    v_exp_f32 v125, v125
    v_mfma_f32_16x16x32_bf16 a[112:115], a[188:191], v[128:131], a[112:115]
    v_cvt_pk_bf16_f32 v158, v124, v125
    v_mfma_f32_16x16x32_bf16 a[100:103], a[184:187], v[132:135], a[100:103]
    v_exp_f32 v126, v126
    v_mfma_f32_16x16x32_bf16 a[116:119], a[188:191], v[132:135], a[116:119]
    v_mfma_f32_16x16x32_bf16 a[104:107], a[184:187], v[136:139], a[104:107]
    v_exp_f32 v127, v127
    v_mfma_f32_16x16x32_bf16 a[120:123], a[188:191], v[136:139], a[120:123]
    v_cvt_pk_bf16_f32 v159, v126, v127
    v_mfma_f32_16x16x32_bf16 a[108:111], a[184:187], v[140:143], a[108:111]
    v_mfma_f32_16x16x32_bf16 a[124:127], a[188:191], v[140:143], a[124:127]
    s_waitcnt vmcnt(16) lgkmcnt(0)
    s_barrier
L2_loop2:
    v_mfma_f32_16x16x32_bf16 v[96:99], a[128:131], v[0:3], v[160:163]
    v_exp_f32 v64, v64
    v_mfma_f32_16x16x32_bf16 v[96:99], a[136:139], v[16:19], v[96:99]
    ds_read_b64_tr_b16 a[160:161], v184 offset:8192
    ds_read_b64_tr_b16 a[162:163], v184 offset:12288
    v_mfma_f32_16x16x32_bf16 v[96:99], a[144:147], v[32:35], v[96:99]
    s_bitcmp1_b32 s6, s49
    v_exp_f32 v65, v65
    v_mfma_f32_16x16x32_bf16 v[96:99], a[152:155], v[48:51], v[96:99]
    ds_read_b64_tr_b16 a[164:165], v185 offset:8192
    ds_read_b64_tr_b16 a[166:167], v185 offset:12288
    v_mfma_f32_16x16x32_bf16 v[100:103], a[128:131], v[4:7], v[164:167]
    s_cbranch_scc1 L2_dosa
L2_retsa:
    v_exp_f32 v66, v66
    v_mfma_f32_16x16x32_bf16 v[100:103], a[136:139], v[20:23], v[100:103]
    ds_read_b64_tr_b16 a[168:169], v186 offset:8192
    ds_read_b64_tr_b16 a[170:171], v186 offset:12288
    v_mfma_f32_16x16x32_bf16 v[100:103], a[144:147], v[36:39], v[100:103]
    v_exp_f32 v67, v67
    v_mfma_f32_16x16x32_bf16 v[100:103], a[152:155], v[52:55], v[100:103]
    ds_read_b64_tr_b16 a[172:173], v187 offset:8192
    ds_read_b64_tr_b16 a[174:175], v187 offset:12288
    v_mfma_f32_16x16x32_bf16 v[104:107], a[128:131], v[8:11], v[168:171]
    v_exp_f32 v80, v80
    v_mfma_f32_16x16x32_bf16 v[104:107], a[136:139], v[24:27], v[104:107]
    ds_read_b64_tr_b16 a[176:177], v188 offset:8192
    ds_read_b64_tr_b16 a[178:179], v188 offset:12288
    v_mfma_f32_16x16x32_bf16 v[104:107], a[144:147], v[40:43], v[104:107]
    v_exp_f32 v81, v81
    v_mfma_f32_16x16x32_bf16 v[104:107], a[152:155], v[56:59], v[104:107]
    ds_read_b64_tr_b16 a[180:181], v189 offset:8192
    ds_read_b64_tr_b16 a[182:183], v189 offset:12288
    v_mfma_f32_16x16x32_bf16 v[108:111], a[128:131], v[12:15], v[172:175]
    v_exp_f32 v82, v82
    v_mfma_f32_16x16x32_bf16 v[108:111], a[136:139], v[28:31], v[108:111]
    ds_read_b64_tr_b16 a[184:185], v190 offset:8192
    ds_read_b64_tr_b16 a[186:187], v190 offset:12288
    v_mfma_f32_16x16x32_bf16 v[108:111], a[144:147], v[44:47], v[108:111]
    v_exp_f32 v83, v83
    v_mfma_f32_16x16x32_bf16 v[108:111], a[152:155], v[60:63], v[108:111]
    ds_read_b64_tr_b16 a[188:189], v191 offset:8192
    ds_read_b64_tr_b16 a[190:191], v191 offset:12288
    v_mfma_f32_16x16x32_bf16 v[112:115], a[132:135], v[0:3], v[160:163]
    v_exp_f32 v68, v68
    v_mfma_f32_16x16x32_bf16 v[112:115], a[140:143], v[16:19], v[112:115]
    v_cvt_pk_bf16_f32 v128, v64, v65
    v_cvt_pk_bf16_f32 v129, v66, v67
    v_mfma_f32_16x16x32_bf16 v[112:115], a[148:151], v[32:35], v[112:115]
    v_exp_f32 v69, v69
    v_mfma_f32_16x16x32_bf16 v[112:115], a[156:159], v[48:51], v[112:115]
    v_cvt_pk_bf16_f32 v130, v80, v81
    v_cvt_pk_bf16_f32 v131, v82, v83
    v_mfma_f32_16x16x32_bf16 v[116:119], a[132:135], v[4:7], v[164:167]
    v_exp_f32 v70, v70
    v_mfma_f32_16x16x32_bf16 v[116:119], a[140:143], v[20:23], v[116:119]
    v_cvt_pk_bf16_f32 v132, v68, v69
    v_mfma_f32_16x16x32_bf16 v[116:119], a[148:151], v[36:39], v[116:119]
    s_add_u32 m0, s45, 0x1e000
    v_exp_f32 v71, v71
    v_mfma_f32_16x16x32_bf16 v[116:119], a[156:159], v[52:55], v[116:119]
    v_cvt_pk_bf16_f32 v133, v70, v71
    v_mfma_f32_16x16x32_bf16 v[120:123], a[132:135], v[8:11], v[168:171]
    v_exp_f32 v84, v84
    v_mfma_f32_16x16x32_bf16 v[120:123], a[140:143], v[24:27], v[120:123]
    buffer_load_dwordx4 v194, s[12:15], s48 offen lds
    v_mfma_f32_16x16x32_bf16 v[120:123], a[148:151], v[40:43], v[120:123]
    v_exp_f32 v85, v85
    v_mfma_f32_16x16x32_bf16 v[120:123], a[156:159], v[56:59], v[120:123]
    v_cvt_pk_bf16_f32 v134, v84, v85
    v_mfma_f32_16x16x32_bf16 v[124:127], a[132:135], v[12:15], v[172:175]
    v_exp_f32 v86, v86
    v_mfma_f32_16x16x32_bf16 v[124:127], a[140:143], v[28:31], v[124:127]
    buffer_load_dwordx4 v195, s[12:15], s48 offen offset:1024 lds
    v_mfma_f32_16x16x32_bf16 v[124:127], a[148:151], v[44:47], v[124:127]
    s_add_u32 s48, s48, 8192
    v_exp_f32 v87, v87
    v_mfma_f32_16x16x32_bf16 v[124:127], a[156:159], v[60:63], v[124:127]
    v_cvt_pk_bf16_f32 v135, v86, v87
    v_smfmac_f32_16x16x64_bf16 v[228:231], v[176:179], v[144:151], v238
    v_exp_f32 v72, v72
    v_smfmac_f32_16x16x64_bf16 v[232:235], v[176:179], v[152:159], v238
    s_waitcnt lgkmcnt(0)
    v_mfma_f32_16x16x32_bf16 a[0:3], a[160:163], v[144:147], a[0:3]
    v_exp_f32 v73, v73
    v_mfma_f32_16x16x32_bf16 a[16:19], a[164:167], v[144:147], a[16:19]
    ds_read_b128 a[128:131], v180 offset:32768
    ds_read_b128 a[132:135], v180 offset:36864
    v_mfma_f32_16x16x32_bf16 a[4:7], a[160:163], v[148:151], a[4:7]
    v_exp_f32 v74, v74
    v_mfma_f32_16x16x32_bf16 a[20:23], a[164:167], v[148:151], a[20:23]
    ds_read_b128 a[136:139], v181 offset:32768
    ds_read_b128 a[140:143], v181 offset:36864
    v_mfma_f32_16x16x32_bf16 a[8:11], a[160:163], v[152:155], a[8:11]
    v_exp_f32 v75, v75
    v_mfma_f32_16x16x32_bf16 a[24:27], a[164:167], v[152:155], a[24:27]
    ds_read_b128 a[144:147], v182 offset:32768
    ds_read_b128 a[148:151], v182 offset:36864
    v_mfma_f32_16x16x32_bf16 a[12:15], a[160:163], v[156:159], a[12:15]
    v_exp_f32 v88, v88
    v_mfma_f32_16x16x32_bf16 a[28:31], a[164:167], v[156:159], a[28:31]
    ds_read_b128 a[152:155], v183 offset:32768
    ds_read_b128 a[156:159], v183 offset:36864
    v_mfma_f32_16x16x32_bf16 a[32:35], a[168:171], v[144:147], a[32:35]
    v_exp_f32 v89, v89
    v_mfma_f32_16x16x32_bf16 a[48:51], a[172:175], v[144:147], a[48:51]
    v_cvt_pk_bf16_f32 v136, v72, v73
    v_cvt_pk_bf16_f32 v137, v74, v75
    v_mfma_f32_16x16x32_bf16 a[36:39], a[168:171], v[148:151], a[36:39]
    v_exp_f32 v90, v90
    v_mfma_f32_16x16x32_bf16 a[52:55], a[172:175], v[148:151], a[52:55]
    v_cvt_pk_bf16_f32 v138, v88, v89
    v_mfma_f32_16x16x32_bf16 a[40:43], a[168:171], v[152:155], a[40:43]
    s_add_u32 m0, s45, 0x4000
    v_exp_f32 v91, v91
    v_mfma_f32_16x16x32_bf16 a[56:59], a[172:175], v[152:155], a[56:59]
    v_cvt_pk_bf16_f32 v139, v90, v91
    v_mfma_f32_16x16x32_bf16 a[44:47], a[168:171], v[156:159], a[44:47]
    v_exp_f32 v76, v76
    v_mfma_f32_16x16x32_bf16 a[60:63], a[172:175], v[156:159], a[60:63]
    buffer_load_dwordx4 v192, s[8:11], s47 offen lds
    v_mfma_f32_16x16x32_bf16 a[64:67], a[176:179], v[144:147], a[64:67]
    v_exp_f32 v77, v77
    v_mfma_f32_16x16x32_bf16 a[80:83], a[180:183], v[144:147], a[80:83]
    v_cvt_pk_bf16_f32 v140, v76, v77
    v_mfma_f32_16x16x32_bf16 a[68:71], a[176:179], v[148:151], a[68:71]
    v_exp_f32 v78, v78
    v_mfma_f32_16x16x32_bf16 a[84:87], a[180:183], v[148:151], a[84:87]
    buffer_load_dwordx4 v193, s[8:11], s47 offen offset:1024 lds
    v_mfma_f32_16x16x32_bf16 a[72:75], a[176:179], v[152:155], a[72:75]
    s_add_u32 s47, s47, 8192
    v_exp_f32 v79, v79
    v_mfma_f32_16x16x32_bf16 a[88:91], a[180:183], v[152:155], a[88:91]
    v_cvt_pk_bf16_f32 v141, v78, v79
    v_mfma_f32_16x16x32_bf16 a[76:79], a[176:179], v[156:159], a[76:79]
    v_exp_f32 v92, v92
    v_mfma_f32_16x16x32_bf16 a[92:95], a[180:183], v[156:159], a[92:95]
    v_mfma_f32_16x16x32_bf16 a[96:99], a[184:187], v[144:147], a[96:99]
    v_exp_f32 v93, v93
    v_mfma_f32_16x16x32_bf16 a[112:115], a[188:191], v[144:147], a[112:115]
    v_cvt_pk_bf16_f32 v142, v92, v93
    v_mfma_f32_16x16x32_bf16 a[100:103], a[184:187], v[148:151], a[100:103]
    v_exp_f32 v94, v94
    v_mfma_f32_16x16x32_bf16 a[116:119], a[188:191], v[148:151], a[116:119]
    v_mfma_f32_16x16x32_bf16 a[104:107], a[184:187], v[152:155], a[104:107]
    v_exp_f32 v95, v95
    v_mfma_f32_16x16x32_bf16 a[120:123], a[188:191], v[152:155], a[120:123]
    v_cvt_pk_bf16_f32 v143, v94, v95
    v_mfma_f32_16x16x32_bf16 a[108:111], a[184:187], v[156:159], a[108:111]
    v_mfma_f32_16x16x32_bf16 a[124:127], a[188:191], v[156:159], a[124:127]
    s_waitcnt lgkmcnt(0)
    v_mfma_f32_16x16x32_bf16 v[64:67], a[128:131], v[0:3], v[160:163]
    v_exp_f32 v96, v96
    v_mfma_f32_16x16x32_bf16 v[64:67], a[136:139], v[16:19], v[64:67]
    ds_read_b64_tr_b16 a[160:161], v184 offset:16384
    ds_read_b64_tr_b16 a[162:163], v184 offset:20480
    v_mfma_f32_16x16x32_bf16 v[64:67], a[144:147], v[32:35], v[64:67]
    s_cmp_eq_u32 s49, 7
    v_exp_f32 v97, v97
    v_mfma_f32_16x16x32_bf16 v[64:67], a[152:155], v[48:51], v[64:67]
    ds_read_b64_tr_b16 a[164:165], v185 offset:16384
    ds_read_b64_tr_b16 a[166:167], v185 offset:20480
    v_mfma_f32_16x16x32_bf16 v[68:71], a[128:131], v[4:7], v[164:167]
    s_cbranch_scc1 L2_dovsw
L2_retvsw:
    v_exp_f32 v98, v98
    v_mfma_f32_16x16x32_bf16 v[68:71], a[136:139], v[20:23], v[68:71]
    ds_read_b64_tr_b16 a[168:169], v186 offset:16384
    ds_read_b64_tr_b16 a[170:171], v186 offset:20480
    v_mfma_f32_16x16x32_bf16 v[68:71], a[144:147], v[36:39], v[68:71]
    v_exp_f32 v99, v99
    v_mfma_f32_16x16x32_bf16 v[68:71], a[152:155], v[52:55], v[68:71]
    ds_read_b64_tr_b16 a[172:173], v187 offset:16384
    ds_read_b64_tr_b16 a[174:175], v187 offset:20480
    v_mfma_f32_16x16x32_bf16 v[72:75], a[128:131], v[8:11], v[168:171]
    v_exp_f32 v112, v112
    v_mfma_f32_16x16x32_bf16 v[72:75], a[136:139], v[24:27], v[72:75]
    ds_read_b64_tr_b16 a[176:177], v188 offset:16384
    ds_read_b64_tr_b16 a[178:179], v188 offset:20480
    v_mfma_f32_16x16x32_bf16 v[72:75], a[144:147], v[40:43], v[72:75]
    v_exp_f32 v113, v113
    v_mfma_f32_16x16x32_bf16 v[72:75], a[152:155], v[56:59], v[72:75]
    ds_read_b64_tr_b16 a[180:181], v189 offset:16384
    ds_read_b64_tr_b16 a[182:183], v189 offset:20480
    v_mfma_f32_16x16x32_bf16 v[76:79], a[128:131], v[12:15], v[172:175]
    v_exp_f32 v114, v114
    v_mfma_f32_16x16x32_bf16 v[76:79], a[136:139], v[28:31], v[76:79]
    ds_read_b64_tr_b16 a[184:185], v190 offset:16384
    ds_read_b64_tr_b16 a[186:187], v190 offset:20480
    v_mfma_f32_16x16x32_bf16 v[76:79], a[144:147], v[44:47], v[76:79]
    v_exp_f32 v115, v115
    v_mfma_f32_16x16x32_bf16 v[76:79], a[152:155], v[60:63], v[76:79]
    ds_read_b64_tr_b16 a[188:189], v191 offset:16384
    ds_read_b64_tr_b16 a[190:191], v191 offset:20480
    v_mfma_f32_16x16x32_bf16 v[80:83], a[132:135], v[0:3], v[160:163]
    v_exp_f32 v100, v100
    v_mfma_f32_16x16x32_bf16 v[80:83], a[140:143], v[16:19], v[80:83]
    v_cvt_pk_bf16_f32 v144, v96, v97
    v_cvt_pk_bf16_f32 v145, v98, v99
    v_mfma_f32_16x16x32_bf16 v[80:83], a[148:151], v[32:35], v[80:83]
    v_exp_f32 v101, v101
    v_mfma_f32_16x16x32_bf16 v[80:83], a[156:159], v[48:51], v[80:83]
    v_cvt_pk_bf16_f32 v146, v112, v113
    v_cvt_pk_bf16_f32 v147, v114, v115
    v_mfma_f32_16x16x32_bf16 v[84:87], a[132:135], v[4:7], v[164:167]
    v_exp_f32 v102, v102
    v_mfma_f32_16x16x32_bf16 v[84:87], a[140:143], v[20:23], v[84:87]
    v_cvt_pk_bf16_f32 v148, v100, v101
    v_mfma_f32_16x16x32_bf16 v[84:87], a[148:151], v[36:39], v[84:87]
    s_add_u32 m0, s45, 0x10000
    v_exp_f32 v103, v103
    v_mfma_f32_16x16x32_bf16 v[84:87], a[156:159], v[52:55], v[84:87]
    v_cvt_pk_bf16_f32 v149, v102, v103
    v_mfma_f32_16x16x32_bf16 v[88:91], a[132:135], v[8:11], v[168:171]
    v_exp_f32 v116, v116
    v_mfma_f32_16x16x32_bf16 v[88:91], a[140:143], v[24:27], v[88:91]
    buffer_load_dwordx4 v194, s[12:15], s48 offen lds
    v_mfma_f32_16x16x32_bf16 v[88:91], a[148:151], v[40:43], v[88:91]
    v_exp_f32 v117, v117
    v_mfma_f32_16x16x32_bf16 v[88:91], a[156:159], v[56:59], v[88:91]
    v_cvt_pk_bf16_f32 v150, v116, v117
    v_mfma_f32_16x16x32_bf16 v[92:95], a[132:135], v[12:15], v[172:175]
    v_exp_f32 v118, v118
    v_mfma_f32_16x16x32_bf16 v[92:95], a[140:143], v[28:31], v[92:95]
    buffer_load_dwordx4 v195, s[12:15], s48 offen offset:1024 lds
    v_mfma_f32_16x16x32_bf16 v[92:95], a[148:151], v[44:47], v[92:95]
    s_add_u32 s48, s48, 8192
    v_exp_f32 v119, v119
    v_mfma_f32_16x16x32_bf16 v[92:95], a[156:159], v[60:63], v[92:95]
    v_cvt_pk_bf16_f32 v151, v118, v119
    v_smfmac_f32_16x16x64_bf16 v[228:231], v[176:179], v[128:135], v238
    v_exp_f32 v104, v104
    v_smfmac_f32_16x16x64_bf16 v[232:235], v[176:179], v[136:143], v238
    s_waitcnt lgkmcnt(0)
    v_mfma_f32_16x16x32_bf16 a[0:3], a[160:163], v[128:131], a[0:3]
    v_exp_f32 v105, v105
    v_mfma_f32_16x16x32_bf16 a[16:19], a[164:167], v[128:131], a[16:19]
    ds_read_b128 a[128:131], v180 offset:40960
    ds_read_b128 a[132:135], v180 offset:45056
    v_mfma_f32_16x16x32_bf16 a[4:7], a[160:163], v[132:135], a[4:7]
    v_exp_f32 v106, v106
    v_mfma_f32_16x16x32_bf16 a[20:23], a[164:167], v[132:135], a[20:23]
    ds_read_b128 a[136:139], v181 offset:40960
    ds_read_b128 a[140:143], v181 offset:45056
    v_mfma_f32_16x16x32_bf16 a[8:11], a[160:163], v[136:139], a[8:11]
    v_exp_f32 v107, v107
    v_mfma_f32_16x16x32_bf16 a[24:27], a[164:167], v[136:139], a[24:27]
    ds_read_b128 a[144:147], v182 offset:40960
    ds_read_b128 a[148:151], v182 offset:45056
    v_mfma_f32_16x16x32_bf16 a[12:15], a[160:163], v[140:143], a[12:15]
    v_exp_f32 v120, v120
    v_mfma_f32_16x16x32_bf16 a[28:31], a[164:167], v[140:143], a[28:31]
    ds_read_b128 a[152:155], v183 offset:40960
    ds_read_b128 a[156:159], v183 offset:45056
    v_mfma_f32_16x16x32_bf16 a[32:35], a[168:171], v[128:131], a[32:35]
    v_exp_f32 v121, v121
    v_mfma_f32_16x16x32_bf16 a[48:51], a[172:175], v[128:131], a[48:51]
    v_cvt_pk_bf16_f32 v152, v104, v105
    v_cvt_pk_bf16_f32 v153, v106, v107
    v_mfma_f32_16x16x32_bf16 a[36:39], a[168:171], v[132:135], a[36:39]
    v_exp_f32 v122, v122
    v_mfma_f32_16x16x32_bf16 a[52:55], a[172:175], v[132:135], a[52:55]
    v_cvt_pk_bf16_f32 v154, v120, v121
    v_mfma_f32_16x16x32_bf16 a[40:43], a[168:171], v[136:139], a[40:43]
    s_add_u32 m0, s45, 0x6000
    v_exp_f32 v123, v123
    v_mfma_f32_16x16x32_bf16 a[56:59], a[172:175], v[136:139], a[56:59]
    v_cvt_pk_bf16_f32 v155, v122, v123
    v_mfma_f32_16x16x32_bf16 a[44:47], a[168:171], v[140:143], a[44:47]
    v_exp_f32 v108, v108
    v_mfma_f32_16x16x32_bf16 a[60:63], a[172:175], v[140:143], a[60:63]
    buffer_load_dwordx4 v192, s[8:11], s47 offen lds
    v_mfma_f32_16x16x32_bf16 a[64:67], a[176:179], v[128:131], a[64:67]
    v_exp_f32 v109, v109
    v_mfma_f32_16x16x32_bf16 a[80:83], a[180:183], v[128:131], a[80:83]
    v_cvt_pk_bf16_f32 v156, v108, v109
    v_mfma_f32_16x16x32_bf16 a[68:71], a[176:179], v[132:135], a[68:71]
    v_exp_f32 v110, v110
    v_mfma_f32_16x16x32_bf16 a[84:87], a[180:183], v[132:135], a[84:87]
    buffer_load_dwordx4 v193, s[8:11], s47 offen offset:1024 lds
    v_mfma_f32_16x16x32_bf16 a[72:75], a[176:179], v[136:139], a[72:75]
    s_add_u32 s47, s47, 8192
    v_exp_f32 v111, v111
    v_mfma_f32_16x16x32_bf16 a[88:91], a[180:183], v[136:139], a[88:91]
    v_cvt_pk_bf16_f32 v157, v110, v111
    v_mfma_f32_16x16x32_bf16 a[76:79], a[176:179], v[140:143], a[76:79]
    v_exp_f32 v124, v124
    v_mfma_f32_16x16x32_bf16 a[92:95], a[180:183], v[140:143], a[92:95]
    v_mfma_f32_16x16x32_bf16 a[96:99], a[184:187], v[128:131], a[96:99]
    v_exp_f32 v125, v125
    v_mfma_f32_16x16x32_bf16 a[112:115], a[188:191], v[128:131], a[112:115]
    v_cvt_pk_bf16_f32 v158, v124, v125
    v_mfma_f32_16x16x32_bf16 a[100:103], a[184:187], v[132:135], a[100:103]
    v_exp_f32 v126, v126
    v_mfma_f32_16x16x32_bf16 a[116:119], a[188:191], v[132:135], a[116:119]
    v_mfma_f32_16x16x32_bf16 a[104:107], a[184:187], v[136:139], a[104:107]
    v_exp_f32 v127, v127
    v_mfma_f32_16x16x32_bf16 a[120:123], a[188:191], v[136:139], a[120:123]
    v_cvt_pk_bf16_f32 v159, v126, v127
    v_mfma_f32_16x16x32_bf16 a[108:111], a[184:187], v[140:143], a[108:111]
    v_mfma_f32_16x16x32_bf16 a[124:127], a[188:191], v[140:143], a[124:127]
    s_waitcnt vmcnt(16) lgkmcnt(0)
    s_barrier
    v_mfma_f32_16x16x32_bf16 v[96:99], a[128:131], v[0:3], v[160:163]
    v_exp_f32 v64, v64
    v_mfma_f32_16x16x32_bf16 v[96:99], a[136:139], v[16:19], v[96:99]
    ds_read_b64_tr_b16 a[160:161], v184 offset:24576
    ds_read_b64_tr_b16 a[162:163], v184 offset:28672
    v_mfma_f32_16x16x32_bf16 v[96:99], a[144:147], v[32:35], v[96:99]
    v_exp_f32 v65, v65
    v_mfma_f32_16x16x32_bf16 v[96:99], a[152:155], v[48:51], v[96:99]
    ds_read_b64_tr_b16 a[164:165], v185 offset:24576
    ds_read_b64_tr_b16 a[166:167], v185 offset:28672
    v_mfma_f32_16x16x32_bf16 v[100:103], a[128:131], v[4:7], v[164:167]
    v_exp_f32 v66, v66
    v_mfma_f32_16x16x32_bf16 v[100:103], a[136:139], v[20:23], v[100:103]
    ds_read_b64_tr_b16 a[168:169], v186 offset:24576
    ds_read_b64_tr_b16 a[170:171], v186 offset:28672
    v_mfma_f32_16x16x32_bf16 v[100:103], a[144:147], v[36:39], v[100:103]
    v_exp_f32 v67, v67
    v_mfma_f32_16x16x32_bf16 v[100:103], a[152:155], v[52:55], v[100:103]
    ds_read_b64_tr_b16 a[172:173], v187 offset:24576
    ds_read_b64_tr_b16 a[174:175], v187 offset:28672
    v_mfma_f32_16x16x32_bf16 v[104:107], a[128:131], v[8:11], v[168:171]
    v_exp_f32 v80, v80
    v_mfma_f32_16x16x32_bf16 v[104:107], a[136:139], v[24:27], v[104:107]
    ds_read_b64_tr_b16 a[176:177], v188 offset:24576
    ds_read_b64_tr_b16 a[178:179], v188 offset:28672
    v_mfma_f32_16x16x32_bf16 v[104:107], a[144:147], v[40:43], v[104:107]
    v_exp_f32 v81, v81
    v_mfma_f32_16x16x32_bf16 v[104:107], a[152:155], v[56:59], v[104:107]
    ds_read_b64_tr_b16 a[180:181], v189 offset:24576
    ds_read_b64_tr_b16 a[182:183], v189 offset:28672
    v_mfma_f32_16x16x32_bf16 v[108:111], a[128:131], v[12:15], v[172:175]
    v_exp_f32 v82, v82
    v_mfma_f32_16x16x32_bf16 v[108:111], a[136:139], v[28:31], v[108:111]
    ds_read_b64_tr_b16 a[184:185], v190 offset:24576
    ds_read_b64_tr_b16 a[186:187], v190 offset:28672
    v_mfma_f32_16x16x32_bf16 v[108:111], a[144:147], v[44:47], v[108:111]
    v_exp_f32 v83, v83
    v_mfma_f32_16x16x32_bf16 v[108:111], a[152:155], v[60:63], v[108:111]
    ds_read_b64_tr_b16 a[188:189], v191 offset:24576
    ds_read_b64_tr_b16 a[190:191], v191 offset:28672
    v_mfma_f32_16x16x32_bf16 v[112:115], a[132:135], v[0:3], v[160:163]
    v_exp_f32 v68, v68
    v_mfma_f32_16x16x32_bf16 v[112:115], a[140:143], v[16:19], v[112:115]
    v_cvt_pk_bf16_f32 v128, v64, v65
    v_cvt_pk_bf16_f32 v129, v66, v67
    v_mfma_f32_16x16x32_bf16 v[112:115], a[148:151], v[32:35], v[112:115]
    v_exp_f32 v69, v69
    v_mfma_f32_16x16x32_bf16 v[112:115], a[156:159], v[48:51], v[112:115]
    v_cvt_pk_bf16_f32 v130, v80, v81
    v_cvt_pk_bf16_f32 v131, v82, v83
    v_mfma_f32_16x16x32_bf16 v[116:119], a[132:135], v[4:7], v[164:167]
    v_exp_f32 v70, v70
    v_mfma_f32_16x16x32_bf16 v[116:119], a[140:143], v[20:23], v[116:119]
    v_cvt_pk_bf16_f32 v132, v68, v69
    v_mfma_f32_16x16x32_bf16 v[116:119], a[148:151], v[36:39], v[116:119]
    s_add_u32 m0, s45, 0x12000
    v_exp_f32 v71, v71
    v_mfma_f32_16x16x32_bf16 v[116:119], a[156:159], v[52:55], v[116:119]
    v_cvt_pk_bf16_f32 v133, v70, v71
    v_mfma_f32_16x16x32_bf16 v[120:123], a[132:135], v[8:11], v[168:171]
    v_exp_f32 v84, v84
    v_mfma_f32_16x16x32_bf16 v[120:123], a[140:143], v[24:27], v[120:123]
    buffer_load_dwordx4 v194, s[12:15], s48 offen lds
    v_mfma_f32_16x16x32_bf16 v[120:123], a[148:151], v[40:43], v[120:123]
    v_exp_f32 v85, v85
    v_mfma_f32_16x16x32_bf16 v[120:123], a[156:159], v[56:59], v[120:123]
    v_cvt_pk_bf16_f32 v134, v84, v85
    v_mfma_f32_16x16x32_bf16 v[124:127], a[132:135], v[12:15], v[172:175]
    v_exp_f32 v86, v86
    v_mfma_f32_16x16x32_bf16 v[124:127], a[140:143], v[28:31], v[124:127]
    buffer_load_dwordx4 v195, s[12:15], s48 offen offset:1024 lds
    v_mfma_f32_16x16x32_bf16 v[124:127], a[148:151], v[44:47], v[124:127]
    s_add_u32 s48, s48, 8192
    v_exp_f32 v87, v87
    v_mfma_f32_16x16x32_bf16 v[124:127], a[156:159], v[60:63], v[124:127]
    v_cvt_pk_bf16_f32 v135, v86, v87
    v_smfmac_f32_16x16x64_bf16 v[228:231], v[176:179], v[144:151], v238
    v_exp_f32 v72, v72
    v_smfmac_f32_16x16x64_bf16 v[232:235], v[176:179], v[152:159], v238
    s_waitcnt lgkmcnt(0)
    v_mfma_f32_16x16x32_bf16 a[0:3], a[160:163], v[144:147], a[0:3]
    v_exp_f32 v73, v73
    v_mfma_f32_16x16x32_bf16 a[16:19], a[164:167], v[144:147], a[16:19]
    ds_read_b128 a[128:131], v180 offset:49152
    ds_read_b128 a[132:135], v180 offset:53248
    v_mfma_f32_16x16x32_bf16 a[4:7], a[160:163], v[148:151], a[4:7]
    v_exp_f32 v74, v74
    v_mfma_f32_16x16x32_bf16 a[20:23], a[164:167], v[148:151], a[20:23]
    ds_read_b128 a[136:139], v181 offset:49152
    ds_read_b128 a[140:143], v181 offset:53248
    v_mfma_f32_16x16x32_bf16 a[8:11], a[160:163], v[152:155], a[8:11]
    v_exp_f32 v75, v75
    v_mfma_f32_16x16x32_bf16 a[24:27], a[164:167], v[152:155], a[24:27]
    ds_read_b128 a[144:147], v182 offset:49152
    ds_read_b128 a[148:151], v182 offset:53248
    v_mfma_f32_16x16x32_bf16 a[12:15], a[160:163], v[156:159], a[12:15]
    v_exp_f32 v88, v88
    v_mfma_f32_16x16x32_bf16 a[28:31], a[164:167], v[156:159], a[28:31]
    ds_read_b128 a[152:155], v183 offset:49152
    ds_read_b128 a[156:159], v183 offset:53248
    v_mfma_f32_16x16x32_bf16 a[32:35], a[168:171], v[144:147], a[32:35]
    v_exp_f32 v89, v89
    v_mfma_f32_16x16x32_bf16 a[48:51], a[172:175], v[144:147], a[48:51]
    v_cvt_pk_bf16_f32 v136, v72, v73
    v_cvt_pk_bf16_f32 v137, v74, v75
    v_mfma_f32_16x16x32_bf16 a[36:39], a[168:171], v[148:151], a[36:39]
    v_exp_f32 v90, v90
    v_mfma_f32_16x16x32_bf16 a[52:55], a[172:175], v[148:151], a[52:55]
    v_cvt_pk_bf16_f32 v138, v88, v89
    v_mfma_f32_16x16x32_bf16 a[40:43], a[168:171], v[152:155], a[40:43]
    s_add_u32 m0, s45, 0x8000
    v_exp_f32 v91, v91
    v_mfma_f32_16x16x32_bf16 a[56:59], a[172:175], v[152:155], a[56:59]
    v_cvt_pk_bf16_f32 v139, v90, v91
    v_mfma_f32_16x16x32_bf16 a[44:47], a[168:171], v[156:159], a[44:47]
    v_exp_f32 v76, v76
    v_mfma_f32_16x16x32_bf16 a[60:63], a[172:175], v[156:159], a[60:63]
    buffer_load_dwordx4 v192, s[8:11], s47 offen lds
    v_mfma_f32_16x16x32_bf16 a[64:67], a[176:179], v[144:147], a[64:67]
    v_exp_f32 v77, v77
    v_mfma_f32_16x16x32_bf16 a[80:83], a[180:183], v[144:147], a[80:83]
    v_cvt_pk_bf16_f32 v140, v76, v77
    v_mfma_f32_16x16x32_bf16 a[68:71], a[176:179], v[148:151], a[68:71]
    v_exp_f32 v78, v78
    v_mfma_f32_16x16x32_bf16 a[84:87], a[180:183], v[148:151], a[84:87]
    buffer_load_dwordx4 v193, s[8:11], s47 offen offset:1024 lds
    v_mfma_f32_16x16x32_bf16 a[72:75], a[176:179], v[152:155], a[72:75]
    s_add_u32 s47, s47, 8192
    v_exp_f32 v79, v79
    v_mfma_f32_16x16x32_bf16 a[88:91], a[180:183], v[152:155], a[88:91]
    v_cvt_pk_bf16_f32 v141, v78, v79
    v_mfma_f32_16x16x32_bf16 a[76:79], a[176:179], v[156:159], a[76:79]
    v_exp_f32 v92, v92
    v_mfma_f32_16x16x32_bf16 a[92:95], a[180:183], v[156:159], a[92:95]
    v_mfma_f32_16x16x32_bf16 a[96:99], a[184:187], v[144:147], a[96:99]
    v_exp_f32 v93, v93
    v_mfma_f32_16x16x32_bf16 a[112:115], a[188:191], v[144:147], a[112:115]
L_it7:
    s_cbranch_execz L_it11
    v_cvt_pk_bf16_f32 v142, v92, v93
    v_mfma_f32_16x16x32_bf16 a[100:103], a[184:187], v[148:151], a[100:103]
    v_exp_f32 v94, v94
    v_mfma_f32_16x16x32_bf16 a[116:119], a[188:191], v[148:151], a[116:119]
    v_mfma_f32_16x16x32_bf16 a[104:107], a[184:187], v[152:155], a[104:107]
    v_exp_f32 v95, v95
    v_mfma_f32_16x16x32_bf16 a[120:123], a[188:191], v[152:155], a[120:123]
    v_cvt_pk_bf16_f32 v143, v94, v95
    v_mfma_f32_16x16x32_bf16 a[108:111], a[184:187], v[156:159], a[108:111]
    v_mfma_f32_16x16x32_bf16 a[124:127], a[188:191], v[156:159], a[124:127]
    s_waitcnt lgkmcnt(0)
    v_mfma_f32_16x16x32_bf16 v[64:67], a[128:131], v[0:3], v[160:163]
    v_exp_f32 v96, v96
    v_mfma_f32_16x16x32_bf16 v[64:67], a[136:139], v[16:19], v[64:67]
    ds_read_b64_tr_b16 a[160:161], v184 offset:32768
    ds_read_b64_tr_b16 a[162:163], v184 offset:36864
    v_mfma_f32_16x16x32_bf16 v[64:67], a[144:147], v[32:35], v[64:67]
    v_exp_f32 v97, v97
    v_mfma_f32_16x16x32_bf16 v[64:67], a[152:155], v[48:51], v[64:67]
    ds_read_b64_tr_b16 a[164:165], v185 offset:32768
    ds_read_b64_tr_b16 a[166:167], v185 offset:36864
    v_mfma_f32_16x16x32_bf16 v[68:71], a[128:131], v[4:7], v[164:167]
    v_exp_f32 v98, v98
    v_mfma_f32_16x16x32_bf16 v[68:71], a[136:139], v[20:23], v[68:71]
    ds_read_b64_tr_b16 a[168:169], v186 offset:32768
    ds_read_b64_tr_b16 a[170:171], v186 offset:36864
    v_mfma_f32_16x16x32_bf16 v[68:71], a[144:147], v[36:39], v[68:71]
    v_exp_f32 v99, v99
    v_mfma_f32_16x16x32_bf16 v[68:71], a[152:155], v[52:55], v[68:71]
    ds_read_b64_tr_b16 a[172:173], v187 offset:32768
    ds_read_b64_tr_b16 a[174:175], v187 offset:36864
    v_mfma_f32_16x16x32_bf16 v[72:75], a[128:131], v[8:11], v[168:171]
    v_exp_f32 v112, v112
    v_mfma_f32_16x16x32_bf16 v[72:75], a[136:139], v[24:27], v[72:75]
    ds_read_b64_tr_b16 a[176:177], v188 offset:32768
    ds_read_b64_tr_b16 a[178:179], v188 offset:36864
    v_mfma_f32_16x16x32_bf16 v[72:75], a[144:147], v[40:43], v[72:75]
    v_exp_f32 v113, v113
    v_mfma_f32_16x16x32_bf16 v[72:75], a[152:155], v[56:59], v[72:75]
    ds_read_b64_tr_b16 a[180:181], v189 offset:32768
    ds_read_b64_tr_b16 a[182:183], v189 offset:36864
    v_mfma_f32_16x16x32_bf16 v[76:79], a[128:131], v[12:15], v[172:175]
    v_exp_f32 v114, v114
    v_mfma_f32_16x16x32_bf16 v[76:79], a[136:139], v[28:31], v[76:79]
    ds_read_b64_tr_b16 a[184:185], v190 offset:32768
    ds_read_b64_tr_b16 a[186:187], v190 offset:36864
    v_mfma_f32_16x16x32_bf16 v[76:79], a[144:147], v[44:47], v[76:79]
    v_exp_f32 v115, v115
    v_mfma_f32_16x16x32_bf16 v[76:79], a[152:155], v[60:63], v[76:79]
    ds_read_b64_tr_b16 a[188:189], v191 offset:32768
    ds_read_b64_tr_b16 a[190:191], v191 offset:36864
    v_mfma_f32_16x16x32_bf16 v[80:83], a[132:135], v[0:3], v[160:163]
    v_exp_f32 v100, v100
    v_mfma_f32_16x16x32_bf16 v[80:83], a[140:143], v[16:19], v[80:83]
    v_cvt_pk_bf16_f32 v144, v96, v97
    v_cvt_pk_bf16_f32 v145, v98, v99
    v_mfma_f32_16x16x32_bf16 v[80:83], a[148:151], v[32:35], v[80:83]
    v_exp_f32 v101, v101
    v_mfma_f32_16x16x32_bf16 v[80:83], a[156:159], v[48:51], v[80:83]
    v_cvt_pk_bf16_f32 v146, v112, v113
    v_cvt_pk_bf16_f32 v147, v114, v115
    v_mfma_f32_16x16x32_bf16 v[84:87], a[132:135], v[4:7], v[164:167]
    v_exp_f32 v102, v102
    v_mfma_f32_16x16x32_bf16 v[84:87], a[140:143], v[20:23], v[84:87]
    v_cvt_pk_bf16_f32 v148, v100, v101
    v_mfma_f32_16x16x32_bf16 v[84:87], a[148:151], v[36:39], v[84:87]
    s_add_u32 m0, s45, 0x14000
    v_exp_f32 v103, v103
    v_mfma_f32_16x16x32_bf16 v[84:87], a[156:159], v[52:55], v[84:87]
    v_cvt_pk_bf16_f32 v149, v102, v103
    v_mfma_f32_16x16x32_bf16 v[88:91], a[132:135], v[8:11], v[168:171]
    v_exp_f32 v116, v116
    v_mfma_f32_16x16x32_bf16 v[88:91], a[140:143], v[24:27], v[88:91]
    buffer_load_dwordx4 v194, s[12:15], s48 offen lds
    v_mfma_f32_16x16x32_bf16 v[88:91], a[148:151], v[40:43], v[88:91]
    v_exp_f32 v117, v117
    v_mfma_f32_16x16x32_bf16 v[88:91], a[156:159], v[56:59], v[88:91]
    v_cvt_pk_bf16_f32 v150, v116, v117
    v_mfma_f32_16x16x32_bf16 v[92:95], a[132:135], v[12:15], v[172:175]
    v_exp_f32 v118, v118
    v_mfma_f32_16x16x32_bf16 v[92:95], a[140:143], v[28:31], v[92:95]
    buffer_load_dwordx4 v195, s[12:15], s48 offen offset:1024 lds
    v_mfma_f32_16x16x32_bf16 v[92:95], a[148:151], v[44:47], v[92:95]
    s_add_u32 s48, s48, 8192
    v_exp_f32 v119, v119
    v_mfma_f32_16x16x32_bf16 v[92:95], a[156:159], v[60:63], v[92:95]
    v_cvt_pk_bf16_f32 v151, v118, v119
    v_smfmac_f32_16x16x64_bf16 v[228:231], v[176:179], v[128:135], v238
    v_exp_f32 v104, v104
    v_smfmac_f32_16x16x64_bf16 v[232:235], v[176:179], v[136:143], v238
    s_waitcnt lgkmcnt(0)
    v_mfma_f32_16x16x32_bf16 a[0:3], a[160:163], v[128:131], a[0:3]
    v_exp_f32 v105, v105
    v_mfma_f32_16x16x32_bf16 a[16:19], a[164:167], v[128:131], a[16:19]
    ds_read_b128 a[128:131], v180 offset:57344
    ds_read_b128 a[132:135], v180 offset:61440
    v_mfma_f32_16x16x32_bf16 a[4:7], a[160:163], v[132:135], a[4:7]
    v_exp_f32 v106, v106
    v_mfma_f32_16x16x32_bf16 a[20:23], a[164:167], v[132:135], a[20:23]
    ds_read_b128 a[136:139], v181 offset:57344
    ds_read_b128 a[140:143], v181 offset:61440
    v_mfma_f32_16x16x32_bf16 a[8:11], a[160:163], v[136:139], a[8:11]
    v_exp_f32 v107, v107
    v_mfma_f32_16x16x32_bf16 a[24:27], a[164:167], v[136:139], a[24:27]
    ds_read_b128 a[144:147], v182 offset:57344
    ds_read_b128 a[148:151], v182 offset:61440
    v_mfma_f32_16x16x32_bf16 a[12:15], a[160:163], v[140:143], a[12:15]
    v_exp_f32 v120, v120
    v_mfma_f32_16x16x32_bf16 a[28:31], a[164:167], v[140:143], a[28:31]
    ds_read_b128 a[152:155], v183 offset:57344
    ds_read_b128 a[156:159], v183 offset:61440
    v_mfma_f32_16x16x32_bf16 a[32:35], a[168:171], v[128:131], a[32:35]
    v_exp_f32 v121, v121
    v_mfma_f32_16x16x32_bf16 a[48:51], a[172:175], v[128:131], a[48:51]
    v_cvt_pk_bf16_f32 v152, v104, v105
    v_cvt_pk_bf16_f32 v153, v106, v107
    v_mfma_f32_16x16x32_bf16 a[36:39], a[168:171], v[132:135], a[36:39]
    v_exp_f32 v122, v122
    v_mfma_f32_16x16x32_bf16 a[52:55], a[172:175], v[132:135], a[52:55]
    v_cvt_pk_bf16_f32 v154, v120, v121
    v_mfma_f32_16x16x32_bf16 a[40:43], a[168:171], v[136:139], a[40:43]
    s_add_u32 m0, s45, 0xa000
    v_exp_f32 v123, v123
    v_mfma_f32_16x16x32_bf16 a[56:59], a[172:175], v[136:139], a[56:59]
    v_cvt_pk_bf16_f32 v155, v122, v123
    v_mfma_f32_16x16x32_bf16 a[44:47], a[168:171], v[140:143], a[44:47]
    v_exp_f32 v108, v108
    v_mfma_f32_16x16x32_bf16 a[60:63], a[172:175], v[140:143], a[60:63]
    buffer_load_dwordx4 v192, s[8:11], s47 offen lds
    v_mfma_f32_16x16x32_bf16 a[64:67], a[176:179], v[128:131], a[64:67]
    v_exp_f32 v109, v109
    v_mfma_f32_16x16x32_bf16 a[80:83], a[180:183], v[128:131], a[80:83]
    v_cvt_pk_bf16_f32 v156, v108, v109
    v_mfma_f32_16x16x32_bf16 a[68:71], a[176:179], v[132:135], a[68:71]
    v_exp_f32 v110, v110
    v_mfma_f32_16x16x32_bf16 a[84:87], a[180:183], v[132:135], a[84:87]
    buffer_load_dwordx4 v193, s[8:11], s47 offen offset:1024 lds
    v_mfma_f32_16x16x32_bf16 a[72:75], a[176:179], v[136:139], a[72:75]
    s_add_u32 s47, s47, 8192
    v_exp_f32 v111, v111
    v_mfma_f32_16x16x32_bf16 a[88:91], a[180:183], v[136:139], a[88:91]
    v_cvt_pk_bf16_f32 v157, v110, v111
    v_mfma_f32_16x16x32_bf16 a[76:79], a[176:179], v[140:143], a[76:79]
    v_exp_f32 v124, v124
    v_mfma_f32_16x16x32_bf16 a[92:95], a[180:183], v[140:143], a[92:95]
    v_mfma_f32_16x16x32_bf16 a[96:99], a[184:187], v[128:131], a[96:99]
    v_exp_f32 v125, v125
    v_mfma_f32_16x16x32_bf16 a[112:115], a[188:191], v[128:131], a[112:115]
    v_cvt_pk_bf16_f32 v158, v124, v125
    v_mfma_f32_16x16x32_bf16 a[100:103], a[184:187], v[132:135], a[100:103]
    v_exp_f32 v126, v126
    v_mfma_f32_16x16x32_bf16 a[116:119], a[188:191], v[132:135], a[116:119]
    v_mfma_f32_16x16x32_bf16 a[104:107], a[184:187], v[136:139], a[104:107]
    v_exp_f32 v127, v127
    v_mfma_f32_16x16x32_bf16 a[120:123], a[188:191], v[136:139], a[120:123]
    v_cvt_pk_bf16_f32 v159, v126, v127
    v_mfma_f32_16x16x32_bf16 a[108:111], a[184:187], v[140:143], a[108:111]
    v_mfma_f32_16x16x32_bf16 a[124:127], a[188:191], v[140:143], a[124:127]
    s_waitcnt vmcnt(16) lgkmcnt(0)
    s_barrier
    v_mfma_f32_16x16x32_bf16 v[96:99], a[128:131], v[0:3], v[160:163]
    v_exp_f32 v64, v64
    v_mfma_f32_16x16x32_bf16 v[96:99], a[136:139], v[16:19], v[96:99]
    ds_read_b64_tr_b16 a[160:161], v184 offset:40960
    ds_read_b64_tr_b16 a[162:163], v184 offset:45056
    v_mfma_f32_16x16x32_bf16 v[96:99], a[144:147], v[32:35], v[96:99]
    v_exp_f32 v65, v65
    v_mfma_f32_16x16x32_bf16 v[96:99], a[152:155], v[48:51], v[96:99]
    ds_read_b64_tr_b16 a[164:165], v185 offset:40960
    ds_read_b64_tr_b16 a[166:167], v185 offset:45056
    v_mfma_f32_16x16x32_bf16 v[100:103], a[128:131], v[4:7], v[164:167]
    v_exp_f32 v66, v66
    v_mfma_f32_16x16x32_bf16 v[100:103], a[136:139], v[20:23], v[100:103]
    ds_read_b64_tr_b16 a[168:169], v186 offset:40960
    ds_read_b64_tr_b16 a[170:171], v186 offset:45056
    v_mfma_f32_16x16x32_bf16 v[100:103], a[144:147], v[36:39], v[100:103]
    v_exp_f32 v67, v67
    v_mfma_f32_16x16x32_bf16 v[100:103], a[152:155], v[52:55], v[100:103]
    ds_read_b64_tr_b16 a[172:173], v187 offset:40960
    ds_read_b64_tr_b16 a[174:175], v187 offset:45056
    v_mfma_f32_16x16x32_bf16 v[104:107], a[128:131], v[8:11], v[168:171]
    v_exp_f32 v80, v80
    v_mfma_f32_16x16x32_bf16 v[104:107], a[136:139], v[24:27], v[104:107]
    ds_read_b64_tr_b16 a[176:177], v188 offset:40960
    ds_read_b64_tr_b16 a[178:179], v188 offset:45056
    v_mfma_f32_16x16x32_bf16 v[104:107], a[144:147], v[40:43], v[104:107]
    v_exp_f32 v81, v81
    v_mfma_f32_16x16x32_bf16 v[104:107], a[152:155], v[56:59], v[104:107]
    ds_read_b64_tr_b16 a[180:181], v189 offset:40960
    ds_read_b64_tr_b16 a[182:183], v189 offset:45056
    v_mfma_f32_16x16x32_bf16 v[108:111], a[128:131], v[12:15], v[172:175]
    v_exp_f32 v82, v82
    v_mfma_f32_16x16x32_bf16 v[108:111], a[136:139], v[28:31], v[108:111]
    ds_read_b64_tr_b16 a[184:185], v190 offset:40960
    ds_read_b64_tr_b16 a[186:187], v190 offset:45056
    v_mfma_f32_16x16x32_bf16 v[108:111], a[144:147], v[44:47], v[108:111]
    v_exp_f32 v83, v83
    v_mfma_f32_16x16x32_bf16 v[108:111], a[152:155], v[60:63], v[108:111]
    ds_read_b64_tr_b16 a[188:189], v191 offset:40960
    ds_read_b64_tr_b16 a[190:191], v191 offset:45056
    v_mfma_f32_16x16x32_bf16 v[112:115], a[132:135], v[0:3], v[160:163]
    v_exp_f32 v68, v68
    v_mfma_f32_16x16x32_bf16 v[112:115], a[140:143], v[16:19], v[112:115]
    v_cvt_pk_bf16_f32 v128, v64, v65
    v_cvt_pk_bf16_f32 v129, v66, v67
    v_mfma_f32_16x16x32_bf16 v[112:115], a[148:151], v[32:35], v[112:115]
    v_exp_f32 v69, v69
    v_mfma_f32_16x16x32_bf16 v[112:115], a[156:159], v[48:51], v[112:115]
    v_cvt_pk_bf16_f32 v130, v80, v81
    v_cvt_pk_bf16_f32 v131, v82, v83
    v_mfma_f32_16x16x32_bf16 v[116:119], a[132:135], v[4:7], v[164:167]
    v_exp_f32 v70, v70
    v_mfma_f32_16x16x32_bf16 v[116:119], a[140:143], v[20:23], v[116:119]
    v_cvt_pk_bf16_f32 v132, v68, v69
    v_mfma_f32_16x16x32_bf16 v[116:119], a[148:151], v[36:39], v[116:119]
    s_add_u32 m0, s45, 0x16000
    v_exp_f32 v71, v71
    v_mfma_f32_16x16x32_bf16 v[116:119], a[156:159], v[52:55], v[116:119]
    v_cvt_pk_bf16_f32 v133, v70, v71
    v_mfma_f32_16x16x32_bf16 v[120:123], a[132:135], v[8:11], v[168:171]
    v_exp_f32 v84, v84
    v_mfma_f32_16x16x32_bf16 v[120:123], a[140:143], v[24:27], v[120:123]
    buffer_load_dwordx4 v194, s[12:15], s48 offen lds
    v_mfma_f32_16x16x32_bf16 v[120:123], a[148:151], v[40:43], v[120:123]
    v_exp_f32 v85, v85
    v_mfma_f32_16x16x32_bf16 v[120:123], a[156:159], v[56:59], v[120:123]
    v_cvt_pk_bf16_f32 v134, v84, v85
    v_mfma_f32_16x16x32_bf16 v[124:127], a[132:135], v[12:15], v[172:175]
    v_exp_f32 v86, v86
    v_mfma_f32_16x16x32_bf16 v[124:127], a[140:143], v[28:31], v[124:127]
    buffer_load_dwordx4 v195, s[12:15], s48 offen offset:1024 lds
    v_mfma_f32_16x16x32_bf16 v[124:127], a[148:151], v[44:47], v[124:127]
    s_add_u32 s48, s48, 8192
    v_exp_f32 v87, v87
    v_mfma_f32_16x16x32_bf16 v[124:127], a[156:159], v[60:63], v[124:127]
    v_cvt_pk_bf16_f32 v135, v86, v87
    v_smfmac_f32_16x16x64_bf16 v[228:231], v[176:179], v[144:151], v238
    v_exp_f32 v72, v72
    v_smfmac_f32_16x16x64_bf16 v[232:235], v[176:179], v[152:159], v238
    s_waitcnt lgkmcnt(0)
    v_mfma_f32_16x16x32_bf16 a[0:3], a[160:163], v[144:147], a[0:3]
    v_exp_f32 v73, v73
    v_mfma_f32_16x16x32_bf16 a[16:19], a[164:167], v[144:147], a[16:19]
    ds_read_b128 a[128:131], v180 offset:0
    ds_read_b128 a[132:135], v180 offset:4096
    v_mfma_f32_16x16x32_bf16 a[4:7], a[160:163], v[148:151], a[4:7]
    v_exp_f32 v74, v74
    v_mfma_f32_16x16x32_bf16 a[20:23], a[164:167], v[148:151], a[20:23]
    ds_read_b128 a[136:139], v181 offset:0
    ds_read_b128 a[140:143], v181 offset:4096
    v_mfma_f32_16x16x32_bf16 a[8:11], a[160:163], v[152:155], a[8:11]
    v_exp_f32 v75, v75
    v_mfma_f32_16x16x32_bf16 a[24:27], a[164:167], v[152:155], a[24:27]
    ds_read_b128 a[144:147], v182 offset:0
    ds_read_b128 a[148:151], v182 offset:4096
    v_mfma_f32_16x16x32_bf16 a[12:15], a[160:163], v[156:159], a[12:15]
    v_exp_f32 v88, v88
    v_mfma_f32_16x16x32_bf16 a[28:31], a[164:167], v[156:159], a[28:31]
    ds_read_b128 a[152:155], v183 offset:0
    ds_read_b128 a[156:159], v183 offset:4096
    v_mfma_f32_16x16x32_bf16 a[32:35], a[168:171], v[144:147], a[32:35]
    v_exp_f32 v89, v89
    v_mfma_f32_16x16x32_bf16 a[48:51], a[172:175], v[144:147], a[48:51]
    v_cvt_pk_bf16_f32 v136, v72, v73
    v_cvt_pk_bf16_f32 v137, v74, v75
    v_mfma_f32_16x16x32_bf16 a[36:39], a[168:171], v[148:151], a[36:39]
    v_exp_f32 v90, v90
    v_mfma_f32_16x16x32_bf16 a[52:55], a[172:175], v[148:151], a[52:55]
    v_cvt_pk_bf16_f32 v138, v88, v89
    v_mfma_f32_16x16x32_bf16 a[40:43], a[168:171], v[152:155], a[40:43]
    s_add_u32 m0, s45, 0xc000
    v_exp_f32 v91, v91
    v_mfma_f32_16x16x32_bf16 a[56:59], a[172:175], v[152:155], a[56:59]
    v_cvt_pk_bf16_f32 v139, v90, v91
    v_mfma_f32_16x16x32_bf16 a[44:47], a[168:171], v[156:159], a[44:47]
    v_exp_f32 v76, v76
    v_mfma_f32_16x16x32_bf16 a[60:63], a[172:175], v[156:159], a[60:63]
    buffer_load_dwordx4 v192, s[8:11], s47 offen lds
    v_mfma_f32_16x16x32_bf16 a[64:67], a[176:179], v[144:147], a[64:67]
    v_exp_f32 v77, v77
    v_mfma_f32_16x16x32_bf16 a[80:83], a[180:183], v[144:147], a[80:83]
    v_cvt_pk_bf16_f32 v140, v76, v77
    v_mfma_f32_16x16x32_bf16 a[68:71], a[176:179], v[148:151], a[68:71]
    v_exp_f32 v78, v78
    v_mfma_f32_16x16x32_bf16 a[84:87], a[180:183], v[148:151], a[84:87]
    buffer_load_dwordx4 v193, s[8:11], s47 offen offset:1024 lds
    v_mfma_f32_16x16x32_bf16 a[72:75], a[176:179], v[152:155], a[72:75]
    s_add_u32 s47, s47, 8192
    v_exp_f32 v79, v79
    v_mfma_f32_16x16x32_bf16 a[88:91], a[180:183], v[152:155], a[88:91]
    v_cvt_pk_bf16_f32 v141, v78, v79
    v_mfma_f32_16x16x32_bf16 a[76:79], a[176:179], v[156:159], a[76:79]
    v_exp_f32 v92, v92
    v_mfma_f32_16x16x32_bf16 a[92:95], a[180:183], v[156:159], a[92:95]
    v_mfma_f32_16x16x32_bf16 a[96:99], a[184:187], v[144:147], a[96:99]
    s_cmp_eq_u32 s49, 7
    v_exp_f32 v93, v93
    v_mfma_f32_16x16x32_bf16 a[112:115], a[188:191], v[144:147], a[112:115]
    v_cvt_pk_bf16_f32 v142, v92, v93
    v_mfma_f32_16x16x32_bf16 a[100:103], a[184:187], v[148:151], a[100:103]
    v_exp_f32 v94, v94
    v_mfma_f32_16x16x32_bf16 a[116:119], a[188:191], v[148:151], a[116:119]
    v_mfma_f32_16x16x32_bf16 a[104:107], a[184:187], v[152:155], a[104:107]
    v_exp_f32 v95, v95
    v_mfma_f32_16x16x32_bf16 a[120:123], a[188:191], v[152:155], a[120:123]
    v_cvt_pk_bf16_f32 v143, v94, v95
    v_mfma_f32_16x16x32_bf16 a[108:111], a[184:187], v[156:159], a[108:111]
    v_mfma_f32_16x16x32_bf16 a[124:127], a[188:191], v[156:159], a[124:127]
    s_waitcnt lgkmcnt(0)
    s_cbranch_scc1 L2_tail
    v_mfma_f32_16x16x32_bf16 v[64:67], a[128:131], v[0:3], v[160:163]
    v_exp_f32 v96, v96
    v_mfma_f32_16x16x32_bf16 v[64:67], a[136:139], v[16:19], v[64:67]
    ds_read_b64_tr_b16 a[160:161], v184 offset:49152
    ds_read_b64_tr_b16 a[162:163], v184 offset:53248
    v_mfma_f32_16x16x32_bf16 v[64:67], a[144:147], v[32:35], v[64:67]
    v_exp_f32 v97, v97
    v_mfma_f32_16x16x32_bf16 v[64:67], a[152:155], v[48:51], v[64:67]
    ds_read_b64_tr_b16 a[164:165], v185 offset:49152
    ds_read_b64_tr_b16 a[166:167], v185 offset:53248
    v_mfma_f32_16x16x32_bf16 v[68:71], a[128:131], v[4:7], v[164:167]
    v_exp_f32 v98, v98
    v_mfma_f32_16x16x32_bf16 v[68:71], a[136:139], v[20:23], v[68:71]
    ds_read_b64_tr_b16 a[168:169], v186 offset:49152
    ds_read_b64_tr_b16 a[170:171], v186 offset:53248
    v_mfma_f32_16x16x32_bf16 v[68:71], a[144:147], v[36:39], v[68:71]
    v_exp_f32 v99, v99
    v_mfma_f32_16x16x32_bf16 v[68:71], a[152:155], v[52:55], v[68:71]
    ds_read_b64_tr_b16 a[172:173], v187 offset:49152
    ds_read_b64_tr_b16 a[174:175], v187 offset:53248
    v_mfma_f32_16x16x32_bf16 v[72:75], a[128:131], v[8:11], v[168:171]
    v_exp_f32 v112, v112
    v_mfma_f32_16x16x32_bf16 v[72:75], a[136:139], v[24:27], v[72:75]
    ds_read_b64_tr_b16 a[176:177], v188 offset:49152
    ds_read_b64_tr_b16 a[178:179], v188 offset:53248
    v_mfma_f32_16x16x32_bf16 v[72:75], a[144:147], v[40:43], v[72:75]
    v_exp_f32 v113, v113
    v_mfma_f32_16x16x32_bf16 v[72:75], a[152:155], v[56:59], v[72:75]
    ds_read_b64_tr_b16 a[180:181], v189 offset:49152
    ds_read_b64_tr_b16 a[182:183], v189 offset:53248
    v_mfma_f32_16x16x32_bf16 v[76:79], a[128:131], v[12:15], v[172:175]
    v_exp_f32 v114, v114
    v_mfma_f32_16x16x32_bf16 v[76:79], a[136:139], v[28:31], v[76:79]
    ds_read_b64_tr_b16 a[184:185], v190 offset:49152
    ds_read_b64_tr_b16 a[186:187], v190 offset:53248
    v_mfma_f32_16x16x32_bf16 v[76:79], a[144:147], v[44:47], v[76:79]
    v_exp_f32 v115, v115
    v_mfma_f32_16x16x32_bf16 v[76:79], a[152:155], v[60:63], v[76:79]
    ds_read_b64_tr_b16 a[188:189], v191 offset:49152
    ds_read_b64_tr_b16 a[190:191], v191 offset:53248
    v_mfma_f32_16x16x32_bf16 v[80:83], a[132:135], v[0:3], v[160:163]
    v_exp_f32 v100, v100
    v_mfma_f32_16x16x32_bf16 v[80:83], a[140:143], v[16:19], v[80:83]
    v_cvt_pk_bf16_f32 v144, v96, v97
    v_cvt_pk_bf16_f32 v145, v98, v99
    v_mfma_f32_16x16x32_bf16 v[80:83], a[148:151], v[32:35], v[80:83]
    v_exp_f32 v101, v101
    v_mfma_f32_16x16x32_bf16 v[80:83], a[156:159], v[48:51], v[80:83]
    v_cvt_pk_bf16_f32 v146, v112, v113
    v_cvt_pk_bf16_f32 v147, v114, v115
    v_mfma_f32_16x16x32_bf16 v[84:87], a[132:135], v[4:7], v[164:167]
    v_exp_f32 v102, v102
    v_mfma_f32_16x16x32_bf16 v[84:87], a[140:143], v[20:23], v[84:87]
    v_cvt_pk_bf16_f32 v148, v100, v101
    v_mfma_f32_16x16x32_bf16 v[84:87], a[148:151], v[36:39], v[84:87]
    s_add_u32 m0, s45, 0x18000
    v_exp_f32 v103, v103
    v_mfma_f32_16x16x32_bf16 v[84:87], a[156:159], v[52:55], v[84:87]
    v_cvt_pk_bf16_f32 v149, v102, v103
    v_mfma_f32_16x16x32_bf16 v[88:91], a[132:135], v[8:11], v[168:171]
    v_exp_f32 v116, v116
    v_mfma_f32_16x16x32_bf16 v[88:91], a[140:143], v[24:27], v[88:91]
    buffer_load_dwordx4 v194, s[12:15], s48 offen lds
    v_mfma_f32_16x16x32_bf16 v[88:91], a[148:151], v[40:43], v[88:91]
    v_exp_f32 v117, v117
    v_mfma_f32_16x16x32_bf16 v[88:91], a[156:159], v[56:59], v[88:91]
    v_cvt_pk_bf16_f32 v150, v116, v117
    v_mfma_f32_16x16x32_bf16 v[92:95], a[132:135], v[12:15], v[172:175]
    v_exp_f32 v118, v118
    v_mfma_f32_16x16x32_bf16 v[92:95], a[140:143], v[28:31], v[92:95]
    buffer_load_dwordx4 v195, s[12:15], s48 offen offset:1024 lds
    v_mfma_f32_16x16x32_bf16 v[92:95], a[148:151], v[44:47], v[92:95]
    s_add_u32 s48, s48, 8192
    v_exp_f32 v119, v119
    v_mfma_f32_16x16x32_bf16 v[92:95], a[156:159], v[60:63], v[92:95]
    v_cvt_pk_bf16_f32 v151, v118, v119
    v_smfmac_f32_16x16x64_bf16 v[228:231], v[176:179], v[128:135], v238
    v_exp_f32 v104, v104
    v_smfmac_f32_16x16x64_bf16 v[232:235], v[176:179], v[136:143], v238
    s_waitcnt lgkmcnt(0)
    v_mfma_f32_16x16x32_bf16 a[0:3], a[160:163], v[128:131], a[0:3]
    v_exp_f32 v105, v105
    v_mfma_f32_16x16x32_bf16 a[16:19], a[164:167], v[128:131], a[16:19]
    ds_read_b128 a[128:131], v180 offset:8192
    ds_read_b128 a[132:135], v180 offset:12288
    v_mfma_f32_16x16x32_bf16 a[4:7], a[160:163], v[132:135], a[4:7]
    v_exp_f32 v106, v106
    v_mfma_f32_16x16x32_bf16 a[20:23], a[164:167], v[132:135], a[20:23]
    ds_read_b128 a[136:139], v181 offset:8192
    ds_read_b128 a[140:143], v181 offset:12288
    v_mfma_f32_16x16x32_bf16 a[8:11], a[160:163], v[136:139], a[8:11]
    v_exp_f32 v107, v107
    v_mfma_f32_16x16x32_bf16 a[24:27], a[164:167], v[136:139], a[24:27]
    ds_read_b128 a[144:147], v182 offset:8192
    ds_read_b128 a[148:151], v182 offset:12288
    v_mfma_f32_16x16x32_bf16 a[12:15], a[160:163], v[140:143], a[12:15]
    v_exp_f32 v120, v120
    v_mfma_f32_16x16x32_bf16 a[28:31], a[164:167], v[140:143], a[28:31]
    ds_read_b128 a[152:155], v183 offset:8192
    ds_read_b128 a[156:159], v183 offset:12288
    v_mfma_f32_16x16x32_bf16 a[32:35], a[168:171], v[128:131], a[32:35]
    v_exp_f32 v121, v121
    v_mfma_f32_16x16x32_bf16 a[48:51], a[172:175], v[128:131], a[48:51]
    v_cvt_pk_bf16_f32 v152, v104, v105
    v_cvt_pk_bf16_f32 v153, v106, v107
    v_mfma_f32_16x16x32_bf16 a[36:39], a[168:171], v[132:135], a[36:39]
    v_exp_f32 v122, v122
    v_mfma_f32_16x16x32_bf16 a[52:55], a[172:175], v[132:135], a[52:55]
    v_cvt_pk_bf16_f32 v154, v120, v121
    v_mfma_f32_16x16x32_bf16 a[40:43], a[168:171], v[136:139], a[40:43]
    s_add_u32 m0, s45, 0xe000
    v_exp_f32 v123, v123
    v_mfma_f32_16x16x32_bf16 a[56:59], a[172:175], v[136:139], a[56:59]
    v_cvt_pk_bf16_f32 v155, v122, v123
    v_mfma_f32_16x16x32_bf16 a[44:47], a[168:171], v[140:143], a[44:47]
    v_exp_f32 v108, v108
    v_mfma_f32_16x16x32_bf16 a[60:63], a[172:175], v[140:143], a[60:63]
    buffer_load_dwordx4 v192, s[8:11], s47 offen lds
    v_mfma_f32_16x16x32_bf16 a[64:67], a[176:179], v[128:131], a[64:67]
    v_exp_f32 v109, v109
    v_mfma_f32_16x16x32_bf16 a[80:83], a[180:183], v[128:131], a[80:83]
    v_cvt_pk_bf16_f32 v156, v108, v109
    v_mfma_f32_16x16x32_bf16 a[68:71], a[176:179], v[132:135], a[68:71]
    v_exp_f32 v110, v110
    v_mfma_f32_16x16x32_bf16 a[84:87], a[180:183], v[132:135], a[84:87]
    buffer_load_dwordx4 v193, s[8:11], s47 offen offset:1024 lds
    v_mfma_f32_16x16x32_bf16 a[72:75], a[176:179], v[136:139], a[72:75]
    s_add_u32 s47, s47, 8192
    v_exp_f32 v111, v111
    v_mfma_f32_16x16x32_bf16 a[88:91], a[180:183], v[136:139], a[88:91]
    v_cvt_pk_bf16_f32 v157, v110, v111
    v_mfma_f32_16x16x32_bf16 a[76:79], a[176:179], v[140:143], a[76:79]
    v_exp_f32 v124, v124
    v_mfma_f32_16x16x32_bf16 a[92:95], a[180:183], v[140:143], a[92:95]
    v_mfma_f32_16x16x32_bf16 a[96:99], a[184:187], v[128:131], a[96:99]
    v_exp_f32 v125, v125
    v_mfma_f32_16x16x32_bf16 a[112:115], a[188:191], v[128:131], a[112:115]
    v_cvt_pk_bf16_f32 v158, v124, v125
    v_mfma_f32_16x16x32_bf16 a[100:103], a[184:187], v[132:135], a[100:103]
    v_exp_f32 v126, v126
    v_mfma_f32_16x16x32_bf16 a[116:119], a[188:191], v[132:135], a[116:119]
    v_mfma_f32_16x16x32_bf16 a[104:107], a[184:187], v[136:139], a[104:107]
    v_exp_f32 v127, v127
    v_mfma_f32_16x16x32_bf16 a[120:123], a[188:191], v[136:139], a[120:123]
    v_cvt_pk_bf16_f32 v159, v126, v127
    v_mfma_f32_16x16x32_bf16 a[108:111], a[184:187], v[140:143], a[108:111]
    v_mfma_f32_16x16x32_bf16 a[124:127], a[188:191], v[140:143], a[124:127]
    s_waitcnt vmcnt(16) lgkmcnt(0)
    s_barrier
    v_mfma_f32_16x16x32_bf16 v[96:99], a[128:131], v[0:3], v[160:163]
    v_exp_f32 v64, v64
    v_mfma_f32_16x16x32_bf16 v[96:99], a[136:139], v[16:19], v[96:99]
    ds_read_b64_tr_b16 a[160:161], v184 offset:57344
    ds_read_b64_tr_b16 a[162:163], v184 offset:61440
    v_mfma_f32_16x16x32_bf16 v[96:99], a[144:147], v[32:35], v[96:99]
    s_cmp_eq_u32 s49, s75
    v_exp_f32 v65, v65
    v_mfma_f32_16x16x32_bf16 v[96:99], a[152:155], v[48:51], v[96:99]
    ds_read_b64_tr_b16 a[164:165], v185 offset:57344
    ds_read_b64_tr_b16 a[166:167], v185 offset:61440
    v_mfma_f32_16x16x32_bf16 v[100:103], a[128:131], v[4:7], v[164:167]
    s_cbranch_scc1 L2_dochk
L2_retchk:
    v_exp_f32 v66, v66
    v_mfma_f32_16x16x32_bf16 v[100:103], a[136:139], v[20:23], v[100:103]
    ds_read_b64_tr_b16 a[168:169], v186 offset:57344
    ds_read_b64_tr_b16 a[170:171], v186 offset:61440
    v_mfma_f32_16x16x32_bf16 v[100:103], a[144:147], v[36:39], v[100:103]
    s_bitcmp1_b32 s7, s49
    v_exp_f32 v67, v67
    v_mfma_f32_16x16x32_bf16 v[100:103], a[152:155], v[52:55], v[100:103]
    ds_read_b64_tr_b16 a[172:173], v187 offset:57344
    ds_read_b64_tr_b16 a[174:175], v187 offset:61440
    v_mfma_f32_16x16x32_bf16 v[104:107], a[128:131], v[8:11], v[168:171]
    s_cbranch_scc1 L2_dosb
L2_retsb:
    v_exp_f32 v80, v80
    v_mfma_f32_16x16x32_bf16 v[104:107], a[136:139], v[24:27], v[104:107]
    ds_read_b64_tr_b16 a[176:177], v188 offset:57344
    ds_read_b64_tr_b16 a[178:179], v188 offset:61440
    v_mfma_f32_16x16x32_bf16 v[104:107], a[144:147], v[40:43], v[104:107]
    v_exp_f32 v81, v81
    v_mfma_f32_16x16x32_bf16 v[104:107], a[152:155], v[56:59], v[104:107]
    ds_read_b64_tr_b16 a[180:181], v189 offset:57344
    ds_read_b64_tr_b16 a[182:183], v189 offset:61440
    v_mfma_f32_16x16x32_bf16 v[108:111], a[128:131], v[12:15], v[172:175]
    v_exp_f32 v82, v82
    v_mfma_f32_16x16x32_bf16 v[108:111], a[136:139], v[28:31], v[108:111]
    ds_read_b64_tr_b16 a[184:185], v190 offset:57344
    ds_read_b64_tr_b16 a[186:187], v190 offset:61440
    v_mfma_f32_16x16x32_bf16 v[108:111], a[144:147], v[44:47], v[108:111]
    v_exp_f32 v83, v83
    v_mfma_f32_16x16x32_bf16 v[108:111], a[152:155], v[60:63], v[108:111]
    ds_read_b64_tr_b16 a[188:189], v191 offset:57344
    ds_read_b64_tr_b16 a[190:191], v191 offset:61440
    v_mfma_f32_16x16x32_bf16 v[112:115], a[132:135], v[0:3], v[160:163]
    v_exp_f32 v68, v68
    v_mfma_f32_16x16x32_bf16 v[112:115], a[140:143], v[16:19], v[112:115]
    v_cvt_pk_bf16_f32 v128, v64, v65
    v_cvt_pk_bf16_f32 v129, v66, v67
    v_mfma_f32_16x16x32_bf16 v[112:115], a[148:151], v[32:35], v[112:115]
    v_exp_f32 v69, v69
    v_mfma_f32_16x16x32_bf16 v[112:115], a[156:159], v[48:51], v[112:115]
    v_cvt_pk_bf16_f32 v130, v80, v81
    v_cvt_pk_bf16_f32 v131, v82, v83
    v_mfma_f32_16x16x32_bf16 v[116:119], a[132:135], v[4:7], v[164:167]
    v_exp_f32 v70, v70
    v_mfma_f32_16x16x32_bf16 v[116:119], a[140:143], v[20:23], v[116:119]
    v_cvt_pk_bf16_f32 v132, v68, v69
    v_mfma_f32_16x16x32_bf16 v[116:119], a[148:151], v[36:39], v[116:119]
    s_add_u32 m0, s45, 0x1a000
    v_exp_f32 v71, v71
    v_mfma_f32_16x16x32_bf16 v[116:119], a[156:159], v[52:55], v[116:119]
    v_cvt_pk_bf16_f32 v133, v70, v71
    v_mfma_f32_16x16x32_bf16 v[120:123], a[132:135], v[8:11], v[168:171]
    v_exp_f32 v84, v84
    v_mfma_f32_16x16x32_bf16 v[120:123], a[140:143], v[24:27], v[120:123]
    buffer_load_dwordx4 v194, s[12:15], s48 offen lds
    v_mfma_f32_16x16x32_bf16 v[120:123], a[148:151], v[40:43], v[120:123]
    v_exp_f32 v85, v85
    v_mfma_f32_16x16x32_bf16 v[120:123], a[156:159], v[56:59], v[120:123]
    v_cvt_pk_bf16_f32 v134, v84, v85
    v_mfma_f32_16x16x32_bf16 v[124:127], a[132:135], v[12:15], v[172:175]
    v_exp_f32 v86, v86
    v_mfma_f32_16x16x32_bf16 v[124:127], a[140:143], v[28:31], v[124:127]
    buffer_load_dwordx4 v195, s[12:15], s48 offen offset:1024 lds
    v_mfma_f32_16x16x32_bf16 v[124:127], a[148:151], v[44:47], v[124:127]
    s_add_u32 s48, s48, 8192
    v_exp_f32 v87, v87
    v_mfma_f32_16x16x32_bf16 v[124:127], a[156:159], v[60:63], v[124:127]
    v_cvt_pk_bf16_f32 v135, v86, v87
    v_smfmac_f32_16x16x64_bf16 v[228:231], v[176:179], v[144:151], v238
    v_exp_f32 v72, v72
    v_smfmac_f32_16x16x64_bf16 v[232:235], v[176:179], v[152:159], v238
    s_waitcnt lgkmcnt(0)
    v_mfma_f32_16x16x32_bf16 a[0:3], a[160:163], v[144:147], a[0:3]
    v_exp_f32 v73, v73
    v_mfma_f32_16x16x32_bf16 a[16:19], a[164:167], v[144:147], a[16:19]
    ds_read_b128 a[128:131], v180 offset:16384
    ds_read_b128 a[132:135], v180 offset:20480
    v_mfma_f32_16x16x32_bf16 a[4:7], a[160:163], v[148:151], a[4:7]
    v_exp_f32 v74, v74
    v_mfma_f32_16x16x32_bf16 a[20:23], a[164:167], v[148:151], a[20:23]
    ds_read_b128 a[136:139], v181 offset:16384
    ds_read_b128 a[140:143], v181 offset:20480
    v_mfma_f32_16x16x32_bf16 a[8:11], a[160:163], v[152:155], a[8:11]
    v_exp_f32 v75, v75
    v_mfma_f32_16x16x32_bf16 a[24:27], a[164:167], v[152:155], a[24:27]
    ds_read_b128 a[144:147], v182 offset:16384
    ds_read_b128 a[148:151], v182 offset:20480
    v_mfma_f32_16x16x32_bf16 a[12:15], a[160:163], v[156:159], a[12:15]
    v_exp_f32 v88, v88
    v_mfma_f32_16x16x32_bf16 a[28:31], a[164:167], v[156:159], a[28:31]
    ds_read_b128 a[152:155], v183 offset:16384
    ds_read_b128 a[156:159], v183 offset:20480
    v_mfma_f32_16x16x32_bf16 a[32:35], a[168:171], v[144:147], a[32:35]
    v_exp_f32 v89, v89
    v_mfma_f32_16x16x32_bf16 a[48:51], a[172:175], v[144:147], a[48:51]
    v_cvt_pk_bf16_f32 v136, v72, v73
    v_cvt_pk_bf16_f32 v137, v74, v75
    v_mfma_f32_16x16x32_bf16 a[36:39], a[168:171], v[148:151], a[36:39]
    v_exp_f32 v90, v90
    v_mfma_f32_16x16x32_bf16 a[52:55], a[172:175], v[148:151], a[52:55]
    v_cvt_pk_bf16_f32 v138, v88, v89
    v_mfma_f32_16x16x32_bf16 a[40:43], a[168:171], v[152:155], a[40:43]
    s_add_u32 m0, s45, 0x0
    v_exp_f32 v91, v91
    v_mfma_f32_16x16x32_bf16 a[56:59], a[172:175], v[152:155], a[56:59]
    v_cvt_pk_bf16_f32 v139, v90, v91
    v_mfma_f32_16x16x32_bf16 a[44:47], a[168:171], v[156:159], a[44:47]
    v_exp_f32 v76, v76
    v_mfma_f32_16x16x32_bf16 a[60:63], a[172:175], v[156:159], a[60:63]
    buffer_load_dwordx4 v192, s[8:11], s47 offen lds
L_it8:
    s_cbranch_execz L_it12
    v_mfma_f32_16x16x32_bf16 a[64:67], a[176:179], v[144:147], a[64:67]
    v_exp_f32 v77, v77
    v_mfma_f32_16x16x32_bf16 a[80:83], a[180:183], v[144:147], a[80:83]
    v_cvt_pk_bf16_f32 v140, v76, v77
    v_mfma_f32_16x16x32_bf16 a[68:71], a[176:179], v[148:151], a[68:71]
    v_exp_f32 v78, v78
    v_mfma_f32_16x16x32_bf16 a[84:87], a[180:183], v[148:151], a[84:87]
    buffer_load_dwordx4 v193, s[8:11], s47 offen offset:1024 lds
    v_mfma_f32_16x16x32_bf16 a[72:75], a[176:179], v[152:155], a[72:75]
    s_add_u32 s47, s47, 8192
    v_exp_f32 v79, v79
    v_mfma_f32_16x16x32_bf16 a[88:91], a[180:183], v[152:155], a[88:91]
    v_cvt_pk_bf16_f32 v141, v78, v79
    v_mfma_f32_16x16x32_bf16 a[76:79], a[176:179], v[156:159], a[76:79]
    v_exp_f32 v92, v92
    v_mfma_f32_16x16x32_bf16 a[92:95], a[180:183], v[156:159], a[92:95]
    v_mfma_f32_16x16x32_bf16 a[96:99], a[184:187], v[144:147], a[96:99]
    s_add_u32 s49, s49, 1
    v_exp_f32 v93, v93
    v_mfma_f32_16x16x32_bf16 a[112:115], a[188:191], v[144:147], a[112:115]
    v_cvt_pk_bf16_f32 v142, v92, v93
    v_mfma_f32_16x16x32_bf16 a[100:103], a[184:187], v[148:151], a[100:103]
    v_exp_f32 v94, v94
    v_mfma_f32_16x16x32_bf16 a[116:119], a[188:191], v[148:151], a[116:119]
    v_mfma_f32_16x16x32_bf16 a[104:107], a[184:187], v[152:155], a[104:107]
    v_exp_f32 v95, v95
    v_mfma_f32_16x16x32_bf16 a[120:123], a[188:191], v[152:155], a[120:123]
    v_cvt_pk_bf16_f32 v143, v94, v95
    v_mfma_f32_16x16x32_bf16 a[108:111], a[184:187], v[156:159], a[108:111]
    v_mfma_f32_16x16x32_bf16 a[124:127], a[188:191], v[156:159], a[124:127]
    s_waitcnt lgkmcnt(0)
    s_branch L2_loop
L2_tail:
    s_add_u32 s90, s38, 0x4000
    s_add_u32 s91, s90, 57344
    s_add_u32 s92, s91, 57344
    s_add_u32 s93, s92, 57344
    ds_read_b64_tr_b16 a[160:161], v184 offset:49152
    ds_read_b64_tr_b16 a[162:163], v184 offset:53248
    ds_read_b64_tr_b16 a[164:165], v185 offset:49152
    ds_read_b64_tr_b16 a[166:167], v185 offset:53248
    ds_read_b64_tr_b16 a[168:169], v186 offset:49152
    ds_read_b64_tr_b16 a[170:171], v186 offset:53248
    ds_read_b64_tr_b16 a[172:173], v187 offset:49152
    ds_read_b64_tr_b16 a[174:175], v187 offset:53248
    ds_read_b64_tr_b16 a[176:177], v188 offset:49152
    ds_read_b64_tr_b16 a[178:179], v188 offset:53248
    ds_read_b64_tr_b16 a[180:181], v189 offset:49152
    ds_read_b64_tr_b16 a[182:183], v189 offset:53248
    ds_read_b64_tr_b16 a[184:185], v190 offset:49152
    ds_read_b64_tr_b16 a[186:187], v190 offset:53248
    ds_read_b64_tr_b16 a[188:189], v191 offset:49152
    ds_read_b64_tr_b16 a[190:191], v191 offset:53248
    v_smfmac_f32_16x16x64_bf16 v[228:231], v[176:179], v[128:135], v238
    s_add_u32 m0, s45, 0xe000
    s_nop 0
    buffer_load_dwordx4 v192, s[8:11], s47 offen lds
    v_exp_f32 v96, v96
    v_smfmac_f32_16x16x64_bf16 v[232:235], v[176:179], v[136:143], v238
    v_exp_f32 v97, v97
    s_waitcnt lgkmcnt(0)
    v_mfma_f32_16x16x32_bf16 a[0:3], a[160:163], v[128:131], a[0:3]
    v_exp_f32 v98, v98
    v_cvt_pk_bf16_f32 v144, v96, v97
    v_mfma_f32_16x16x32_bf16 a[16:19], a[164:167], v[128:131], a[16:19]
    buffer_load_dwordx4 v193, s[8:11], s47 offen offset:1024 lds
    v_exp_f32 v99, v99
    v_mfma_f32_16x16x32_bf16 a[4:7], a[160:163], v[132:135], a[4:7]
    v_exp_f32 v112, v112
    v_cvt_pk_bf16_f32 v145, v98, v99
    v_mfma_f32_16x16x32_bf16 a[20:23], a[164:167], v[132:135], a[20:23]
    v_exp_f32 v113, v113
    v_mfma_f32_16x16x32_bf16 a[8:11], a[160:163], v[136:139], a[8:11]
    buffer_load_dwordx4 a[128:131], v211, s[24:27], s90 offen sc1
    s_add_u32 s90, s90, 4096
    v_exp_f32 v114, v114
    v_mfma_f32_16x16x32_bf16 a[24:27], a[164:167], v[136:139], a[24:27]
    v_cvt_pk_bf16_f32 v146, v112, v113
    v_exp_f32 v115, v115
    v_mfma_f32_16x16x32_bf16 a[12:15], a[160:163], v[140:143], a[12:15]
    v_exp_f32 v100, v100
    v_mfma_f32_16x16x32_bf16 a[28:31], a[164:167], v[140:143], a[28:31]
    buffer_load_dwordx4 a[132:135], v211, s[24:27], s91 offen sc1
    s_add_u32 s91, s91, 4096
    v_cvt_pk_bf16_f32 v147, v114, v115
    v_exp_f32 v101, v101
    v_mfma_f32_16x16x32_bf16 a[32:35], a[168:171], v[128:131], a[32:35]
    v_exp_f32 v102, v102
    v_mfma_f32_16x16x32_bf16 a[48:51], a[172:175], v[128:131], a[48:51]
    v_cvt_pk_bf16_f32 v148, v100, v101
    v_exp_f32 v103, v103
    v_mfma_f32_16x16x32_bf16 a[36:39], a[168:171], v[132:135], a[36:39]
    buffer_load_dwordx4 a[136:139], v211, s[24:27], s92 offen sc1
    s_add_u32 s92, s92, 4096
    v_exp_f32 v116, v116
    v_mfma_f32_16x16x32_bf16 a[52:55], a[172:175], v[132:135], a[52:55]
    v_cvt_pk_bf16_f32 v149, v102, v103
    v_mfma_f32_16x16x32_bf16 a[40:43], a[168:171], v[136:139], a[40:43]
    v_exp_f32 v117, v117
    v_exp_f32 v118, v118
    v_mfma_f32_16x16x32_bf16 a[56:59], a[172:175], v[136:139], a[56:59]
    buffer_load_dwordx4 a[140:143], v211, s[24:27], s93 offen sc1
    s_add_u32 s93, s93, 4096
    v_cvt_pk_bf16_f32 v150, v116, v117
    v_mfma_f32_16x16x32_bf16 a[44:47], a[168:171], v[140:143], a[44:47]
    v_exp_f32 v119, v119
    v_exp_f32 v104, v104
    v_mfma_f32_16x16x32_bf16 a[60:63], a[172:175], v[140:143], a[60:63]
    v_cvt_pk_bf16_f32 v151, v118, v119
    v_mfma_f32_16x16x32_bf16 a[64:67], a[176:179], v[128:131], a[64:67]
    buffer_load_dwordx4 a[144:147], v211, s[24:27], s90 offen sc1
    s_add_u32 s90, s90, 4096
    v_exp_f32 v105, v105
    v_mfma_f32_16x16x32_bf16 a[80:83], a[180:183], v[128:131], a[80:83]
    v_exp_f32 v106, v106
    v_cvt_pk_bf16_f32 v152, v104, v105
    v_mfma_f32_16x16x32_bf16 a[68:71], a[176:179], v[132:135], a[68:71]
    v_exp_f32 v107, v107
    v_mfma_f32_16x16x32_bf16 a[84:87], a[180:183], v[132:135], a[84:87]
    buffer_load_dwordx4 a[148:151], v211, s[24:27], s91 offen sc1
    s_add_u32 s91, s91, 4096
    v_exp_f32 v120, v120
    v_cvt_pk_bf16_f32 v153, v106, v107
    v_mfma_f32_16x16x32_bf16 a[72:75], a[176:179], v[136:139], a[72:75]
    v_exp_f32 v121, v121
    v_mfma_f32_16x16x32_bf16 a[88:91], a[180:183], v[136:139], a[88:91]
    v_exp_f32 v122, v122
    v_mfma_f32_16x16x32_bf16 a[76:79], a[176:179], v[140:143], a[76:79]
    buffer_load_dwordx4 a[152:155], v211, s[24:27], s92 offen sc1
    s_add_u32 s92, s92, 4096
    v_cvt_pk_bf16_f32 v154, v120, v121
    v_exp_f32 v123, v123
    v_mfma_f32_16x16x32_bf16 a[92:95], a[180:183], v[140:143], a[92:95]
    v_exp_f32 v108, v108
    v_mfma_f32_16x16x32_bf16 a[96:99], a[184:187], v[128:131], a[96:99]
    v_cvt_pk_bf16_f32 v155, v122, v123
    v_exp_f32 v109, v109
    v_mfma_f32_16x16x32_bf16 a[112:115], a[188:191], v[128:131], a[112:115]
    buffer_load_dwordx4 a[156:159], v211, s[24:27], s93 offen sc1
    s_add_u32 s93, s93, 4096
    v_exp_f32 v110, v110
    v_mfma_f32_16x16x32_bf16 a[100:103], a[184:187], v[132:135], a[100:103]
    v_cvt_pk_bf16_f32 v156, v108, v109
    v_exp_f32 v111, v111
    v_mfma_f32_16x16x32_bf16 a[116:119], a[188:191], v[132:135], a[116:119]
    v_exp_f32 v124, v124
    v_mfma_f32_16x16x32_bf16 a[104:107], a[184:187], v[136:139], a[104:107]
    v_cvt_pk_bf16_f32 v157, v110, v111
    v_mfma_f32_16x16x32_bf16 a[120:123], a[188:191], v[136:139], a[120:123]
    v_exp_f32 v125, v125
    v_exp_f32 v126, v126
    v_mfma_f32_16x16x32_bf16 a[108:111], a[184:187], v[140:143], a[108:111]
    v_cvt_pk_bf16_f32 v158, v124, v125
    v_mfma_f32_16x16x32_bf16 a[124:127], a[188:191], v[140:143], a[124:127]
    v_exp_f32 v127, v127
    s_nop 0
    v_cvt_pk_bf16_f32 v159, v126, v127
    s_waitcnt lgkmcnt(0)
    s_waitcnt vmcnt(8) lgkmcnt(0)
    s_barrier
    ds_read_b64_tr_b16 a[160:161], v184 offset:57344
    ds_read_b64_tr_b16 a[162:163], v184 offset:61440
    ds_read_b64_tr_b16 a[164:165], v185 offset:57344
    ds_read_b64_tr_b16 a[166:167], v185 offset:61440
    ds_read_b64_tr_b16 a[168:169], v186 offset:57344
    ds_read_b64_tr_b16 a[170:171], v186 offset:61440
    ds_read_b64_tr_b16 a[172:173], v187 offset:57344
    ds_read_b64_tr_b16 a[174:175], v187 offset:61440
    ds_read_b64_tr_b16 a[176:177], v188 offset:57344
    ds_read_b64_tr_b16 a[178:179], v188 offset:61440
    ds_read_b64_tr_b16 a[180:181], v189 offset:57344
    ds_read_b64_tr_b16 a[182:183], v189 offset:61440
    ds_read_b64_tr_b16 a[184:185], v190 offset:57344
    ds_read_b64_tr_b16 a[186:187], v190 offset:61440
    ds_read_b64_tr_b16 a[188:189], v191 offset:57344
    ds_read_b64_tr_b16 a[190:191], v191 offset:61440
    v_smfmac_f32_16x16x64_bf16 v[228:231], v[176:179], v[144:151], v238
    s_add_u32 m0, s95, 0x18000
    s_add_u32 s94, s37, 0x18000
    buffer_load_dwordx4 v211, s[68:71], s94 offen offset:0 sc1 lds
    v_smfmac_f32_16x16x64_bf16 v[232:235], v[176:179], v[152:159], v238
    buffer_load_dwordx4 v211, s[68:71], s94 offen offset:1024 sc1 lds
    s_waitcnt lgkmcnt(0)
    v_mfma_f32_16x16x32_bf16 a[0:3], a[160:163], v[144:147], a[0:3]
    buffer_load_dwordx4 v211, s[68:71], s94 offen offset:2048 sc1 lds
    v_mfma_f32_16x16x32_bf16 a[16:19], a[164:167], v[144:147], a[16:19]
    buffer_load_dwordx4 v211, s[68:71], s94 offen offset:3072 sc1 lds
    v_mfma_f32_16x16x32_bf16 a[4:7], a[160:163], v[148:151], a[4:7]
    v_mfma_f32_16x16x32_bf16 a[20:23], a[164:167], v[148:151], a[20:23]
    v_mfma_f32_16x16x32_bf16 a[8:11], a[160:163], v[152:155], a[8:11]
    v_mfma_f32_16x16x32_bf16 a[24:27], a[164:167], v[152:155], a[24:27]
    v_mfma_f32_16x16x32_bf16 a[12:15], a[160:163], v[156:159], a[12:15]
    v_mfma_f32_16x16x32_bf16 a[28:31], a[164:167], v[156:159], a[28:31]
    v_mfma_f32_16x16x32_bf16 a[32:35], a[168:171], v[144:147], a[32:35]
    v_mfma_f32_16x16x32_bf16 a[48:51], a[172:175], v[144:147], a[48:51]
    v_mfma_f32_16x16x32_bf16 a[36:39], a[168:171], v[148:151], a[36:39]
    v_mfma_f32_16x16x32_bf16 a[52:55], a[172:175], v[148:151], a[52:55]
    v_mfma_f32_16x16x32_bf16 a[40:43], a[168:171], v[152:155], a[40:43]
    v_mfma_f32_16x16x32_bf16 a[56:59], a[172:175], v[152:155], a[56:59]
    v_mfma_f32_16x16x32_bf16 a[44:47], a[168:171], v[156:159], a[44:47]
    v_mfma_f32_16x16x32_bf16 a[60:63], a[172:175], v[156:159], a[60:63]
    v_mfma_f32_16x16x32_bf16 a[64:67], a[176:179], v[144:147], a[64:67]
    v_mfma_f32_16x16x32_bf16 a[80:83], a[180:183], v[144:147], a[80:83]
    v_mfma_f32_16x16x32_bf16 a[68:71], a[176:179], v[148:151], a[68:71]
    v_mfma_f32_16x16x32_bf16 a[84:87], a[180:183], v[148:151], a[84:87]
    v_mfma_f32_16x16x32_bf16 a[72:75], a[176:179], v[152:155], a[72:75]
    v_mfma_f32_16x16x32_bf16 a[88:91], a[180:183], v[152:155], a[88:91]
    v_mfma_f32_16x16x32_bf16 a[76:79], a[176:179], v[156:159], a[76:79]
    v_mfma_f32_16x16x32_bf16 a[92:95], a[180:183], v[156:159], a[92:95]
    v_mfma_f32_16x16x32_bf16 a[96:99], a[184:187], v[144:147], a[96:99]
    v_mfma_f32_16x16x32_bf16 a[112:115], a[188:191], v[144:147], a[112:115]
    v_mfma_f32_16x16x32_bf16 a[100:103], a[184:187], v[148:151], a[100:103]
    v_mfma_f32_16x16x32_bf16 a[116:119], a[188:191], v[148:151], a[116:119]
    v_mfma_f32_16x16x32_bf16 a[104:107], a[184:187], v[152:155], a[104:107]
    v_mfma_f32_16x16x32_bf16 a[120:123], a[188:191], v[152:155], a[120:123]
    v_mfma_f32_16x16x32_bf16 a[108:111], a[184:187], v[156:159], a[108:111]
    v_mfma_f32_16x16x32_bf16 a[124:127], a[188:191], v[156:159], a[124:127]
    v_add_f32 v228, v228, v229
    v_add_f32 v230, v230, v231
    v_add_f32 v232, v232, v233
    v_add_f32 v234, v234, v235
    s_mov_b32 s53, 0x7b800000
    s_mov_b64 s[56:57], -1
    v_cmp_gt_f32 vcc, s53, v228
    s_nop 3
    s_and_b64 s[56:57], s[56:57], vcc
    v_cmp_gt_f32 vcc, s53, v230
    s_nop 3
    s_and_b64 s[56:57], s[56:57], vcc
    v_cmp_gt_f32 vcc, s53, v232
    s_nop 3
    s_and_b64 s[56:57], s[56:57], vcc
    v_cmp_gt_f32 vcc, s53, v234
    s_nop 3
    s_and_b64 s[56:57], s[56:57], vcc
    v_rcp_f32 v228, v228
    v_rcp_f32 v230, v230
    v_rcp_f32 v232, v232
    v_rcp_f32 v234, v234
    v_mov_b32 v216, 0
    s_mov_b32 s51, s55
    v_accvgpr_read_b32 v64, a0
    v_accvgpr_read_b32 v65, a1
    v_accvgpr_read_b32 v66, a2
    v_accvgpr_read_b32 v67, a3
    v_accvgpr_read_b32 v68, a16
    v_accvgpr_read_b32 v69, a17
    v_accvgpr_read_b32 v70, a18
    v_accvgpr_read_b32 v71, a19
    v_pk_mul_f32 v[64:65], v[64:65], v[228:229] op_sel:[0,0] op_sel_hi:[1,0]
    v_pk_mul_f32 v[66:67], v[66:67], v[228:229] op_sel:[0,0] op_sel_hi:[1,0]
    v_pk_mul_f32 v[68:69], v[68:69], v[228:229] op_sel:[0,0] op_sel_hi:[1,0]
    v_pk_mul_f32 v[70:71], v[70:71], v[228:229] op_sel:[0,0] op_sel_hi:[1,0]
    v_maximum3_f32 v216, v216, |v64|, |v65|
    v_maximum3_f32 v216, v216, |v66|, |v67|
    v_maximum3_f32 v216, v216, |v68|, |v69|
    v_maximum3_f32 v216, v216, |v70|, |v71|
    v_cvt_pk_bf16_f32 v72, v64, v65
    v_cvt_pk_bf16_f32 v73, v66, v67
    v_cvt_pk_bf16_f32 v74, v68, v69
    v_cvt_pk_bf16_f32 v75, v70, v71
    buffer_store_dwordx4 v[72:75], v211, s[32:35], s51 offen offset:0 sc1
    v_accvgpr_read_b32 v80, a32
    v_accvgpr_read_b32 v81, a33
    v_accvgpr_read_b32 v82, a34
    v_accvgpr_read_b32 v83, a35
    v_accvgpr_read_b32 v84, a48
    v_accvgpr_read_b32 v85, a49
    v_accvgpr_read_b32 v86, a50
    v_accvgpr_read_b32 v87, a51
    v_pk_mul_f32 v[80:81], v[80:81], v[228:229] op_sel:[0,0] op_sel_hi:[1,0]
    v_pk_mul_f32 v[82:83], v[82:83], v[228:229] op_sel:[0,0] op_sel_hi:[1,0]
    v_pk_mul_f32 v[84:85], v[84:85], v[228:229] op_sel:[0,0] op_sel_hi:[1,0]
    v_pk_mul_f32 v[86:87], v[86:87], v[228:229] op_sel:[0,0] op_sel_hi:[1,0]
    v_maximum3_f32 v216, v216, |v80|, |v81|
    v_maximum3_f32 v216, v216, |v82|, |v83|
    v_maximum3_f32 v216, v216, |v84|, |v85|
    v_maximum3_f32 v216, v216, |v86|, |v87|
    v_cvt_pk_bf16_f32 v88, v80, v81
    v_cvt_pk_bf16_f32 v89, v82, v83
    v_cvt_pk_bf16_f32 v90, v84, v85
    v_cvt_pk_bf16_f32 v91, v86, v87
    buffer_store_dwordx4 v[88:91], v211, s[32:35], s51 offen offset:1024 sc1
    v_accvgpr_read_b32 v96, a64
    v_accvgpr_read_b32 v97, a65
    v_accvgpr_read_b32 v98, a66
    v_accvgpr_read_b32 v99, a67
    v_accvgpr_read_b32 v100, a80
    v_accvgpr_read_b32 v101, a81
    v_accvgpr_read_b32 v102, a82
    v_accvgpr_read_b32 v103, a83
    v_pk_mul_f32 v[96:97], v[96:97], v[228:229] op_sel:[0,0] op_sel_hi:[1,0]
    v_pk_mul_f32 v[98:99], v[98:99], v[228:229] op_sel:[0,0] op_sel_hi:[1,0]
    v_pk_mul_f32 v[100:101], v[100:101], v[228:229] op_sel:[0,0] op_sel_hi:[1,0]
    v_pk_mul_f32 v[102:103], v[102:103], v[228:229] op_sel:[0,0] op_sel_hi:[1,0]
    v_maximum3_f32 v216, v216, |v96|, |v97|
    v_maximum3_f32 v216, v216, |v98|, |v99|
    v_maximum3_f32 v216, v216, |v100|, |v101|
    v_maximum3_f32 v216, v216, |v102|, |v103|
    v_cvt_pk_bf16_f32 v104, v96, v97
    v_cvt_pk_bf16_f32 v105, v98, v99
    v_cvt_pk_bf16_f32 v106, v100, v101
    v_cvt_pk_bf16_f32 v107, v102, v103
    buffer_store_dwordx4 v[104:107], v211, s[32:35], s51 offen offset:2048 sc1
    v_accvgpr_read_b32 v112, a96
    v_accvgpr_read_b32 v113, a97
    v_accvgpr_read_b32 v114, a98
    v_accvgpr_read_b32 v115, a99
    v_accvgpr_read_b32 v116, a112
    v_accvgpr_read_b32 v117, a113
    v_accvgpr_read_b32 v118, a114
    v_accvgpr_read_b32 v119, a115
    v_pk_mul_f32 v[112:113], v[112:113], v[228:229] op_sel:[0,0] op_sel_hi:[1,0]
    v_pk_mul_f32 v[114:115], v[114:115], v[228:229] op_sel:[0,0] op_sel_hi:[1,0]
    v_pk_mul_f32 v[116:117], v[116:117], v[228:229] op_sel:[0,0] op_sel_hi:[1,0]
    v_pk_mul_f32 v[118:119], v[118:119], v[228:229] op_sel:[0,0] op_sel_hi:[1,0]
    v_maximum3_f32 v216, v216, |v112|, |v113|
    v_maximum3_f32 v216, v216, |v114|, |v115|
    v_maximum3_f32 v216, v216, |v116|, |v117|
    v_maximum3_f32 v216, v216, |v118|, |v119|
    v_cvt_pk_bf16_f32 v120, v112, v113
    v_cvt_pk_bf16_f32 v121, v114, v115
    v_cvt_pk_bf16_f32 v122, v116, v117
    v_cvt_pk_bf16_f32 v123, v118, v119
    buffer_store_dwordx4 v[120:123], v211, s[32:35], s51 offen offset:3072 sc1
    s_add_u32 s51, s51, 131072
    v_accvgpr_read_b32 v64, a4
    v_accvgpr_read_b32 v65, a5
    v_accvgpr_read_b32 v66, a6
    v_accvgpr_read_b32 v67, a7
    v_accvgpr_read_b32 v68, a20
    v_accvgpr_read_b32 v69, a21
    v_accvgpr_read_b32 v70, a22
    v_accvgpr_read_b32 v71, a23
    v_pk_mul_f32 v[64:65], v[64:65], v[230:231] op_sel:[0,0] op_sel_hi:[1,0]
    v_pk_mul_f32 v[66:67], v[66:67], v[230:231] op_sel:[0,0] op_sel_hi:[1,0]
    v_pk_mul_f32 v[68:69], v[68:69], v[230:231] op_sel:[0,0] op_sel_hi:[1,0]
    v_pk_mul_f32 v[70:71], v[70:71], v[230:231] op_sel:[0,0] op_sel_hi:[1,0]
    v_maximum3_f32 v216, v216, |v64|, |v65|
    v_maximum3_f32 v216, v216, |v66|, |v67|
    v_maximum3_f32 v216, v216, |v68|, |v69|
    v_maximum3_f32 v216, v216, |v70|, |v71|
    v_cvt_pk_bf16_f32 v72, v64, v65
    v_cvt_pk_bf16_f32 v73, v66, v67
    v_cvt_pk_bf16_f32 v74, v68, v69
    v_cvt_pk_bf16_f32 v75, v70, v71
    buffer_store_dwordx4 v[72:75], v211, s[32:35], s51 offen offset:0 sc1
    v_accvgpr_read_b32 v80, a36
    v_accvgpr_read_b32 v81, a37
    v_accvgpr_read_b32 v82, a38
    v_accvgpr_read_b32 v83, a39
    v_accvgpr_read_b32 v84, a52
    v_accvgpr_read_b32 v85, a53
    v_accvgpr_read_b32 v86, a54
    v_accvgpr_read_b32 v87, a55
    v_pk_mul_f32 v[80:81], v[80:81], v[230:231] op_sel:[0,0] op_sel_hi:[1,0]
    v_pk_mul_f32 v[82:83], v[82:83], v[230:231] op_sel:[0,0] op_sel_hi:[1,0]
    v_pk_mul_f32 v[84:85], v[84:85], v[230:231] op_sel:[0,0] op_sel_hi:[1,0]
    v_pk_mul_f32 v[86:87], v[86:87], v[230:231] op_sel:[0,0] op_sel_hi:[1,0]
    v_maximum3_f32 v216, v216, |v80|, |v81|
    v_maximum3_f32 v216, v216, |v82|, |v83|
    v_maximum3_f32 v216, v216, |v84|, |v85|
    v_maximum3_f32 v216, v216, |v86|, |v87|
    v_cvt_pk_bf16_f32 v88, v80, v81
    v_cvt_pk_bf16_f32 v89, v82, v83
    v_cvt_pk_bf16_f32 v90, v84, v85
    v_cvt_pk_bf16_f32 v91, v86, v87
    buffer_store_dwordx4 v[88:91], v211, s[32:35], s51 offen offset:1024 sc1
    v_accvgpr_read_b32 v96, a68
    v_accvgpr_read_b32 v97, a69
    v_accvgpr_read_b32 v98, a70
    v_accvgpr_read_b32 v99, a71
    v_accvgpr_read_b32 v100, a84
    v_accvgpr_read_b32 v101, a85
    v_accvgpr_read_b32 v102, a86
    v_accvgpr_read_b32 v103, a87
    v_pk_mul_f32 v[96:97], v[96:97], v[230:231] op_sel:[0,0] op_sel_hi:[1,0]
    v_pk_mul_f32 v[98:99], v[98:99], v[230:231] op_sel:[0,0] op_sel_hi:[1,0]
    v_pk_mul_f32 v[100:101], v[100:101], v[230:231] op_sel:[0,0] op_sel_hi:[1,0]
    v_pk_mul_f32 v[102:103], v[102:103], v[230:231] op_sel:[0,0] op_sel_hi:[1,0]
    v_maximum3_f32 v216, v216, |v96|, |v97|
    v_maximum3_f32 v216, v216, |v98|, |v99|
    v_maximum3_f32 v216, v216, |v100|, |v101|
    v_maximum3_f32 v216, v216, |v102|, |v103|
    v_cvt_pk_bf16_f32 v104, v96, v97
    v_cvt_pk_bf16_f32 v105, v98, v99
    v_cvt_pk_bf16_f32 v106, v100, v101
    v_cvt_pk_bf16_f32 v107, v102, v103
    buffer_store_dwordx4 v[104:107], v211, s[32:35], s51 offen offset:2048 sc1
    v_accvgpr_read_b32 v112, a100
    v_accvgpr_read_b32 v113, a101
    v_accvgpr_read_b32 v114, a102
    v_accvgpr_read_b32 v115, a103
    v_accvgpr_read_b32 v116, a116
    v_accvgpr_read_b32 v117, a117
    v_accvgpr_read_b32 v118, a118
    v_accvgpr_read_b32 v119, a119
    v_pk_mul_f32 v[112:113], v[112:113], v[230:231] op_sel:[0,0] op_sel_hi:[1,0]
    v_pk_mul_f32 v[114:115], v[114:115], v[230:231] op_sel:[0,0] op_sel_hi:[1,0]
    v_pk_mul_f32 v[116:117], v[116:117], v[230:231] op_sel:[0,0] op_sel_hi:[1,0]
    v_pk_mul_f32 v[118:119], v[118:119], v[230:231] op_sel:[0,0] op_sel_hi:[1,0]
    v_maximum3_f32 v216, v216, |v112|, |v113|
    v_maximum3_f32 v216, v216, |v114|, |v115|
    v_maximum3_f32 v216, v216, |v116|, |v117|
    v_maximum3_f32 v216, v216, |v118|, |v119|
    v_cvt_pk_bf16_f32 v120, v112, v113
    v_cvt_pk_bf16_f32 v121, v114, v115
    v_cvt_pk_bf16_f32 v122, v116, v117
    v_cvt_pk_bf16_f32 v123, v118, v119
    buffer_store_dwordx4 v[120:123], v211, s[32:35], s51 offen offset:3072 sc1
    s_add_u32 s51, s51, 131072
    v_accvgpr_read_b32 v64, a8
    v_accvgpr_read_b32 v65, a9
    v_accvgpr_read_b32 v66, a10
    v_accvgpr_read_b32 v67, a11
    v_accvgpr_read_b32 v68, a24
    v_accvgpr_read_b32 v69, a25
    v_accvgpr_read_b32 v70, a26
    v_accvgpr_read_b32 v71, a27
    v_pk_mul_f32 v[64:65], v[64:65], v[232:233] op_sel:[0,0] op_sel_hi:[1,0]
    v_pk_mul_f32 v[66:67], v[66:67], v[232:233] op_sel:[0,0] op_sel_hi:[1,0]
    v_pk_mul_f32 v[68:69], v[68:69], v[232:233] op_sel:[0,0] op_sel_hi:[1,0]
    v_pk_mul_f32 v[70:71], v[70:71], v[232:233] op_sel:[0,0] op_sel_hi:[1,0]
    v_maximum3_f32 v216, v216, |v64|, |v65|
    v_maximum3_f32 v216, v216, |v66|, |v67|
    v_maximum3_f32 v216, v216, |v68|, |v69|
    v_maximum3_f32 v216, v216, |v70|, |v71|
    v_cvt_pk_bf16_f32 v72, v64, v65
    v_cvt_pk_bf16_f32 v73, v66, v67
    v_cvt_pk_bf16_f32 v74, v68, v69
    v_cvt_pk_bf16_f32 v75, v70, v71
    buffer_store_dwordx4 v[72:75], v211, s[32:35], s51 offen offset:0 sc1
    v_accvgpr_read_b32 v80, a40
    v_accvgpr_read_b32 v81, a41
    v_accvgpr_read_b32 v82, a42
    v_accvgpr_read_b32 v83, a43
    v_accvgpr_read_b32 v84, a56
    v_accvgpr_read_b32 v85, a57
    v_accvgpr_read_b32 v86, a58
    v_accvgpr_read_b32 v87, a59
    v_pk_mul_f32 v[80:81], v[80:81], v[232:233] op_sel:[0,0] op_sel_hi:[1,0]
    v_pk_mul_f32 v[82:83], v[82:83], v[232:233] op_sel:[0,0] op_sel_hi:[1,0]
    v_pk_mul_f32 v[84:85], v[84:85], v[232:233] op_sel:[0,0] op_sel_hi:[1,0]
    v_pk_mul_f32 v[86:87], v[86:87], v[232:233] op_sel:[0,0] op_sel_hi:[1,0]
    v_maximum3_f32 v216, v216, |v80|, |v81|
    v_maximum3_f32 v216, v216, |v82|, |v83|
    v_maximum3_f32 v216, v216, |v84|, |v85|
    v_maximum3_f32 v216, v216, |v86|, |v87|
    v_cvt_pk_bf16_f32 v88, v80, v81
    v_cvt_pk_bf16_f32 v89, v82, v83
    v_cvt_pk_bf16_f32 v90, v84, v85
    v_cvt_pk_bf16_f32 v91, v86, v87
    buffer_store_dwordx4 v[88:91], v211, s[32:35], s51 offen offset:1024 sc1
    v_accvgpr_read_b32 v96, a72
    v_accvgpr_read_b32 v97, a73
    v_accvgpr_read_b32 v98, a74
    v_accvgpr_read_b32 v99, a75
    v_accvgpr_read_b32 v100, a88
    v_accvgpr_read_b32 v101, a89
    v_accvgpr_read_b32 v102, a90
    v_accvgpr_read_b32 v103, a91
    v_pk_mul_f32 v[96:97], v[96:97], v[232:233] op_sel:[0,0] op_sel_hi:[1,0]
    v_pk_mul_f32 v[98:99], v[98:99], v[232:233] op_sel:[0,0] op_sel_hi:[1,0]
    v_pk_mul_f32 v[100:101], v[100:101], v[232:233] op_sel:[0,0] op_sel_hi:[1,0]
    v_pk_mul_f32 v[102:103], v[102:103], v[232:233] op_sel:[0,0] op_sel_hi:[1,0]
    v_maximum3_f32 v216, v216, |v96|, |v97|
    v_maximum3_f32 v216, v216, |v98|, |v99|
    v_maximum3_f32 v216, v216, |v100|, |v101|
    v_maximum3_f32 v216, v216, |v102|, |v103|
    v_cvt_pk_bf16_f32 v104, v96, v97
    v_cvt_pk_bf16_f32 v105, v98, v99
    v_cvt_pk_bf16_f32 v106, v100, v101
    v_cvt_pk_bf16_f32 v107, v102, v103
    buffer_store_dwordx4 v[104:107], v211, s[32:35], s51 offen offset:2048 sc1
    v_accvgpr_read_b32 v112, a104
    v_accvgpr_read_b32 v113, a105
    v_accvgpr_read_b32 v114, a106
    v_accvgpr_read_b32 v115, a107
    v_accvgpr_read_b32 v116, a120
    v_accvgpr_read_b32 v117, a121
    v_accvgpr_read_b32 v118, a122
    v_accvgpr_read_b32 v119, a123
    v_pk_mul_f32 v[112:113], v[112:113], v[232:233] op_sel:[0,0] op_sel_hi:[1,0]
    v_pk_mul_f32 v[114:115], v[114:115], v[232:233] op_sel:[0,0] op_sel_hi:[1,0]
    v_pk_mul_f32 v[116:117], v[116:117], v[232:233] op_sel:[0,0] op_sel_hi:[1,0]
    v_pk_mul_f32 v[118:119], v[118:119], v[232:233] op_sel:[0,0] op_sel_hi:[1,0]
    v_maximum3_f32 v216, v216, |v112|, |v113|
    v_maximum3_f32 v216, v216, |v114|, |v115|
    v_maximum3_f32 v216, v216, |v116|, |v117|
    v_maximum3_f32 v216, v216, |v118|, |v119|
    v_cvt_pk_bf16_f32 v120, v112, v113
    v_cvt_pk_bf16_f32 v121, v114, v115
    v_cvt_pk_bf16_f32 v122, v116, v117
    v_cvt_pk_bf16_f32 v123, v118, v119
    buffer_store_dwordx4 v[120:123], v211, s[32:35], s51 offen offset:3072 sc1
    s_add_u32 s51, s51, 131072
    v_accvgpr_read_b32 v64, a12
    v_accvgpr_read_b32 v65, a13
    v_accvgpr_read_b32 v66, a14
    v_accvgpr_read_b32 v67, a15
    v_accvgpr_read_b32 v68, a28
    v_accvgpr_read_b32 v69, a29
    v_accvgpr_read_b32 v70, a30
    v_accvgpr_read_b32 v71, a31
    v_pk_mul_f32 v[64:65], v[64:65], v[234:235] op_sel:[0,0] op_sel_hi:[1,0]
    v_pk_mul_f32 v[66:67], v[66:67], v[234:235] op_sel:[0,0] op_sel_hi:[1,0]
    v_pk_mul_f32 v[68:69], v[68:69], v[234:235] op_sel:[0,0] op_sel_hi:[1,0]
    v_pk_mul_f32 v[70:71], v[70:71], v[234:235] op_sel:[0,0] op_sel_hi:[1,0]
    v_maximum3_f32 v216, v216, |v64|, |v65|
    v_maximum3_f32 v216, v216, |v66|, |v67|
    v_maximum3_f32 v216, v216, |v68|, |v69|
    v_maximum3_f32 v216, v216, |v70|, |v71|
    v_cvt_pk_bf16_f32 v72, v64, v65
    v_cvt_pk_bf16_f32 v73, v66, v67
    v_cvt_pk_bf16_f32 v74, v68, v69
    v_cvt_pk_bf16_f32 v75, v70, v71
    buffer_store_dwordx4 v[72:75], v211, s[32:35], s51 offen offset:0 sc1
    v_accvgpr_read_b32 v80, a44
    v_accvgpr_read_b32 v81, a45
    v_accvgpr_read_b32 v82, a46
    v_accvgpr_read_b32 v83, a47
    v_accvgpr_read_b32 v84, a60
    v_accvgpr_read_b32 v85, a61
    v_accvgpr_read_b32 v86, a62
    v_accvgpr_read_b32 v87, a63
    v_pk_mul_f32 v[80:81], v[80:81], v[234:235] op_sel:[0,0] op_sel_hi:[1,0]
    v_pk_mul_f32 v[82:83], v[82:83], v[234:235] op_sel:[0,0] op_sel_hi:[1,0]
    v_pk_mul_f32 v[84:85], v[84:85], v[234:235] op_sel:[0,0] op_sel_hi:[1,0]
    v_pk_mul_f32 v[86:87], v[86:87], v[234:235] op_sel:[0,0] op_sel_hi:[1,0]
    v_maximum3_f32 v216, v216, |v80|, |v81|
    v_maximum3_f32 v216, v216, |v82|, |v83|
    v_maximum3_f32 v216, v216, |v84|, |v85|
    v_maximum3_f32 v216, v216, |v86|, |v87|
    v_cvt_pk_bf16_f32 v88, v80, v81
    v_cvt_pk_bf16_f32 v89, v82, v83
    v_cvt_pk_bf16_f32 v90, v84, v85
    v_cvt_pk_bf16_f32 v91, v86, v87
    buffer_store_dwordx4 v[88:91], v211, s[32:35], s51 offen offset:1024 sc1
    v_accvgpr_read_b32 v96, a76
    v_accvgpr_read_b32 v97, a77
    v_accvgpr_read_b32 v98, a78
    v_accvgpr_read_b32 v99, a79
    v_accvgpr_read_b32 v100, a92
    v_accvgpr_read_b32 v101, a93
    v_accvgpr_read_b32 v102, a94
    v_accvgpr_read_b32 v103, a95
    v_pk_mul_f32 v[96:97], v[96:97], v[234:235] op_sel:[0,0] op_sel_hi:[1,0]
    v_pk_mul_f32 v[98:99], v[98:99], v[234:235] op_sel:[0,0] op_sel_hi:[1,0]
    v_pk_mul_f32 v[100:101], v[100:101], v[234:235] op_sel:[0,0] op_sel_hi:[1,0]
L_it9:
    s_cbranch_execz L_it13
    v_pk_mul_f32 v[102:103], v[102:103], v[234:235] op_sel:[0,0] op_sel_hi:[1,0]
    v_maximum3_f32 v216, v216, |v96|, |v97|
    v_maximum3_f32 v216, v216, |v98|, |v99|
    v_maximum3_f32 v216, v216, |v100|, |v101|
    v_maximum3_f32 v216, v216, |v102|, |v103|
    v_cvt_pk_bf16_f32 v104, v96, v97
    v_cvt_pk_bf16_f32 v105, v98, v99
    v_cvt_pk_bf16_f32 v106, v100, v101
    v_cvt_pk_bf16_f32 v107, v102, v103
    buffer_store_dwordx4 v[104:107], v211, s[32:35], s51 offen offset:2048 sc1
    v_accvgpr_read_b32 v112, a108
    v_accvgpr_read_b32 v113, a109
    v_accvgpr_read_b32 v114, a110
    v_accvgpr_read_b32 v115, a111
    v_accvgpr_read_b32 v116, a124
    v_accvgpr_read_b32 v117, a125
    v_accvgpr_read_b32 v118, a126
    v_accvgpr_read_b32 v119, a127
    v_pk_mul_f32 v[112:113], v[112:113], v[234:235] op_sel:[0,0] op_sel_hi:[1,0]
    v_pk_mul_f32 v[114:115], v[114:115], v[234:235] op_sel:[0,0] op_sel_hi:[1,0]
    v_pk_mul_f32 v[116:117], v[116:117], v[234:235] op_sel:[0,0] op_sel_hi:[1,0]
    v_pk_mul_f32 v[118:119], v[118:119], v[234:235] op_sel:[0,0] op_sel_hi:[1,0]
    v_maximum3_f32 v216, v216, |v112|, |v113|
    v_maximum3_f32 v216, v216, |v114|, |v115|
    v_maximum3_f32 v216, v216, |v116|, |v117|
    v_maximum3_f32 v216, v216, |v118|, |v119|
    v_cvt_pk_bf16_f32 v120, v112, v113
    v_cvt_pk_bf16_f32 v121, v114, v115
    v_cvt_pk_bf16_f32 v122, v116, v117
    v_cvt_pk_bf16_f32 v123, v118, v119
    buffer_store_dwordx4 v[120:123], v211, s[32:35], s51 offen offset:3072 sc1
    buffer_load_dwordx4 a[160:163], v211, s[24:27], s90 offen sc1
    s_add_u32 s90, s90, 4096
    buffer_load_dwordx4 a[164:167], v211, s[24:27], s91 offen sc1
    s_add_u32 s91, s91, 4096
    buffer_load_dwordx4 a[168:171], v211, s[24:27], s92 offen sc1
    s_add_u32 s92, s92, 4096
    buffer_load_dwordx4 a[172:175], v211, s[24:27], s93 offen sc1
    s_add_u32 s93, s93, 4096
    s_cmp_lg_u32 s50, 0
    s_cbranch_scc1 L3_dobar
    s_mov_b32 s53, 0x7f800000
    v_cmp_gt_f32 vcc, s53, v216
    s_nop 3
    s_and_b64 s[56:57], s[56:57], vcc
    v_cmp_lt_f32 vcc, 0x30800000, v216
    s_nop 3
    s_and_b64 s[56:57], s[56:57], vcc
    s_cmp_eq_u64 s[56:57], -1
    s_cselect_b32 s52, 0, 1
    v_mov_b32 v218, s52
    v_mov_b32 v219, s44
    v_lshlrev_b32 v219, 2, v219
    v_add_u32 v219, 0x20000, v219
    ds_write_b32 v219, v218
    v_mov_b32 v219, 0x20000
    s_waitcnt lgkmcnt(0)
    s_barrier
    ds_read_b128 v[220:223], v219
    s_waitcnt lgkmcnt(0)
    v_or_b32 v220, v220, v221
    v_or3_b32 v220, v220, v222, v223
    s_nop 0
    v_readfirstlane_b32 s52, v220
    s_nop 3
    s_cmp_eq_u32 s52, 0
    s_cbranch_scc0 L2_fb
L3_go:
    v_add_u32 v180, 0x10000, v248
    v_add_u32 v181, 0x10000, v249
    v_add_u32 v182, 0x10000, v250
    v_add_u32 v183, 0x10000, v251
    ds_read_b64_tr_b16 v[64:65], v248 offset:0
    ds_read_b64_tr_b16 v[66:67], v248 offset:2048
    ds_read_b64_tr_b16 v[68:69], v249 offset:0
    ds_read_b64_tr_b16 v[70:71], v249 offset:2048
    ds_read_b64_tr_b16 v[72:73], v250 offset:0
    ds_read_b64_tr_b16 v[74:75], v250 offset:2048
    ds_read_b64_tr_b16 v[76:77], v251 offset:0
    ds_read_b64_tr_b16 v[78:79], v251 offset:2048
    s_lshl_b32 s3, s44, 11
    s_add_u32 s3, s3, 0x20000
    v_add_u32 v204, s3, v211
    s_lshl_b32 s3, s44, 13
    s_add_u32 s3, s3, 0x20000
    v_add_u32 v205, s3, v211
    s_waitcnt lgkmcnt(0)
    v_mfma_f32_16x16x32_bf16 v[0:3], v[64:67], a[192:195], 0
    ds_read_b64_tr_b16 v[80:81], v248 offset:16384
    v_mfma_f32_16x16x32_bf16 v[4:7], v[64:67], a[196:199], 0
    ds_read_b64_tr_b16 v[82:83], v248 offset:18432
    v_mfma_f32_16x16x32_bf16 v[8:11], v[64:67], a[200:203], 0
    ds_read_b64_tr_b16 v[84:85], v249 offset:16384
    v_mfma_f32_16x16x32_bf16 v[12:15], v[64:67], a[204:207], 0
    ds_read_b64_tr_b16 v[86:87], v249 offset:18432
    v_mfma_f32_16x16x32_bf16 v[16:19], v[68:71], a[192:195], 0
    ds_read_b64_tr_b16 v[88:89], v250 offset:16384
    v_mfma_f32_16x16x32_bf16 v[20:23], v[68:71], a[196:199], 0
    ds_read_b64_tr_b16 v[90:91], v250 offset:18432
    v_mfma_f32_16x16x32_bf16 v[24:27], v[68:71], a[200:203], 0
    ds_read_b64_tr_b16 v[92:93], v251 offset:16384
    v_mfma_f32_16x16x32_bf16 v[28:31], v[68:71], a[204:207], 0
    ds_read_b64_tr_b16 v[94:95], v251 offset:18432
    v_mfma_f32_16x16x32_bf16 v[32:35], v[72:75], a[192:195], 0
    s_add_u32 m0, s95, 0x1c000
    s_add_u32 s94, s37, 0x1c000
    buffer_load_dwordx4 v211, s[68:71], s94 offen offset:0 sc1 lds
    v_mfma_f32_16x16x32_bf16 v[36:39], v[72:75], a[196:199], 0
    buffer_load_dwordx4 v211, s[68:71], s94 offen offset:1024 sc1 lds
    v_mfma_f32_16x16x32_bf16 v[40:43], v[72:75], a[200:203], 0
    buffer_load_dwordx4 v211, s[68:71], s94 offen offset:2048 sc1 lds
    v_mfma_f32_16x16x32_bf16 v[44:47], v[72:75], a[204:207], 0
    buffer_load_dwordx4 v211, s[68:71], s94 offen offset:3072 sc1 lds
    v_mfma_f32_16x16x32_bf16 v[48:51], v[76:79], a[192:195], 0
    buffer_load_dwordx4 a[176:179], v211, s[24:27], s90 offen sc1
    s_add_u32 s90, s90, 4096
    v_mfma_f32_16x16x32_bf16 v[52:55], v[76:79], a[196:199], 0
    buffer_load_dwordx4 a[180:183], v211, s[24:27], s91 offen sc1
    s_add_u32 s91, s91, 4096
    v_mfma_f32_16x16x32_bf16 v[56:59], v[76:79], a[200:203], 0
    buffer_load_dwordx4 a[184:187], v211, s[24:27], s92 offen sc1
    s_add_u32 s92, s92, 4096
    v_mfma_f32_16x16x32_bf16 v[60:63], v[76:79], a[204:207], 0
    buffer_load_dwordx4 a[188:191], v211, s[24:27], s93 offen sc1
    s_add_u32 s93, s93, 4096
    s_waitcnt vmcnt(28) lgkmcnt(0)
    v_mfma_f32_16x16x32_bf16 v[0:3], v[80:83], a[208:211], v[0:3]
    ds_read_b64_tr_b16 v[64:65], v248 offset:32768
    v_mfma_f32_16x16x32_bf16 v[4:7], v[80:83], a[212:215], v[4:7]
    ds_read_b64_tr_b16 v[66:67], v248 offset:34816
    v_mfma_f32_16x16x32_bf16 v[8:11], v[80:83], a[216:219], v[8:11]
    ds_read_b64_tr_b16 v[68:69], v249 offset:32768
    v_mfma_f32_16x16x32_bf16 v[12:15], v[80:83], a[220:223], v[12:15]
    ds_read_b64_tr_b16 v[70:71], v249 offset:34816
    v_mfma_f32_16x16x32_bf16 v[16:19], v[84:87], a[208:211], v[16:19]
    ds_read_b64_tr_b16 v[72:73], v250 offset:32768
    v_mfma_f32_16x16x32_bf16 v[20:23], v[84:87], a[212:215], v[20:23]
    ds_read_b64_tr_b16 v[74:75], v250 offset:34816
    v_mfma_f32_16x16x32_bf16 v[24:27], v[84:87], a[216:219], v[24:27]
    ds_read_b64_tr_b16 v[76:77], v251 offset:32768
    v_mfma_f32_16x16x32_bf16 v[28:31], v[84:87], a[220:223], v[28:31]
    ds_read_b64_tr_b16 v[78:79], v251 offset:34816
    v_mfma_f32_16x16x32_bf16 v[32:35], v[88:91], a[208:211], v[32:35]
    s_add_u32 m0, s95, 0x0
    s_add_u32 s94, s37, 0x20000
    buffer_load_dwordx4 v211, s[68:71], s94 offen offset:0 sc1 lds
    v_mfma_f32_16x16x32_bf16 v[36:39], v[88:91], a[212:215], v[36:39]
    buffer_load_dwordx4 v211, s[68:71], s94 offen offset:1024 sc1 lds
    v_mfma_f32_16x16x32_bf16 v[40:43], v[88:91], a[216:219], v[40:43]
    buffer_load_dwordx4 v211, s[68:71], s94 offen offset:2048 sc1 lds
    v_mfma_f32_16x16x32_bf16 v[44:47], v[88:91], a[220:223], v[44:47]
    buffer_load_dwordx4 v211, s[68:71], s94 offen offset:3072 sc1 lds
    v_mfma_f32_16x16x32_bf16 v[48:51], v[92:95], a[208:211], v[48:51]
    buffer_load_dwordx4 a[192:195], v211, s[24:27], s90 offen sc1
    s_add_u32 s90, s90, 4096
    v_mfma_f32_16x16x32_bf16 v[52:55], v[92:95], a[212:215], v[52:55]
    buffer_load_dwordx4 a[196:199], v211, s[24:27], s91 offen sc1
    s_add_u32 s91, s91, 4096
    v_mfma_f32_16x16x32_bf16 v[56:59], v[92:95], a[216:219], v[56:59]
    buffer_load_dwordx4 a[200:203], v211, s[24:27], s92 offen sc1
    s_add_u32 s92, s92, 4096
    v_mfma_f32_16x16x32_bf16 v[60:63], v[92:95], a[220:223], v[60:63]
    buffer_load_dwordx4 a[204:207], v211, s[24:27], s93 offen sc1
    s_add_u32 s93, s93, 4096
    s_waitcnt lgkmcnt(0)
    v_mfma_f32_16x16x32_bf16 v[0:3], v[64:67], a[224:227], v[0:3]
    ds_read_b64_tr_b16 v[80:81], v248 offset:49152
    v_mfma_f32_16x16x32_bf16 v[4:7], v[64:67], a[228:231], v[4:7]
    ds_read_b64_tr_b16 v[82:83], v248 offset:51200
    v_mfma_f32_16x16x32_bf16 v[8:11], v[64:67], a[232:235], v[8:11]
    ds_read_b64_tr_b16 v[84:85], v249 offset:49152
    v_mfma_f32_16x16x32_bf16 v[12:15], v[64:67], a[236:239], v[12:15]
    ds_read_b64_tr_b16 v[86:87], v249 offset:51200
    v_mfma_f32_16x16x32_bf16 v[16:19], v[68:71], a[224:227], v[16:19]
    ds_read_b64_tr_b16 v[88:89], v250 offset:49152
    v_mfma_f32_16x16x32_bf16 v[20:23], v[68:71], a[228:231], v[20:23]
    ds_read_b64_tr_b16 v[90:91], v250 offset:51200
    v_mfma_f32_16x16x32_bf16 v[24:27], v[68:71], a[232:235], v[24:27]
    ds_read_b64_tr_b16 v[92:93], v251 offset:49152
    v_mfma_f32_16x16x32_bf16 v[28:31], v[68:71], a[236:239], v[28:31]
    ds_read_b64_tr_b16 v[94:95], v251 offset:51200
    v_mfma_f32_16x16x32_bf16 v[32:35], v[72:75], a[224:227], v[32:35]
    s_add_u32 m0, s95, 0x4000
    s_add_u32 s94, s37, 0x24000
    buffer_load_dwordx4 v211, s[68:71], s94 offen offset:0 sc1 lds
    v_mfma_f32_16x16x32_bf16 v[36:39], v[72:75], a[228:231], v[36:39]
    buffer_load_dwordx4 v211, s[68:71], s94 offen offset:1024 sc1 lds
    v_mfma_f32_16x16x32_bf16 v[40:43], v[72:75], a[232:235], v[40:43]
    buffer_load_dwordx4 v211, s[68:71], s94 offen offset:2048 sc1 lds
    v_mfma_f32_16x16x32_bf16 v[44:47], v[72:75], a[236:239], v[44:47]
    buffer_load_dwordx4 v211, s[68:71], s94 offen offset:3072 sc1 lds
    v_mfma_f32_16x16x32_bf16 v[48:51], v[76:79], a[224:227], v[48:51]
    buffer_load_dwordx4 a[208:211], v211, s[24:27], s90 offen sc1
    s_add_u32 s90, s90, 4096
    v_mfma_f32_16x16x32_bf16 v[52:55], v[76:79], a[228:231], v[52:55]
    buffer_load_dwordx4 a[212:215], v211, s[24:27], s91 offen sc1
    s_add_u32 s91, s91, 4096
    v_mfma_f32_16x16x32_bf16 v[56:59], v[76:79], a[232:235], v[56:59]
    buffer_load_dwordx4 a[216:219], v211, s[24:27], s92 offen sc1
    s_add_u32 s92, s92, 4096
    v_mfma_f32_16x16x32_bf16 v[60:63], v[76:79], a[236:239], v[60:63]
    buffer_load_dwordx4 a[220:223], v211, s[24:27], s93 offen sc1
    s_add_u32 s93, s93, 4096
    s_waitcnt lgkmcnt(0)
    s_waitcnt vmcnt(28)
    s_barrier
    s_cmp_eq_u32 s44, 0
    s_cbranch_scc0 L3_nosig
    v_lshlrev_b32 v244, 22, v211
    v_mov_b32 v245, s72
    s_lshl_b32 s3, s2, 7
    s_add_u32 s3, s3, 0x10000
    buffer_store_dword v245, v244, s[24:27], s3 offen sc1
L3_nosig:
    v_mfma_f32_16x16x32_bf16 v[0:3], v[80:83], a[240:243], v[0:3]
    ds_read_b64_tr_b16 v[64:65], v180 offset:0
    v_mfma_f32_16x16x32_bf16 v[4:7], v[80:83], a[244:247], v[4:7]
    ds_read_b64_tr_b16 v[66:67], v180 offset:2048
    v_mfma_f32_16x16x32_bf16 v[8:11], v[80:83], a[248:251], v[8:11]
    ds_read_b64_tr_b16 v[68:69], v181 offset:0
    v_mfma_f32_16x16x32_bf16 v[12:15], v[80:83], a[252:255], v[12:15]
    ds_read_b64_tr_b16 v[70:71], v181 offset:2048
    v_mfma_f32_16x16x32_bf16 v[16:19], v[84:87], a[240:243], v[16:19]
    ds_read_b64_tr_b16 v[72:73], v182 offset:0
    v_mfma_f32_16x16x32_bf16 v[20:23], v[84:87], a[244:247], v[20:23]
    ds_read_b64_tr_b16 v[74:75], v182 offset:2048
    v_mfma_f32_16x16x32_bf16 v[24:27], v[84:87], a[248:251], v[24:27]
    ds_read_b64_tr_b16 v[76:77], v183 offset:0
    v_mfma_f32_16x16x32_bf16 v[28:31], v[84:87], a[252:255], v[28:31]
    ds_read_b64_tr_b16 v[78:79], v183 offset:2048
    v_mfma_f32_16x16x32_bf16 v[32:35], v[88:91], a[240:243], v[32:35]
    s_add_u32 m0, s95, 0x8000
    s_add_u32 s94, s37, 0x28000
    buffer_load_dwordx4 v211, s[68:71], s94 offen offset:0 sc1 lds
    v_mfma_f32_16x16x32_bf16 v[36:39], v[88:91], a[244:247], v[36:39]
    buffer_load_dwordx4 v211, s[68:71], s94 offen offset:1024 sc1 lds
    v_mfma_f32_16x16x32_bf16 v[40:43], v[88:91], a[248:251], v[40:43]
    buffer_load_dwordx4 v211, s[68:71], s94 offen offset:2048 sc1 lds
    v_mfma_f32_16x16x32_bf16 v[44:47], v[88:91], a[252:255], v[44:47]
    buffer_load_dwordx4 v211, s[68:71], s94 offen offset:3072 sc1 lds
    v_mfma_f32_16x16x32_bf16 v[48:51], v[92:95], a[240:243], v[48:51]
    buffer_load_dwordx4 a[224:227], v211, s[24:27], s90 offen sc1
    s_add_u32 s90, s90, 4096
    v_mfma_f32_16x16x32_bf16 v[52:55], v[92:95], a[244:247], v[52:55]
    buffer_load_dwordx4 a[228:231], v211, s[24:27], s91 offen sc1
    s_add_u32 s91, s91, 4096
    v_mfma_f32_16x16x32_bf16 v[56:59], v[92:95], a[248:251], v[56:59]
    buffer_load_dwordx4 a[232:235], v211, s[24:27], s92 offen sc1
    s_add_u32 s92, s92, 4096
    v_mfma_f32_16x16x32_bf16 v[60:63], v[92:95], a[252:255], v[60:63]
    buffer_load_dwordx4 a[236:239], v211, s[24:27], s93 offen sc1
    s_add_u32 s93, s93, 4096
    s_waitcnt lgkmcnt(0)
    v_mfma_f32_16x16x32_bf16 v[0:3], v[64:67], a[128:131], v[0:3]
    ds_read_b64_tr_b16 v[80:81], v180 offset:16384
    v_mfma_f32_16x16x32_bf16 v[4:7], v[64:67], a[132:135], v[4:7]
    ds_read_b64_tr_b16 v[82:83], v180 offset:18432
    v_mfma_f32_16x16x32_bf16 v[8:11], v[64:67], a[136:139], v[8:11]
    ds_read_b64_tr_b16 v[84:85], v181 offset:16384
    v_mfma_f32_16x16x32_bf16 v[12:15], v[64:67], a[140:143], v[12:15]
    ds_read_b64_tr_b16 v[86:87], v181 offset:18432
    v_mfma_f32_16x16x32_bf16 v[16:19], v[68:71], a[128:131], v[16:19]
    ds_read_b64_tr_b16 v[88:89], v182 offset:16384
    v_mfma_f32_16x16x32_bf16 v[20:23], v[68:71], a[132:135], v[20:23]
    ds_read_b64_tr_b16 v[90:91], v182 offset:18432
    v_mfma_f32_16x16x32_bf16 v[24:27], v[68:71], a[136:139], v[24:27]
    ds_read_b64_tr_b16 v[92:93], v183 offset:16384
    v_mfma_f32_16x16x32_bf16 v[28:31], v[68:71], a[140:143], v[28:31]
    ds_read_b64_tr_b16 v[94:95], v183 offset:18432
    v_mfma_f32_16x16x32_bf16 v[32:35], v[72:75], a[128:131], v[32:35]
    s_add_u32 m0, s95, 0xc000
    s_add_u32 s94, s37, 0x2c000
    buffer_load_dwordx4 v211, s[68:71], s94 offen offset:0 sc1 lds
    v_mfma_f32_16x16x32_bf16 v[36:39], v[72:75], a[132:135], v[36:39]
    buffer_load_dwordx4 v211, s[68:71], s94 offen offset:1024 sc1 lds
    v_mfma_f32_16x16x32_bf16 v[40:43], v[72:75], a[136:139], v[40:43]
    buffer_load_dwordx4 v211, s[68:71], s94 offen offset:2048 sc1 lds
    v_mfma_f32_16x16x32_bf16 v[44:47], v[72:75], a[140:143], v[44:47]
    buffer_load_dwordx4 v211, s[68:71], s94 offen offset:3072 sc1 lds
    v_mfma_f32_16x16x32_bf16 v[48:51], v[76:79], a[128:131], v[48:51]
    buffer_load_dwordx4 a[240:243], v211, s[24:27], s90 offen sc1
    s_add_u32 s90, s90, 4096
    v_mfma_f32_16x16x32_bf16 v[52:55], v[76:79], a[132:135], v[52:55]
    buffer_load_dwordx4 a[244:247], v211, s[24:27], s91 offen sc1
    s_add_u32 s91, s91, 4096
    v_mfma_f32_16x16x32_bf16 v[56:59], v[76:79], a[136:139], v[56:59]
    buffer_load_dwordx4 a[248:251], v211, s[24:27], s92 offen sc1
    s_add_u32 s92, s92, 4096
    v_mfma_f32_16x16x32_bf16 v[60:63], v[76:79], a[140:143], v[60:63]
    buffer_load_dwordx4 a[252:255], v211, s[24:27], s93 offen sc1
    s_add_u32 s93, s93, 4096
    s_waitcnt lgkmcnt(0)
    v_mfma_f32_16x16x32_bf16 v[0:3], v[80:83], a[144:147], v[0:3]
    ds_read_b64_tr_b16 v[64:65], v180 offset:32768
    v_mfma_f32_16x16x32_bf16 v[4:7], v[80:83], a[148:151], v[4:7]
    ds_read_b64_tr_b16 v[66:67], v180 offset:34816
    v_mfma_f32_16x16x32_bf16 v[8:11], v[80:83], a[152:155], v[8:11]
    ds_read_b64_tr_b16 v[68:69], v181 offset:32768
    v_mfma_f32_16x16x32_bf16 v[12:15], v[80:83], a[156:159], v[12:15]
    ds_read_b64_tr_b16 v[70:71], v181 offset:34816
    v_mfma_f32_16x16x32_bf16 v[16:19], v[84:87], a[144:147], v[16:19]
    ds_read_b64_tr_b16 v[72:73], v182 offset:32768
    v_mfma_f32_16x16x32_bf16 v[20:23], v[84:87], a[148:151], v[20:23]
    ds_read_b64_tr_b16 v[74:75], v182 offset:34816
    v_mfma_f32_16x16x32_bf16 v[24:27], v[84:87], a[152:155], v[24:27]
    ds_read_b64_tr_b16 v[76:77], v183 offset:32768
    v_mfma_f32_16x16x32_bf16 v[28:31], v[84:87], a[156:159], v[28:31]
    ds_read_b64_tr_b16 v[78:79], v183 offset:34816
    v_mfma_f32_16x16x32_bf16 v[32:35], v[88:91], a[144:147], v[32:35]
    s_add_u32 m0, s95, 0x10000
    s_add_u32 s94, s37, 0x30000
    buffer_load_dwordx4 v211, s[68:71], s94 offen offset:0 sc1 lds
    v_mfma_f32_16x16x32_bf16 v[36:39], v[88:91], a[148:151], v[36:39]
    buffer_load_dwordx4 v211, s[68:71], s94 offen offset:1024 sc1 lds
    v_mfma_f32_16x16x32_bf16 v[40:43], v[88:91], a[152:155], v[40:43]
    buffer_load_dwordx4 v211, s[68:71], s94 offen offset:2048 sc1 lds
    v_mfma_f32_16x16x32_bf16 v[44:47], v[88:91], a[156:159], v[44:47]
    buffer_load_dwordx4 v211, s[68:71], s94 offen offset:3072 sc1 lds
    v_mfma_f32_16x16x32_bf16 v[48:51], v[92:95], a[144:147], v[48:51]
    buffer_load_dwordx4 a[128:131], v211, s[24:27], s90 offen sc1
    s_add_u32 s90, s90, 4096
    v_mfma_f32_16x16x32_bf16 v[52:55], v[92:95], a[148:151], v[52:55]
    buffer_load_dwordx4 a[132:135], v211, s[24:27], s91 offen sc1
    s_add_u32 s91, s91, 4096
    v_mfma_f32_16x16x32_bf16 v[56:59], v[92:95], a[152:155], v[56:59]
    buffer_load_dwordx4 a[136:139], v211, s[24:27], s92 offen sc1
    s_add_u32 s92, s92, 4096
    v_mfma_f32_16x16x32_bf16 v[60:63], v[92:95], a[156:159], v[60:63]
    buffer_load_dwordx4 a[140:143], v211, s[24:27], s93 offen sc1
    s_add_u32 s93, s93, 4096
    s_waitcnt vmcnt(44) lgkmcnt(0)
    v_mfma_f32_16x16x32_bf16 v[0:3], v[64:67], a[160:163], v[0:3]
    ds_read_b64_tr_b16 v[80:81], v180 offset:49152
    v_mfma_f32_16x16x32_bf16 v[4:7], v[64:67], a[164:167], v[4:7]
    ds_read_b64_tr_b16 v[82:83], v180 offset:51200
    v_mfma_f32_16x16x32_bf16 v[8:11], v[64:67], a[168:171], v[8:11]
    ds_read_b64_tr_b16 v[84:85], v181 offset:49152
    v_mfma_f32_16x16x32_bf16 v[12:15], v[64:67], a[172:175], v[12:15]
    ds_read_b64_tr_b16 v[86:87], v181 offset:51200
    v_mfma_f32_16x16x32_bf16 v[16:19], v[68:71], a[160:163], v[16:19]
    ds_read_b64_tr_b16 v[88:89], v182 offset:49152
    v_mfma_f32_16x16x32_bf16 v[20:23], v[68:71], a[164:167], v[20:23]
    ds_read_b64_tr_b16 v[90:91], v182 offset:51200
    v_mfma_f32_16x16x32_bf16 v[24:27], v[68:71], a[168:171], v[24:27]
    ds_read_b64_tr_b16 v[92:93], v183 offset:49152
    v_mfma_f32_16x16x32_bf16 v[28:31], v[68:71], a[172:175], v[28:31]
    ds_read_b64_tr_b16 v[94:95], v183 offset:51200
    v_mfma_f32_16x16x32_bf16 v[32:35], v[72:75], a[160:163], v[32:35]
    s_add_u32 m0, s95, 0x14000
    s_add_u32 s94, s37, 0x34000
    buffer_load_dwordx4 v211, s[68:71], s94 offen offset:0 sc1 lds
    v_mfma_f32_16x16x32_bf16 v[36:39], v[72:75], a[164:167], v[36:39]
    buffer_load_dwordx4 v211, s[68:71], s94 offen offset:1024 sc1 lds
    v_mfma_f32_16x16x32_bf16 v[40:43], v[72:75], a[168:171], v[40:43]
    buffer_load_dwordx4 v211, s[68:71], s94 offen offset:2048 sc1 lds
    v_mfma_f32_16x16x32_bf16 v[44:47], v[72:75], a[172:175], v[44:47]
    buffer_load_dwordx4 v211, s[68:71], s94 offen offset:3072 sc1 lds
    v_mfma_f32_16x16x32_bf16 v[48:51], v[76:79], a[160:163], v[48:51]
    buffer_load_dwordx4 a[144:147], v211, s[24:27], s90 offen sc1
    s_add_u32 s90, s90, 4096
    v_mfma_f32_16x16x32_bf16 v[52:55], v[76:79], a[164:167], v[52:55]
    buffer_load_dwordx4 a[148:151], v211, s[24:27], s91 offen sc1
    s_add_u32 s91, s91, 4096
    v_mfma_f32_16x16x32_bf16 v[56:59], v[76:79], a[168:171], v[56:59]
    buffer_load_dwordx4 a[152:155], v211, s[24:27], s92 offen sc1
    s_add_u32 s92, s92, 4096
    v_mfma_f32_16x16x32_bf16 v[60:63], v[76:79], a[172:175], v[60:63]
    buffer_load_dwordx4 a[156:159], v211, s[24:27], s93 offen sc1
    s_add_u32 s93, s93, 4096
    s_waitcnt vmcnt(44) lgkmcnt(0)
    v_mfma_f32_16x16x32_bf16 v[0:3], v[80:83], a[176:179], v[0:3]
    ds_read_b64_tr_b16 v[64:65], v248 offset:0
    v_mfma_f32_16x16x32_bf16 v[4:7], v[80:83], a[180:183], v[4:7]
    ds_read_b64_tr_b16 v[66:67], v248 offset:2048
    v_mfma_f32_16x16x32_bf16 v[8:11], v[80:83], a[184:187], v[8:11]
    ds_read_b64_tr_b16 v[68:69], v249 offset:0
    v_mfma_f32_16x16x32_bf16 v[12:15], v[80:83], a[188:191], v[12:15]
    ds_read_b64_tr_b16 v[70:71], v249 offset:2048
    v_mfma_f32_16x16x32_bf16 v[16:19], v[84:87], a[176:179], v[16:19]
    ds_read_b64_tr_b16 v[72:73], v250 offset:0
    v_mfma_f32_16x16x32_bf16 v[20:23], v[84:87], a[180:183], v[20:23]
    ds_read_b64_tr_b16 v[74:75], v250 offset:2048
    v_mfma_f32_16x16x32_bf16 v[24:27], v[84:87], a[184:187], v[24:27]
    ds_read_b64_tr_b16 v[76:77], v251 offset:0
    v_mfma_f32_16x16x32_bf16 v[28:31], v[84:87], a[188:191], v[28:31]
    ds_read_b64_tr_b16 v[78:79], v251 offset:2048
    v_mfma_f32_16x16x32_bf16 v[32:35], v[88:91], a[176:179], v[32:35]
    s_add_u32 m0, s95, 0x18000
    s_add_u32 s94, s36, 0x0
    buffer_load_dwordx4 v211, s[68:71], s94 offen offset:0 sc1 lds
    v_mfma_f32_16x16x32_bf16 v[36:39], v[88:91], a[180:183], v[36:39]
    buffer_load_dwordx4 v211, s[68:71], s94 offen offset:1024 sc1 lds
    v_mfma_f32_16x16x32_bf16 v[40:43], v[88:91], a[184:187], v[40:43]
    buffer_load_dwordx4 v211, s[68:71], s94 offen offset:2048 sc1 lds
    v_mfma_f32_16x16x32_bf16 v[44:47], v[88:91], a[188:191], v[44:47]
    buffer_load_dwordx4 v211, s[68:71], s94 offen offset:3072 sc1 lds
    v_mfma_f32_16x16x32_bf16 v[48:51], v[92:95], a[176:179], v[48:51]
    v_mfma_f32_16x16x32_bf16 v[52:55], v[92:95], a[180:183], v[52:55]
    v_mfma_f32_16x16x32_bf16 v[56:59], v[92:95], a[184:187], v[56:59]
    v_mfma_f32_16x16x32_bf16 v[60:63], v[92:95], a[188:191], v[60:63]
    s_waitcnt vmcnt(40) lgkmcnt(0)
    v_mfma_f32_16x16x32_bf16 v[0:3], v[64:67], a[192:195], v[0:3]
    ds_read_b64_tr_b16 v[80:81], v248 offset:16384
    v_mfma_f32_16x16x32_bf16 v[4:7], v[64:67], a[196:199], v[4:7]
    ds_read_b64_tr_b16 v[82:83], v248 offset:18432
    v_mfma_f32_16x16x32_bf16 v[8:11], v[64:67], a[200:203], v[8:11]
    ds_read_b64_tr_b16 v[84:85], v249 offset:16384
    v_mfma_f32_16x16x32_bf16 v[12:15], v[64:67], a[204:207], v[12:15]
    ds_read_b64_tr_b16 v[86:87], v249 offset:18432
    v_mfma_f32_16x16x32_bf16 v[16:19], v[68:71], a[192:195], v[16:19]
    ds_read_b64_tr_b16 v[88:89], v250 offset:16384
    v_mfma_f32_16x16x32_bf16 v[20:23], v[68:71], a[196:199], v[20:23]
    ds_read_b64_tr_b16 v[90:91], v250 offset:18432
    v_mfma_f32_16x16x32_bf16 v[24:27], v[68:71], a[200:203], v[24:27]
    ds_read_b64_tr_b16 v[92:93], v251 offset:16384
    v_mfma_f32_16x16x32_bf16 v[28:31], v[68:71], a[204:207], v[28:31]
    ds_read_b64_tr_b16 v[94:95], v251 offset:18432
    v_mfma_f32_16x16x32_bf16 v[32:35], v[72:75], a[192:195], v[32:35]
    s_add_u32 m0, s95, 0x1c000
    s_add_u32 s94, s36, 0x1000
    buffer_load_dwordx4 v211, s[68:71], s94 offen offset:0 sc1 lds
    v_mfma_f32_16x16x32_bf16 v[36:39], v[72:75], a[196:199], v[36:39]
    buffer_load_dwordx4 v211, s[68:71], s94 offen offset:1024 sc1 lds
    v_mfma_f32_16x16x32_bf16 v[40:43], v[72:75], a[200:203], v[40:43]
    buffer_load_dwordx4 v211, s[68:71], s94 offen offset:2048 sc1 lds
    v_mfma_f32_16x16x32_bf16 v[44:47], v[72:75], a[204:207], v[44:47]
    buffer_load_dwordx4 v211, s[68:71], s94 offen offset:3072 sc1 lds
    v_mfma_f32_16x16x32_bf16 v[48:51], v[76:79], a[192:195], v[48:51]
    v_mfma_f32_16x16x32_bf16 v[52:55], v[76:79], a[196:199], v[52:55]
    v_mfma_f32_16x16x32_bf16 v[56:59], v[76:79], a[200:203], v[56:59]
    v_mfma_f32_16x16x32_bf16 v[60:63], v[76:79], a[204:207], v[60:63]
    s_waitcnt vmcnt(36) lgkmcnt(0)
    v_mfma_f32_16x16x32_bf16 v[0:3], v[80:83], a[208:211], v[0:3]
    ds_read_b64_tr_b16 v[64:65], v248 offset:32768
    v_mfma_f32_16x16x32_bf16 v[4:7], v[80:83], a[212:215], v[4:7]
    ds_read_b64_tr_b16 v[66:67], v248 offset:34816
    v_mfma_f32_16x16x32_bf16 v[8:11], v[80:83], a[216:219], v[8:11]
    ds_read_b64_tr_b16 v[68:69], v249 offset:32768
    v_mfma_f32_16x16x32_bf16 v[12:15], v[80:83], a[220:223], v[12:15]
    ds_read_b64_tr_b16 v[70:71], v249 offset:34816
    v_mfma_f32_16x16x32_bf16 v[16:19], v[84:87], a[208:211], v[16:19]
    ds_read_b64_tr_b16 v[72:73], v250 offset:32768
    v_mfma_f32_16x16x32_bf16 v[20:23], v[84:87], a[212:215], v[20:23]
    ds_read_b64_tr_b16 v[74:75], v250 offset:34816
    v_mfma_f32_16x16x32_bf16 v[24:27], v[84:87], a[216:219], v[24:27]
    ds_read_b64_tr_b16 v[76:77], v251 offset:32768
    v_mfma_f32_16x16x32_bf16 v[28:31], v[84:87], a[220:223], v[28:31]
    ds_read_b64_tr_b16 v[78:79], v251 offset:34816
    v_mfma_f32_16x16x32_bf16 v[32:35], v[88:91], a[208:211], v[32:35]
    s_add_u32 m0, s95, 0x0
    s_add_u32 s94, s36, 0x2000
    buffer_load_dwordx4 v211, s[68:71], s94 offen offset:0 sc1 lds
    v_mfma_f32_16x16x32_bf16 v[36:39], v[88:91], a[212:215], v[36:39]
    buffer_load_dwordx4 v211, s[68:71], s94 offen offset:1024 sc1 lds
    v_mfma_f32_16x16x32_bf16 v[40:43], v[88:91], a[216:219], v[40:43]
    buffer_load_dwordx4 v211, s[68:71], s94 offen offset:2048 sc1 lds
    v_mfma_f32_16x16x32_bf16 v[44:47], v[88:91], a[220:223], v[44:47]
    buffer_load_dwordx4 v211, s[68:71], s94 offen offset:3072 sc1 lds
    v_mfma_f32_16x16x32_bf16 v[48:51], v[92:95], a[208:211], v[48:51]
    v_mfma_f32_16x16x32_bf16 v[52:55], v[92:95], a[212:215], v[52:55]
    v_mfma_f32_16x16x32_bf16 v[56:59], v[92:95], a[216:219], v[56:59]
    v_mfma_f32_16x16x32_bf16 v[60:63], v[92:95], a[220:223], v[60:63]
    s_waitcnt vmcnt(32) lgkmcnt(0)
    v_mfma_f32_16x16x32_bf16 v[0:3], v[64:67], a[224:227], v[0:3]
    ds_read_b64_tr_b16 v[80:81], v248 offset:49152
    v_mfma_f32_16x16x32_bf16 v[4:7], v[64:67], a[228:231], v[4:7]
    ds_read_b64_tr_b16 v[82:83], v248 offset:51200
    v_mfma_f32_16x16x32_bf16 v[8:11], v[64:67], a[232:235], v[8:11]
    ds_read_b64_tr_b16 v[84:85], v249 offset:49152
    v_mfma_f32_16x16x32_bf16 v[12:15], v[64:67], a[236:239], v[12:15]
    ds_read_b64_tr_b16 v[86:87], v249 offset:51200
    v_mfma_f32_16x16x32_bf16 v[16:19], v[68:71], a[224:227], v[16:19]
    ds_read_b64_tr_b16 v[88:89], v250 offset:49152
    v_mfma_f32_16x16x32_bf16 v[20:23], v[68:71], a[228:231], v[20:23]
    ds_read_b64_tr_b16 v[90:91], v250 offset:51200
    v_mfma_f32_16x16x32_bf16 v[24:27], v[68:71], a[232:235], v[24:27]
    ds_read_b64_tr_b16 v[92:93], v251 offset:49152
    v_mfma_f32_16x16x32_bf16 v[28:31], v[68:71], a[236:239], v[28:31]
    ds_read_b64_tr_b16 v[94:95], v251 offset:51200
    v_mfma_f32_16x16x32_bf16 v[32:35], v[72:75], a[224:227], v[32:35]
    s_add_u32 m0, s95, 0x4000
    s_add_u32 s94, s36, 0x3000
    buffer_load_dwordx4 v211, s[68:71], s94 offen offset:0 sc1 lds
    v_mfma_f32_16x16x32_bf16 v[36:39], v[72:75], a[228:231], v[36:39]
    buffer_load_dwordx4 v211, s[68:71], s94 offen offset:1024 sc1 lds
    v_mfma_f32_16x16x32_bf16 v[40:43], v[72:75], a[232:235], v[40:43]
    buffer_load_dwordx4 v211, s[68:71], s94 offen offset:2048 sc1 lds
    v_mfma_f32_16x16x32_bf16 v[44:47], v[72:75], a[236:239], v[44:47]
    buffer_load_dwordx4 v211, s[68:71], s94 offen offset:3072 sc1 lds
    v_mfma_f32_16x16x32_bf16 v[48:51], v[76:79], a[224:227], v[48:51]
    v_mfma_f32_16x16x32_bf16 v[52:55], v[76:79], a[228:231], v[52:55]
    v_mfma_f32_16x16x32_bf16 v[56:59], v[76:79], a[232:235], v[56:59]
    v_mfma_f32_16x16x32_bf16 v[60:63], v[76:79], a[236:239], v[60:63]
    s_waitcnt vmcnt(28) lgkmcnt(0)
    v_mfma_f32_16x16x32_bf16 v[0:3], v[80:83], a[240:243], v[0:3]
    ds_read_b64_tr_b16 v[64:65], v180 offset:0
    v_mfma_f32_16x16x32_bf16 v[4:7], v[80:83], a[244:247], v[4:7]
    ds_read_b64_tr_b16 v[66:67], v180 offset:2048
    v_mfma_f32_16x16x32_bf16 v[8:11], v[80:83], a[248:251], v[8:11]
    ds_read_b64_tr_b16 v[68:69], v181 offset:0
    v_mfma_f32_16x16x32_bf16 v[12:15], v[80:83], a[252:255], v[12:15]
    ds_read_b64_tr_b16 v[70:71], v181 offset:2048
    v_mfma_f32_16x16x32_bf16 v[16:19], v[84:87], a[240:243], v[16:19]
    ds_read_b64_tr_b16 v[72:73], v182 offset:0
    v_mfma_f32_16x16x32_bf16 v[20:23], v[84:87], a[244:247], v[20:23]
    ds_read_b64_tr_b16 v[74:75], v182 offset:2048
    v_mfma_f32_16x16x32_bf16 v[24:27], v[84:87], a[248:251], v[24:27]
    ds_read_b64_tr_b16 v[76:77], v183 offset:0
    v_mfma_f32_16x16x32_bf16 v[28:31], v[84:87], a[252:255], v[28:31]
    ds_read_b64_tr_b16 v[78:79], v183 offset:2048
    v_mfma_f32_16x16x32_bf16 v[32:35], v[88:91], a[240:243], v[32:35]
    s_add_u32 m0, s95, 0x8000
    s_add_u32 s94, s36, 0x4000
    buffer_load_dwordx4 v211, s[68:71], s94 offen offset:0 sc1 lds
    v_mfma_f32_16x16x32_bf16 v[36:39], v[88:91], a[244:247], v[36:39]
    buffer_load_dwordx4 v211, s[68:71], s94 offen offset:1024 sc1 lds
    v_mfma_f32_16x16x32_bf16 v[40:43], v[88:91], a[248:251], v[40:43]
    buffer_load_dwordx4 v211, s[68:71], s94 offen offset:2048 sc1 lds
    v_mfma_f32_16x16x32_bf16 v[44:47], v[88:91], a[252:255], v[44:47]
    buffer_load_dwordx4 v211, s[68:71], s94 offen offset:3072 sc1 lds
    v_mfma_f32_16x16x32_bf16 v[48:51], v[92:95], a[240:243], v[48:51]
    v_mfma_f32_16x16x32_bf16 v[52:55], v[92:95], a[244:247], v[52:55]
    v_mfma_f32_16x16x32_bf16 v[56:59], v[92:95], a[248:251], v[56:59]
    v_mfma_f32_16x16x32_bf16 v[60:63], v[92:95], a[252:255], v[60:63]
    s_waitcnt vmcnt(24) lgkmcnt(0)
    s_cmp_eq_u32 s44, 0
    s_cbranch_scc0 L3_nopoll
    v_and_b32 v253, 0x1f0, v211
    v_lshlrev_b32 v253, 3, v253
    s_lshl_b32 s73, s43, 12
    s_add_u32 s73, s73, 0x10000
    buffer_load_dword v254, v253, s[24:27], s73 offen sc1
L3_nopoll:
    v_mfma_f32_16x16x32_bf16 v[0:3], v[64:67], a[128:131], v[0:3]
    ds_read_b64_tr_b16 v[80:81], v180 offset:16384
    v_mfma_f32_16x16x32_bf16 v[4:7], v[64:67], a[132:135], v[4:7]
    ds_read_b64_tr_b16 v[82:83], v180 offset:18432
    v_mfma_f32_16x16x32_bf16 v[8:11], v[64:67], a[136:139], v[8:11]
    ds_read_b64_tr_b16 v[84:85], v181 offset:16384
    v_mfma_f32_16x16x32_bf16 v[12:15], v[64:67], a[140:143], v[12:15]
L_it10:
    s_cbranch_execz L_itrB
    ds_read_b64_tr_b16 v[86:87], v181 offset:18432
    v_mfma_f32_16x16x32_bf16 v[16:19], v[68:71], a[128:131], v[16:19]
    ds_read_b64_tr_b16 v[88:89], v182 offset:16384
    v_mfma_f32_16x16x32_bf16 v[20:23], v[68:71], a[132:135], v[20:23]
    ds_read_b64_tr_b16 v[90:91], v182 offset:18432
    v_mfma_f32_16x16x32_bf16 v[24:27], v[68:71], a[136:139], v[24:27]
    ds_read_b64_tr_b16 v[92:93], v183 offset:16384
    v_mfma_f32_16x16x32_bf16 v[28:31], v[68:71], a[140:143], v[28:31]
    ds_read_b64_tr_b16 v[94:95], v183 offset:18432
    v_mfma_f32_16x16x32_bf16 v[32:35], v[72:75], a[128:131], v[32:35]
    s_add_u32 m0, s95, 0xc000
    s_add_u32 s94, s36, 0x5000
    buffer_load_dwordx4 v211, s[68:71], s94 offen offset:0 sc1 lds
    v_mfma_f32_16x16x32_bf16 v[36:39], v[72:75], a[132:135], v[36:39]
    buffer_load_dwordx4 v211, s[68:71], s94 offen offset:1024 sc1 lds
    v_mfma_f32_16x16x32_bf16 v[40:43], v[72:75], a[136:139], v[40:43]
    buffer_load_dwordx4 v211, s[68:71], s94 offen offset:2048 sc1 lds
    v_mfma_f32_16x16x32_bf16 v[44:47], v[72:75], a[140:143], v[44:47]
    buffer_load_dwordx4 v211, s[68:71], s94 offen offset:3072 sc1 lds
    v_mfma_f32_16x16x32_bf16 v[48:51], v[76:79], a[128:131], v[48:51]
    v_mfma_f32_16x16x32_bf16 v[52:55], v[76:79], a[132:135], v[52:55]
    v_mfma_f32_16x16x32_bf16 v[56:59], v[76:79], a[136:139], v[56:59]
    v_mfma_f32_16x16x32_bf16 v[60:63], v[76:79], a[140:143], v[60:63]
    s_waitcnt vmcnt(20) lgkmcnt(0)
    v_mfma_f32_16x16x32_bf16 v[0:3], v[80:83], a[144:147], v[0:3]
    ds_read_b64_tr_b16 v[64:65], v180 offset:32768
    v_mfma_f32_16x16x32_bf16 v[4:7], v[80:83], a[148:151], v[4:7]
    ds_read_b64_tr_b16 v[66:67], v180 offset:34816
    v_mfma_f32_16x16x32_bf16 v[8:11], v[80:83], a[152:155], v[8:11]
    ds_read_b64_tr_b16 v[68:69], v181 offset:32768
    v_mfma_f32_16x16x32_bf16 v[12:15], v[80:83], a[156:159], v[12:15]
    ds_read_b64_tr_b16 v[70:71], v181 offset:34816
    v_mfma_f32_16x16x32_bf16 v[16:19], v[84:87], a[144:147], v[16:19]
    ds_read_b64_tr_b16 v[72:73], v182 offset:32768
    v_mfma_f32_16x16x32_bf16 v[20:23], v[84:87], a[148:151], v[20:23]
    ds_read_b64_tr_b16 v[74:75], v182 offset:34816
    v_mfma_f32_16x16x32_bf16 v[24:27], v[84:87], a[152:155], v[24:27]
    ds_read_b64_tr_b16 v[76:77], v183 offset:32768
    ds_write_b128 v204, v[0:3] offset:0
    v_mfma_f32_16x16x32_bf16 v[28:31], v[84:87], a[156:159], v[28:31]
    ds_read_b64_tr_b16 v[78:79], v183 offset:34816
    ds_write_b128 v204, v[4:7] offset:8192
    v_mfma_f32_16x16x32_bf16 v[32:35], v[88:91], a[144:147], v[32:35]
    s_add_u32 m0, s95, 0x10000
    s_add_u32 s94, s36, 0x6000
    buffer_load_dwordx4 v211, s[68:71], s94 offen offset:0 sc1 lds
    ds_write_b128 v204, v[8:11] offset:16384
    v_mfma_f32_16x16x32_bf16 v[36:39], v[88:91], a[148:151], v[36:39]
    buffer_load_dwordx4 v211, s[68:71], s94 offen offset:1024 sc1 lds
    ds_write_b128 v204, v[12:15] offset:24576
    v_mfma_f32_16x16x32_bf16 v[40:43], v[88:91], a[152:155], v[40:43]
    buffer_load_dwordx4 v211, s[68:71], s94 offen offset:2048 sc1 lds
    ds_write_b128 v204, v[16:19] offset:1024
    v_mfma_f32_16x16x32_bf16 v[44:47], v[88:91], a[156:159], v[44:47]
    buffer_load_dwordx4 v211, s[68:71], s94 offen offset:3072 sc1 lds
    ds_write_b128 v204, v[20:23] offset:9216
    v_mfma_f32_16x16x32_bf16 v[48:51], v[92:95], a[144:147], v[48:51]
    s_add_u32 s3, s44, 0
    s_and_b32 s3, s3, 3
    s_lshl_b32 s3, s3, 17
    s_add_u32 s90, s39, s3
    ds_write_b128 v204, v[24:27] offset:17408
    v_mfma_f32_16x16x32_bf16 v[52:55], v[92:95], a[148:151], v[52:55]
    s_add_u32 s3, s44, 1
    s_and_b32 s3, s3, 3
    s_lshl_b32 s3, s3, 17
    s_add_u32 s91, s39, s3
    ds_write_b128 v204, v[28:31] offset:25600
    v_mfma_f32_16x16x32_bf16 v[56:59], v[92:95], a[152:155], v[56:59]
    s_add_u32 s3, s44, 2
    s_and_b32 s3, s3, 3
    s_lshl_b32 s3, s3, 17
    s_add_u32 s92, s39, s3
    v_mfma_f32_16x16x32_bf16 v[60:63], v[92:95], a[156:159], v[60:63]
    s_add_u32 s3, s44, 3
    s_and_b32 s3, s3, 3
    s_lshl_b32 s3, s3, 17
    s_add_u32 s93, s39, s3
    s_waitcnt lgkmcnt(0)
    s_cmp_eq_u32 s44, 0
    s_cbranch_scc0 L3_rdy
    s_waitcnt vmcnt(8)
    v_cmp_eq_u32 vcc, s72, v254
    s_nop 3
    s_cmp_eq_u64 vcc, -1
    s_cbranch_scc1 L3_rdy
    s_mov_b32 s74, 65536
L3_spin:
    buffer_load_dword v254, v253, s[24:27], s73 offen sc1
    s_waitcnt vmcnt(0)
    v_cmp_eq_u32 vcc, s72, v254
    s_nop 3
    s_cmp_eq_u64 vcc, -1
    s_cbranch_scc1 L3_rdy
    s_sub_u32 s74, s74, 1
    s_cmp_lg_u32 s74, 0
    s_cbranch_scc1 L3_spin
L3_rdy:
    s_barrier
    buffer_load_dwordx4 a[160:163], v211, s[24:27], s90 offen offset:0 sc1
    buffer_load_dwordx4 a[164:167], v211, s[24:27], s91 offen offset:0 sc1
    buffer_load_dwordx4 a[168:171], v211, s[24:27], s92 offen offset:0 sc1
    buffer_load_dwordx4 a[172:175], v211, s[24:27], s93 offen offset:0 sc1
    buffer_load_dwordx4 a[176:179], v211, s[24:27], s90 offen offset:1024 sc1
    buffer_load_dwordx4 a[180:183], v211, s[24:27], s91 offen offset:1024 sc1
    buffer_load_dwordx4 a[184:187], v211, s[24:27], s92 offen offset:1024 sc1
    buffer_load_dwordx4 a[188:191], v211, s[24:27], s93 offen offset:1024 sc1
    buffer_load_dwordx4 a[192:195], v211, s[24:27], s90 offen offset:2048 sc1
    buffer_load_dwordx4 a[196:199], v211, s[24:27], s91 offen offset:2048 sc1
    buffer_load_dwordx4 a[200:203], v211, s[24:27], s92 offen offset:2048 sc1
    buffer_load_dwordx4 a[204:207], v211, s[24:27], s93 offen offset:2048 sc1
    buffer_load_dwordx4 a[208:211], v211, s[24:27], s90 offen offset:3072 sc1
    s_add_u32 s90, s90, 4096
    buffer_load_dwordx4 a[212:215], v211, s[24:27], s91 offen offset:3072 sc1
    s_add_u32 s91, s91, 4096
    buffer_load_dwordx4 a[216:219], v211, s[24:27], s92 offen offset:3072 sc1
    s_add_u32 s92, s92, 4096
    buffer_load_dwordx4 a[220:223], v211, s[24:27], s93 offen offset:3072 sc1
    s_add_u32 s93, s93, 4096
    buffer_load_dwordx4 a[224:227], v211, s[24:27], s90 offen offset:0 sc1
    buffer_load_dwordx4 a[228:231], v211, s[24:27], s91 offen offset:0 sc1
    buffer_load_dwordx4 a[232:235], v211, s[24:27], s92 offen offset:0 sc1
    buffer_load_dwordx4 a[236:239], v211, s[24:27], s93 offen offset:0 sc1
    buffer_load_dwordx4 a[240:243], v211, s[24:27], s90 offen offset:1024 sc1
    buffer_load_dwordx4 a[244:247], v211, s[24:27], s91 offen offset:1024 sc1
    buffer_load_dwordx4 a[248:251], v211, s[24:27], s92 offen offset:1024 sc1
    buffer_load_dwordx4 a[252:255], v211, s[24:27], s93 offen offset:1024 sc1
    buffer_load_dwordx4 a[128:131], v211, s[24:27], s90 offen offset:2048 sc1
    buffer_load_dwordx4 a[132:135], v211, s[24:27], s91 offen offset:2048 sc1
    buffer_load_dwordx4 a[136:139], v211, s[24:27], s92 offen offset:2048 sc1
    buffer_load_dwordx4 a[140:143], v211, s[24:27], s93 offen offset:2048 sc1
    ds_read_b128 v[96:99], v205 offset:0
    ds_read_b128 v[100:103], v205 offset:1024
    ds_read_b128 v[104:107], v205 offset:2048
    ds_read_b128 v[108:111], v205 offset:3072
    ds_read_b128 v[112:115], v205 offset:4096
    ds_read_b128 v[116:119], v205 offset:5120
    ds_read_b128 v[120:123], v205 offset:6144
    ds_read_b128 v[124:127], v205 offset:7168
    s_waitcnt vmcnt(24) lgkmcnt(0)
    s_barrier
    v_mfma_f32_16x16x32_bf16 a[0:3], v[64:67], a[160:163], 0
    ds_read_b64_tr_b16 v[80:81], v180 offset:49152
    v_add_f32 v96, v96, v104
    v_mfma_f32_16x16x32_bf16 a[4:7], v[64:67], a[164:167], 0
    ds_read_b64_tr_b16 v[82:83], v180 offset:51200
    v_add_f32 v97, v97, v105
    v_mfma_f32_16x16x32_bf16 a[8:11], v[64:67], a[168:171], 0
    ds_read_b64_tr_b16 v[84:85], v181 offset:49152
    v_add_f32 v98, v98, v106
    v_mfma_f32_16x16x32_bf16 a[12:15], v[64:67], a[172:175], 0
    ds_read_b64_tr_b16 v[86:87], v181 offset:51200
    v_add_f32 v99, v99, v107
    v_mfma_f32_16x16x32_bf16 a[16:19], v[68:71], a[160:163], 0
    ds_read_b64_tr_b16 v[88:89], v182 offset:49152
    v_add_f32 v100, v100, v108
    v_mfma_f32_16x16x32_bf16 a[20:23], v[68:71], a[164:167], 0
    ds_read_b64_tr_b16 v[90:91], v182 offset:51200
    v_add_f32 v101, v101, v109
    v_mfma_f32_16x16x32_bf16 a[24:27], v[68:71], a[168:171], 0
    ds_read_b64_tr_b16 v[92:93], v183 offset:49152
    v_add_f32 v102, v102, v110
    v_mfma_f32_16x16x32_bf16 a[28:31], v[68:71], a[172:175], 0
    ds_read_b64_tr_b16 v[94:95], v183 offset:51200
    v_add_f32 v103, v103, v111
    v_mfma_f32_16x16x32_bf16 a[32:35], v[72:75], a[160:163], 0
    s_add_u32 m0, s95, 0x14000
    s_add_u32 s94, s36, 0x7000
    buffer_load_dwordx4 v211, s[68:71], s94 offen offset:0 sc1 lds
    ds_write_b128 v204, v[32:35] offset:0
    v_mfma_f32_16x16x32_bf16 a[36:39], v[72:75], a[164:167], 0
    buffer_load_dwordx4 v211, s[68:71], s94 offen offset:1024 sc1 lds
    ds_write_b128 v204, v[36:39] offset:8192
    v_mfma_f32_16x16x32_bf16 a[40:43], v[72:75], a[168:171], 0
    buffer_load_dwordx4 v211, s[68:71], s94 offen offset:2048 sc1 lds
    ds_write_b128 v204, v[40:43] offset:16384
    v_mfma_f32_16x16x32_bf16 a[44:47], v[72:75], a[172:175], 0
    buffer_load_dwordx4 v211, s[68:71], s94 offen offset:3072 sc1 lds
    ds_write_b128 v204, v[44:47] offset:24576
    v_mfma_f32_16x16x32_bf16 a[48:51], v[76:79], a[160:163], 0
    buffer_load_dwordx4 a[144:147], v211, s[24:27], s90 offen offset:3072 sc1
    s_add_u32 s90, s90, 4096
    ds_write_b128 v204, v[48:51] offset:1024
    v_mfma_f32_16x16x32_bf16 a[52:55], v[76:79], a[164:167], 0
    buffer_load_dwordx4 a[148:151], v211, s[24:27], s91 offen offset:3072 sc1
    s_add_u32 s91, s91, 4096
    ds_write_b128 v204, v[52:55] offset:9216
    v_mfma_f32_16x16x32_bf16 a[56:59], v[76:79], a[168:171], 0
    buffer_load_dwordx4 a[152:155], v211, s[24:27], s92 offen offset:3072 sc1
    s_add_u32 s92, s92, 4096
    ds_write_b128 v204, v[56:59] offset:17408
    v_mfma_f32_16x16x32_bf16 a[60:63], v[76:79], a[172:175], 0
    buffer_load_dwordx4 a[156:159], v211, s[24:27], s93 offen offset:3072 sc1
    s_add_u32 s93, s93, 4096
    ds_write_b128 v204, v[60:63] offset:25600
    s_waitcnt vmcnt(28) lgkmcnt(0)
    s_barrier
    v_mfma_f32_16x16x32_bf16 a[0:3], v[80:83], a[176:179], a[0:3]
    ds_read_b64_tr_b16 v[64:65], v248 offset:0
    v_add_f32 v112, v112, v120
    v_mfma_f32_16x16x32_bf16 a[4:7], v[80:83], a[180:183], a[4:7]
    ds_read_b64_tr_b16 v[66:67], v248 offset:2048
    v_add_f32 v113, v113, v121
    v_mfma_f32_16x16x32_bf16 a[8:11], v[80:83], a[184:187], a[8:11]
    ds_read_b64_tr_b16 v[68:69], v249 offset:0
    v_add_f32 v114, v114, v122
    v_mfma_f32_16x16x32_bf16 a[12:15], v[80:83], a[188:191], a[12:15]
    ds_read_b64_tr_b16 v[70:71], v249 offset:2048
    v_add_f32 v115, v115, v123
    v_mfma_f32_16x16x32_bf16 a[16:19], v[84:87], a[176:179], a[16:19]
    ds_read_b64_tr_b16 v[72:73], v250 offset:0
    v_add_f32 v116, v116, v124
    v_mfma_f32_16x16x32_bf16 a[20:23], v[84:87], a[180:183], a[20:23]
    ds_read_b64_tr_b16 v[74:75], v250 offset:2048
    v_add_f32 v117, v117, v125
    v_mfma_f32_16x16x32_bf16 a[24:27], v[84:87], a[184:187], a[24:27]
    ds_read_b64_tr_b16 v[76:77], v251 offset:0
    v_add_f32 v118, v118, v126
    v_mfma_f32_16x16x32_bf16 a[28:31], v[84:87], a[188:191], a[28:31]
    ds_read_b64_tr_b16 v[78:79], v251 offset:2048
    v_add_f32 v119, v119, v127
    v_mfma_f32_16x16x32_bf16 a[32:35], v[88:91], a[176:179], a[32:35]
    s_add_u32 m0, s95, 0x18000
    s_add_u32 s94, s36, 0x8000
    buffer_load_dwordx4 v211, s[68:71], s94 offen offset:0 sc1 lds
    ds_read_b128 v[144:147], v205 offset:0
    v_mfma_f32_16x16x32_bf16 a[36:39], v[88:91], a[180:183], a[36:39]
    buffer_load_dwordx4 v211, s[68:71], s94 offen offset:1024 sc1 lds
    ds_read_b128 v[148:151], v205 offset:1024
    v_mfma_f32_16x16x32_bf16 a[40:43], v[88:91], a[184:187], a[40:43]
    buffer_load_dwordx4 v211, s[68:71], s94 offen offset:2048 sc1 lds
    ds_read_b128 v[152:155], v205 offset:2048
    v_mfma_f32_16x16x32_bf16 a[44:47], v[88:91], a[188:191], a[44:47]
    buffer_load_dwordx4 v211, s[68:71], s94 offen offset:3072 sc1 lds
    ds_read_b128 v[156:159], v205 offset:3072
    v_mfma_f32_16x16x32_bf16 a[48:51], v[92:95], a[176:179], a[48:51]
    buffer_load_dwordx4 a[160:163], v211, s[24:27], s90 offen offset:0 sc1
    ds_read_b128 v[160:163], v205 offset:4096
    v_mfma_f32_16x16x32_bf16 a[52:55], v[92:95], a[180:183], a[52:55]
    buffer_load_dwordx4 a[164:167], v211, s[24:27], s91 offen offset:0 sc1
    ds_read_b128 v[164:167], v205 offset:5120
    v_mfma_f32_16x16x32_bf16 a[56:59], v[92:95], a[184:187], a[56:59]
    buffer_load_dwordx4 a[168:171], v211, s[24:27], s92 offen offset:0 sc1
    ds_read_b128 v[168:171], v205 offset:6144
    v_mfma_f32_16x16x32_bf16 a[60:63], v[92:95], a[188:191], a[60:63]
    buffer_load_dwordx4 a[172:175], v211, s[24:27], s93 offen offset:0 sc1
    ds_read_b128 v[172:175], v205 offset:7168
    s_waitcnt vmcnt(32) lgkmcnt(0)
    v_mfma_f32_16x16x32_bf16 a[0:3], v[64:67], a[192:195], a[0:3]
    ds_read_b64_tr_b16 v[80:81], v248 offset:16384
    v_add_f32 v128, v96, v112
    v_mfma_f32_16x16x32_bf16 a[4:7], v[64:67], a[196:199], a[4:7]
    ds_read_b64_tr_b16 v[82:83], v248 offset:18432
    v_add_f32 v129, v97, v113
    v_mfma_f32_16x16x32_bf16 a[8:11], v[64:67], a[200:203], a[8:11]
    ds_read_b64_tr_b16 v[84:85], v249 offset:16384
    v_add_f32 v130, v98, v114
    v_mfma_f32_16x16x32_bf16 a[12:15], v[64:67], a[204:207], a[12:15]
    ds_read_b64_tr_b16 v[86:87], v249 offset:18432
    v_add_f32 v131, v99, v115
    v_mfma_f32_16x16x32_bf16 a[16:19], v[68:71], a[192:195], a[16:19]
    ds_read_b64_tr_b16 v[88:89], v250 offset:16384
    v_add_f32 v132, v100, v116
    v_mfma_f32_16x16x32_bf16 a[20:23], v[68:71], a[196:199], a[20:23]
    ds_read_b64_tr_b16 v[90:91], v250 offset:18432
    v_add_f32 v133, v101, v117
    v_mfma_f32_16x16x32_bf16 a[24:27], v[68:71], a[200:203], a[24:27]
    ds_read_b64_tr_b16 v[92:93], v251 offset:16384
    v_add_f32 v134, v102, v118
    v_mfma_f32_16x16x32_bf16 a[28:31], v[68:71], a[204:207], a[28:31]
    ds_read_b64_tr_b16 v[94:95], v251 offset:18432
    v_add_f32 v135, v103, v119
    v_mfma_f32_16x16x32_bf16 a[32:35], v[72:75], a[192:195], a[32:35]
    s_add_u32 m0, s95, 0x1c000
    s_add_u32 s94, s36, 0x9000
    buffer_load_dwordx4 v211, s[68:71], s94 offen offset:0 sc1 lds
    v_mfma_f32_16x16x32_bf16 a[36:39], v[72:75], a[196:199], a[36:39]
    buffer_load_dwordx4 v211, s[68:71], s94 offen offset:1024 sc1 lds
    v_mfma_f32_16x16x32_bf16 a[40:43], v[72:75], a[200:203], a[40:43]
    buffer_load_dwordx4 v211, s[68:71], s94 offen offset:2048 sc1 lds
    v_mfma_f32_16x16x32_bf16 a[44:47], v[72:75], a[204:207], a[44:47]
    buffer_load_dwordx4 v211, s[68:71], s94 offen offset:3072 sc1 lds
    v_mfma_f32_16x16x32_bf16 a[48:51], v[76:79], a[192:195], a[48:51]
    buffer_load_dwordx4 a[176:179], v211, s[24:27], s90 offen offset:1024 sc1
    v_mfma_f32_16x16x32_bf16 a[52:55], v[76:79], a[196:199], a[52:55]
    buffer_load_dwordx4 a[180:183], v211, s[24:27], s91 offen offset:1024 sc1
    v_mfma_f32_16x16x32_bf16 a[56:59], v[76:79], a[200:203], a[56:59]
    buffer_load_dwordx4 a[184:187], v211, s[24:27], s92 offen offset:1024 sc1
    v_mfma_f32_16x16x32_bf16 a[60:63], v[76:79], a[204:207], a[60:63]
    buffer_load_dwordx4 a[188:191], v211, s[24:27], s93 offen offset:1024 sc1
    s_waitcnt vmcnt(36) lgkmcnt(0)
    v_mfma_f32_16x16x32_bf16 a[0:3], v[80:83], a[208:211], a[0:3]
    ds_read_b64_tr_b16 v[64:65], v248 offset:32768
    v_cvt_pk_bf16_f32 v128, 0, v128
    v_mfma_f32_16x16x32_bf16 a[4:7], v[80:83], a[212:215], a[4:7]
    ds_read_b64_tr_b16 v[66:67], v248 offset:34816
    v_cvt_pk_bf16_f32 v129, 0, v129
    v_mfma_f32_16x16x32_bf16 a[8:11], v[80:83], a[216:219], a[8:11]
    ds_read_b64_tr_b16 v[68:69], v249 offset:32768
    v_cvt_pk_bf16_f32 v130, 0, v130
    v_mfma_f32_16x16x32_bf16 a[12:15], v[80:83], a[220:223], a[12:15]
    ds_read_b64_tr_b16 v[70:71], v249 offset:34816
    v_cvt_pk_bf16_f32 v131, 0, v131
    v_mfma_f32_16x16x32_bf16 a[16:19], v[84:87], a[208:211], a[16:19]
    ds_read_b64_tr_b16 v[72:73], v250 offset:32768
    v_cvt_pk_bf16_f32 v132, 0, v132
    v_mfma_f32_16x16x32_bf16 a[20:23], v[84:87], a[212:215], a[20:23]
    ds_read_b64_tr_b16 v[74:75], v250 offset:34816
    v_cvt_pk_bf16_f32 v133, 0, v133
    v_mfma_f32_16x16x32_bf16 a[24:27], v[84:87], a[216:219], a[24:27]
    ds_read_b64_tr_b16 v[76:77], v251 offset:32768
    v_cvt_pk_bf16_f32 v134, 0, v134
    v_mfma_f32_16x16x32_bf16 a[28:31], v[84:87], a[220:223], a[28:31]
    ds_read_b64_tr_b16 v[78:79], v251 offset:34816
    v_cvt_pk_bf16_f32 v135, 0, v135
    v_mfma_f32_16x16x32_bf16 a[32:35], v[88:91], a[208:211], a[32:35]
    s_add_u32 m0, s95, 0x0
    s_add_u32 s94, s36, 0xa000
    buffer_load_dwordx4 v211, s[68:71], s94 offen offset:0 sc1 lds
    v_mfma_f32_16x16x32_bf16 a[36:39], v[88:91], a[212:215], a[36:39]
    buffer_load_dwordx4 v211, s[68:71], s94 offen offset:1024 sc1 lds
    v_mfma_f32_16x16x32_bf16 a[40:43], v[88:91], a[216:219], a[40:43]
    buffer_load_dwordx4 v211, s[68:71], s94 offen offset:2048 sc1 lds
    v_mfma_f32_16x16x32_bf16 a[44:47], v[88:91], a[220:223], a[44:47]
    buffer_load_dwordx4 v211, s[68:71], s94 offen offset:3072 sc1 lds
    v_mfma_f32_16x16x32_bf16 a[48:51], v[92:95], a[208:211], a[48:51]
    buffer_load_dwordx4 a[192:195], v211, s[24:27], s90 offen offset:2048 sc1
    v_mfma_f32_16x16x32_bf16 a[52:55], v[92:95], a[212:215], a[52:55]
    buffer_load_dwordx4 a[196:199], v211, s[24:27], s91 offen offset:2048 sc1
    v_mfma_f32_16x16x32_bf16 a[56:59], v[92:95], a[216:219], a[56:59]
    buffer_load_dwordx4 a[200:203], v211, s[24:27], s92 offen offset:2048 sc1
    v_mfma_f32_16x16x32_bf16 a[60:63], v[92:95], a[220:223], a[60:63]
    buffer_load_dwordx4 a[204:207], v211, s[24:27], s93 offen offset:2048 sc1
    s_waitcnt vmcnt(40) lgkmcnt(0)
    v_mfma_f32_16x16x32_bf16 a[0:3], v[64:67], a[224:227], a[0:3]
    ds_read_b64_tr_b16 v[80:81], v248 offset:49152
    s_mov_b32 s53, 0xbfb8aa3b
    v_mul_f32 v96, s53, v128
    v_mfma_f32_16x16x32_bf16 a[4:7], v[64:67], a[228:231], a[4:7]
    ds_read_b64_tr_b16 v[82:83], v248 offset:51200
    v_mul_f32 v97, s53, v129
    v_mfma_f32_16x16x32_bf16 a[8:11], v[64:67], a[232:235], a[8:11]
    ds_read_b64_tr_b16 v[84:85], v249 offset:49152
    v_mul_f32 v98, s53, v130
    v_mfma_f32_16x16x32_bf16 a[12:15], v[64:67], a[236:239], a[12:15]
    ds_read_b64_tr_b16 v[86:87], v249 offset:51200
    v_mul_f32 v99, s53, v131
    v_mfma_f32_16x16x32_bf16 a[16:19], v[68:71], a[224:227], a[16:19]
    ds_read_b64_tr_b16 v[88:89], v250 offset:49152
    v_mul_f32 v100, s53, v132
    v_mfma_f32_16x16x32_bf16 a[20:23], v[68:71], a[228:231], a[20:23]
    ds_read_b64_tr_b16 v[90:91], v250 offset:51200
    v_mul_f32 v101, s53, v133
    v_mfma_f32_16x16x32_bf16 a[24:27], v[68:71], a[232:235], a[24:27]
    ds_read_b64_tr_b16 v[92:93], v251 offset:49152
    v_mul_f32 v102, s53, v134
    v_mfma_f32_16x16x32_bf16 a[28:31], v[68:71], a[236:239], a[28:31]
    ds_read_b64_tr_b16 v[94:95], v251 offset:51200
    v_mul_f32 v103, s53, v135
    v_mfma_f32_16x16x32_bf16 a[32:35], v[72:75], a[224:227], a[32:35]
    s_add_u32 m0, s95, 0x4000
    s_add_u32 s94, s36, 0xb000
    buffer_load_dwordx4 v211, s[68:71], s94 offen offset:0 sc1 lds
    v_mfma_f32_16x16x32_bf16 a[36:39], v[72:75], a[228:231], a[36:39]
    buffer_load_dwordx4 v211, s[68:71], s94 offen offset:1024 sc1 lds
    v_mfma_f32_16x16x32_bf16 a[40:43], v[72:75], a[232:235], a[40:43]
    buffer_load_dwordx4 v211, s[68:71], s94 offen offset:2048 sc1 lds
    v_mfma_f32_16x16x32_bf16 a[44:47], v[72:75], a[236:239], a[44:47]
    buffer_load_dwordx4 v211, s[68:71], s94 offen offset:3072 sc1 lds
    v_mfma_f32_16x16x32_bf16 a[48:51], v[76:79], a[224:227], a[48:51]
    buffer_load_dwordx4 a[208:211], v211, s[24:27], s90 offen offset:3072 sc1
    s_add_u32 s90, s90, 4096
    v_mfma_f32_16x16x32_bf16 a[52:55], v[76:79], a[228:231], a[52:55]
    buffer_load_dwordx4 a[212:215], v211, s[24:27], s91 offen offset:3072 sc1
    s_add_u32 s91, s91, 4096
    v_mfma_f32_16x16x32_bf16 a[56:59], v[76:79], a[232:235], a[56:59]
    buffer_load_dwordx4 a[216:219], v211, s[24:27], s92 offen offset:3072 sc1
    s_add_u32 s92, s92, 4096
    v_mfma_f32_16x16x32_bf16 a[60:63], v[76:79], a[236:239], a[60:63]
    buffer_load_dwordx4 a[220:223], v211, s[24:27], s93 offen offset:3072 sc1
    s_add_u32 s93, s93, 4096
    s_waitcnt vmcnt(44) lgkmcnt(0)
    v_mfma_f32_16x16x32_bf16 a[0:3], v[80:83], a[240:243], a[0:3]
    ds_read_b64_tr_b16 v[64:65], v180 offset:0
    v_exp_f32 v96, v96
    v_mfma_f32_16x16x32_bf16 a[4:7], v[80:83], a[244:247], a[4:7]
    ds_read_b64_tr_b16 v[66:67], v180 offset:2048
    v_exp_f32 v97, v97
    v_mfma_f32_16x16x32_bf16 a[8:11], v[80:83], a[248:251], a[8:11]
    ds_read_b64_tr_b16 v[68:69], v181 offset:0
    v_exp_f32 v98, v98
    v_mfma_f32_16x16x32_bf16 a[12:15], v[80:83], a[252:255], a[12:15]
    ds_read_b64_tr_b16 v[70:71], v181 offset:2048
    v_exp_f32 v99, v99
    v_mfma_f32_16x16x32_bf16 a[16:19], v[84:87], a[240:243], a[16:19]
    ds_read_b64_tr_b16 v[72:73], v182 offset:0
    v_exp_f32 v100, v100
    v_mfma_f32_16x16x32_bf16 a[20:23], v[84:87], a[244:247], a[20:23]
    ds_read_b64_tr_b16 v[74:75], v182 offset:2048
    v_exp_f32 v101, v101
    v_mfma_f32_16x16x32_bf16 a[24:27], v[84:87], a[248:251], a[24:27]
    ds_read_b64_tr_b16 v[76:77], v183 offset:0
    v_exp_f32 v102, v102
    v_mfma_f32_16x16x32_bf16 a[28:31], v[84:87], a[252:255], a[28:31]
    ds_read_b64_tr_b16 v[78:79], v183 offset:2048
    v_exp_f32 v103, v103
    v_mfma_f32_16x16x32_bf16 a[32:35], v[88:91], a[240:243], a[32:35]
    s_add_u32 m0, s95, 0x8000
    s_add_u32 s94, s36, 0xc000
    buffer_load_dwordx4 v211, s[68:71], s94 offen offset:0 sc1 lds
    v_mfma_f32_16x16x32_bf16 a[36:39], v[88:91], a[244:247], a[36:39]
    buffer_load_dwordx4 v211, s[68:71], s94 offen offset:1024 sc1 lds
    v_mfma_f32_16x16x32_bf16 a[40:43], v[88:91], a[248:251], a[40:43]
    buffer_load_dwordx4 v211, s[68:71], s94 offen offset:2048 sc1 lds
    v_mfma_f32_16x16x32_bf16 a[44:47], v[88:91], a[252:255], a[44:47]
    buffer_load_dwordx4 v211, s[68:71], s94 offen offset:3072 sc1 lds
    v_mfma_f32_16x16x32_bf16 a[48:51], v[92:95], a[240:243], a[48:51]
    buffer_load_dwordx4 a[224:227], v211, s[24:27], s90 offen offset:0 sc1
    v_mfma_f32_16x16x32_bf16 a[52:55], v[92:95], a[244:247], a[52:55]
    buffer_load_dwordx4 a[228:231], v211, s[24:27], s91 offen offset:0 sc1
    v_mfma_f32_16x16x32_bf16 a[56:59], v[92:95], a[248:251], a[56:59]
    buffer_load_dwordx4 a[232:235], v211, s[24:27], s92 offen offset:0 sc1
    v_mfma_f32_16x16x32_bf16 a[60:63], v[92:95], a[252:255], a[60:63]
    buffer_load_dwordx4 a[236:239], v211, s[24:27], s93 offen offset:0 sc1
    s_waitcnt vmcnt(44) lgkmcnt(0)
    v_mfma_f32_16x16x32_bf16 a[0:3], v[64:67], a[128:131], a[0:3]
    ds_read_b64_tr_b16 v[80:81], v180 offset:16384
    v_add_f32 v96, 1.0, v96
    v_mfma_f32_16x16x32_bf16 a[4:7], v[64:67], a[132:135], a[4:7]
    ds_read_b64_tr_b16 v[82:83], v180 offset:18432
    v_add_f32 v97, 1.0, v97
    v_mfma_f32_16x16x32_bf16 a[8:11], v[64:67], a[136:139], a[8:11]
    ds_read_b64_tr_b16 v[84:85], v181 offset:16384
    v_add_f32 v98, 1.0, v98
    v_mfma_f32_16x16x32_bf16 a[12:15], v[64:67], a[140:143], a[12:15]
    ds_read_b64_tr_b16 v[86:87], v181 offset:18432
    v_add_f32 v99, 1.0, v99
    v_mfma_f32_16x16x32_bf16 a[16:19], v[68:71], a[128:131], a[16:19]
    ds_read_b64_tr_b16 v[88:89], v182 offset:16384
    v_add_f32 v100, 1.0, v100
    v_mfma_f32_16x16x32_bf16 a[20:23], v[68:71], a[132:135], a[20:23]
    ds_read_b64_tr_b16 v[90:91], v182 offset:18432
    v_add_f32 v101, 1.0, v101
    v_mfma_f32_16x16x32_bf16 a[24:27], v[68:71], a[136:139], a[24:27]
    ds_read_b64_tr_b16 v[92:93], v183 offset:16384
    v_add_f32 v102, 1.0, v102
    v_mfma_f32_16x16x32_bf16 a[28:31], v[68:71], a[140:143], a[28:31]
    ds_read_b64_tr_b16 v[94:95], v183 offset:18432
    v_add_f32 v103, 1.0, v103
    v_mfma_f32_16x16x32_bf16 a[32:35], v[72:75], a[128:131], a[32:35]
    s_add_u32 m0, s95, 0xc000
    s_add_u32 s94, s36, 0xd000
    buffer_load_dwordx4 v211, s[68:71], s94 offen offset:0 sc1 lds
    v_mfma_f32_16x16x32_bf16 a[36:39], v[72:75], a[132:135], a[36:39]
    buffer_load_dwordx4 v211, s[68:71], s94 offen offset:1024 sc1 lds
    v_mfma_f32_16x16x32_bf16 a[40:43], v[72:75], a[136:139], a[40:43]
    buffer_load_dwordx4 v211, s[68:71], s94 offen offset:2048 sc1 lds
    v_mfma_f32_16x16x32_bf16 a[44:47], v[72:75], a[140:143], a[44:47]
    buffer_load_dwordx4 v211, s[68:71], s94 offen offset:3072 sc1 lds
    v_mfma_f32_16x16x32_bf16 a[48:51], v[76:79], a[128:131], a[48:51]
    buffer_load_dwordx4 a[240:243], v211, s[24:27], s90 offen offset:1024 sc1
    v_mfma_f32_16x16x32_bf16 a[52:55], v[76:79], a[132:135], a[52:55]
    buffer_load_dwordx4 a[244:247], v211, s[24:27], s91 offen offset:1024 sc1
    v_mfma_f32_16x16x32_bf16 a[56:59], v[76:79], a[136:139], a[56:59]
    buffer_load_dwordx4 a[248:251], v211, s[24:27], s92 offen offset:1024 sc1
    v_mfma_f32_16x16x32_bf16 a[60:63], v[76:79], a[140:143], a[60:63]
    buffer_load_dwordx4 a[252:255], v211, s[24:27], s93 offen offset:1024 sc1
    s_waitcnt vmcnt(44) lgkmcnt(0)
    v_mfma_f32_16x16x32_bf16 a[0:3], v[80:83], a[144:147], a[0:3]
    ds_read_b64_tr_b16 v[64:65], v180 offset:32768
    v_rcp_f32 v96, v96
    v_mfma_f32_16x16x32_bf16 a[4:7], v[80:83], a[148:151], a[4:7]
    ds_read_b64_tr_b16 v[66:67], v180 offset:34816
    v_rcp_f32 v97, v97
    v_mfma_f32_16x16x32_bf16 a[8:11], v[80:83], a[152:155], a[8:11]
    ds_read_b64_tr_b16 v[68:69], v181 offset:32768
    v_rcp_f32 v98, v98
    v_mfma_f32_16x16x32_bf16 a[12:15], v[80:83], a[156:159], a[12:15]
    ds_read_b64_tr_b16 v[70:71], v181 offset:34816
    v_rcp_f32 v99, v99
    v_mfma_f32_16x16x32_bf16 a[16:19], v[84:87], a[144:147], a[16:19]
    ds_read_b64_tr_b16 v[72:73], v182 offset:32768
    v_rcp_f32 v100, v100
    v_mfma_f32_16x16x32_bf16 a[20:23], v[84:87], a[148:151], a[20:23]
    ds_read_b64_tr_b16 v[74:75], v182 offset:34816
    v_rcp_f32 v101, v101
    v_mfma_f32_16x16x32_bf16 a[24:27], v[84:87], a[152:155], a[24:27]
    ds_read_b64_tr_b16 v[76:77], v183 offset:32768
    v_rcp_f32 v102, v102
    v_mfma_f32_16x16x32_bf16 a[28:31], v[84:87], a[156:159], a[28:31]
    ds_read_b64_tr_b16 v[78:79], v183 offset:34816
    v_rcp_f32 v103, v103
    v_mfma_f32_16x16x32_bf16 a[32:35], v[88:91], a[144:147], a[32:35]
    s_add_u32 m0, s95, 0x10000
    s_add_u32 s94, s36, 0xe000
    buffer_load_dwordx4 v211, s[68:71], s94 offen offset:0 sc1 lds
    v_mfma_f32_16x16x32_bf16 a[36:39], v[88:91], a[148:151], a[36:39]
    buffer_load_dwordx4 v211, s[68:71], s94 offen offset:1024 sc1 lds
    v_mfma_f32_16x16x32_bf16 a[40:43], v[88:91], a[152:155], a[40:43]
    buffer_load_dwordx4 v211, s[68:71], s94 offen offset:2048 sc1 lds
    v_mfma_f32_16x16x32_bf16 a[44:47], v[88:91], a[156:159], a[44:47]
    buffer_load_dwordx4 v211, s[68:71], s94 offen offset:3072 sc1 lds
    v_mfma_f32_16x16x32_bf16 a[48:51], v[92:95], a[144:147], a[48:51]
    buffer_load_dwordx4 a[128:131], v211, s[24:27], s90 offen offset:2048 sc1
    v_mfma_f32_16x16x32_bf16 a[52:55], v[92:95], a[148:151], a[52:55]
    buffer_load_dwordx4 a[132:135], v211, s[24:27], s91 offen offset:2048 sc1
    v_mfma_f32_16x16x32_bf16 a[56:59], v[92:95], a[152:155], a[56:59]
    buffer_load_dwordx4 a[136:139], v211, s[24:27], s92 offen offset:2048 sc1
    v_mfma_f32_16x16x32_bf16 a[60:63], v[92:95], a[156:159], a[60:63]
    buffer_load_dwordx4 a[140:143], v211, s[24:27], s93 offen offset:2048 sc1
    s_waitcnt vmcnt(44) lgkmcnt(0)
    v_mfma_f32_16x16x32_bf16 a[0:3], v[64:67], a[160:163], a[0:3]
    ds_read_b64_tr_b16 v[80:81], v180 offset:49152
    v_mul_f32 v128, v128, v96
    v_mfma_f32_16x16x32_bf16 a[4:7], v[64:67], a[164:167], a[4:7]
    ds_read_b64_tr_b16 v[82:83], v180 offset:51200
    v_mul_f32 v129, v129, v97
    v_mfma_f32_16x16x32_bf16 a[8:11], v[64:67], a[168:171], a[8:11]
    ds_read_b64_tr_b16 v[84:85], v181 offset:49152
    v_mul_f32 v130, v130, v98
    v_mfma_f32_16x16x32_bf16 a[12:15], v[64:67], a[172:175], a[12:15]
    ds_read_b64_tr_b16 v[86:87], v181 offset:51200
    v_mul_f32 v131, v131, v99
    v_mfma_f32_16x16x32_bf16 a[16:19], v[68:71], a[160:163], a[16:19]
    ds_read_b64_tr_b16 v[88:89], v182 offset:49152
    v_mul_f32 v132, v132, v100
    v_mfma_f32_16x16x32_bf16 a[20:23], v[68:71], a[164:167], a[20:23]
    ds_read_b64_tr_b16 v[90:91], v182 offset:51200
    v_mul_f32 v133, v133, v101
    v_mfma_f32_16x16x32_bf16 a[24:27], v[68:71], a[168:171], a[24:27]
    ds_read_b64_tr_b16 v[92:93], v183 offset:49152
    v_mul_f32 v134, v134, v102
    v_mfma_f32_16x16x32_bf16 a[28:31], v[68:71], a[172:175], a[28:31]
    ds_read_b64_tr_b16 v[94:95], v183 offset:51200
    v_mul_f32 v135, v135, v103
    v_mfma_f32_16x16x32_bf16 a[32:35], v[72:75], a[160:163], a[32:35]
    s_add_u32 m0, s95, 0x14000
    s_add_u32 s94, s36, 0xf000
    buffer_load_dwordx4 v211, s[68:71], s94 offen offset:0 sc1 lds
    v_mfma_f32_16x16x32_bf16 a[36:39], v[72:75], a[164:167], a[36:39]
    buffer_load_dwordx4 v211, s[68:71], s94 offen offset:1024 sc1 lds
    v_mfma_f32_16x16x32_bf16 a[40:43], v[72:75], a[168:171], a[40:43]
    buffer_load_dwordx4 v211, s[68:71], s94 offen offset:2048 sc1 lds
    v_mfma_f32_16x16x32_bf16 a[44:47], v[72:75], a[172:175], a[44:47]
    buffer_load_dwordx4 v211, s[68:71], s94 offen offset:3072 sc1 lds
    v_mfma_f32_16x16x32_bf16 a[48:51], v[76:79], a[160:163], a[48:51]
    buffer_load_dwordx4 a[144:147], v211, s[24:27], s90 offen offset:3072 sc1
    s_add_u32 s90, s90, 4096
    v_mfma_f32_16x16x32_bf16 a[52:55], v[76:79], a[164:167], a[52:55]
    buffer_load_dwordx4 a[148:151], v211, s[24:27], s91 offen offset:3072 sc1
    s_add_u32 s91, s91, 4096
    v_mfma_f32_16x16x32_bf16 a[56:59], v[76:79], a[168:171], a[56:59]
    buffer_load_dwordx4 a[152:155], v211, s[24:27], s92 offen offset:3072 sc1
    s_add_u32 s92, s92, 4096
    v_mfma_f32_16x16x32_bf16 a[60:63], v[76:79], a[172:175], a[60:63]
    buffer_load_dwordx4 a[156:159], v211, s[24:27], s93 offen offset:3072 sc1
    s_add_u32 s93, s93, 4096
    s_waitcnt vmcnt(44) lgkmcnt(0)
    v_mfma_f32_16x16x32_bf16 a[0:3], v[80:83], a[176:179], a[0:3]
    ds_read_b64_tr_b16 v[64:65], v248 offset:0
    v_cvt_pk_bf16_f32 v128, 0, v128
    v_mfma_f32_16x16x32_bf16 a[4:7], v[80:83], a[180:183], a[4:7]
    ds_read_b64_tr_b16 v[66:67], v248 offset:2048
    v_cvt_pk_bf16_f32 v129, 0, v129
    v_mfma_f32_16x16x32_bf16 a[8:11], v[80:83], a[184:187], a[8:11]
    ds_read_b64_tr_b16 v[68:69], v249 offset:0
    v_cvt_pk_bf16_f32 v130, 0, v130
    v_mfma_f32_16x16x32_bf16 a[12:15], v[80:83], a[188:191], a[12:15]
    ds_read_b64_tr_b16 v[70:71], v249 offset:2048
L_it11:
    s_cbranch_execz L_itrB
    v_cvt_pk_bf16_f32 v131, 0, v131
    v_mfma_f32_16x16x32_bf16 a[16:19], v[84:87], a[176:179], a[16:19]
    ds_read_b64_tr_b16 v[72:73], v250 offset:0
    v_cvt_pk_bf16_f32 v132, 0, v132
    v_mfma_f32_16x16x32_bf16 a[20:23], v[84:87], a[180:183], a[20:23]
    ds_read_b64_tr_b16 v[74:75], v250 offset:2048
    v_cvt_pk_bf16_f32 v133, 0, v133
    v_mfma_f32_16x16x32_bf16 a[24:27], v[84:87], a[184:187], a[24:27]
    ds_read_b64_tr_b16 v[76:77], v251 offset:0
    v_cvt_pk_bf16_f32 v134, 0, v134
    v_mfma_f32_16x16x32_bf16 a[28:31], v[84:87], a[188:191], a[28:31]
    ds_read_b64_tr_b16 v[78:79], v251 offset:2048
    v_cvt_pk_bf16_f32 v135, 0, v135
    v_mfma_f32_16x16x32_bf16 a[32:35], v[88:91], a[176:179], a[32:35]
    s_add_u32 m0, s95, 0x18000
    s_add_u32 s94, s36, 0x10000
    buffer_load_dwordx4 v211, s[68:71], s94 offen offset:0 sc1 lds
    v_mfma_f32_16x16x32_bf16 a[36:39], v[88:91], a[180:183], a[36:39]
    buffer_load_dwordx4 v211, s[68:71], s94 offen offset:1024 sc1 lds
    v_mfma_f32_16x16x32_bf16 a[40:43], v[88:91], a[184:187], a[40:43]
    buffer_load_dwordx4 v211, s[68:71], s94 offen offset:2048 sc1 lds
    v_mfma_f32_16x16x32_bf16 a[44:47], v[88:91], a[188:191], a[44:47]
    buffer_load_dwordx4 v211, s[68:71], s94 offen offset:3072 sc1 lds
    v_mfma_f32_16x16x32_bf16 a[48:51], v[92:95], a[176:179], a[48:51]
    buffer_load_dwordx4 a[160:163], v211, s[24:27], s90 offen offset:0 sc1
    v_mfma_f32_16x16x32_bf16 a[52:55], v[92:95], a[180:183], a[52:55]
    buffer_load_dwordx4 a[164:167], v211, s[24:27], s91 offen offset:0 sc1
    v_mfma_f32_16x16x32_bf16 a[56:59], v[92:95], a[184:187], a[56:59]
    buffer_load_dwordx4 a[168:171], v211, s[24:27], s92 offen offset:0 sc1
    v_mfma_f32_16x16x32_bf16 a[60:63], v[92:95], a[188:191], a[60:63]
    buffer_load_dwordx4 a[172:175], v211, s[24:27], s93 offen offset:0 sc1
    s_waitcnt vmcnt(44) lgkmcnt(0)
    v_mfma_f32_16x16x32_bf16 a[0:3], v[64:67], a[192:195], a[0:3]
    ds_read_b64_tr_b16 v[80:81], v248 offset:16384
    v_add_f32 v144, v144, v152
    v_mfma_f32_16x16x32_bf16 a[4:7], v[64:67], a[196:199], a[4:7]
    ds_read_b64_tr_b16 v[82:83], v248 offset:18432
    v_add_f32 v145, v145, v153
    v_mfma_f32_16x16x32_bf16 a[8:11], v[64:67], a[200:203], a[8:11]
    ds_read_b64_tr_b16 v[84:85], v249 offset:16384
    v_add_f32 v146, v146, v154
    v_mfma_f32_16x16x32_bf16 a[12:15], v[64:67], a[204:207], a[12:15]
    ds_read_b64_tr_b16 v[86:87], v249 offset:18432
    v_add_f32 v147, v147, v155
    v_mfma_f32_16x16x32_bf16 a[16:19], v[68:71], a[192:195], a[16:19]
    ds_read_b64_tr_b16 v[88:89], v250 offset:16384
    v_add_f32 v148, v148, v156
    v_mfma_f32_16x16x32_bf16 a[20:23], v[68:71], a[196:199], a[20:23]
    ds_read_b64_tr_b16 v[90:91], v250 offset:18432
    v_add_f32 v149, v149, v157
    v_mfma_f32_16x16x32_bf16 a[24:27], v[68:71], a[200:203], a[24:27]
    ds_read_b64_tr_b16 v[92:93], v251 offset:16384
    v_add_f32 v150, v150, v158
    v_mfma_f32_16x16x32_bf16 a[28:31], v[68:71], a[204:207], a[28:31]
    ds_read_b64_tr_b16 v[94:95], v251 offset:18432
    v_add_f32 v151, v151, v159
    v_mfma_f32_16x16x32_bf16 a[32:35], v[72:75], a[192:195], a[32:35]
    s_add_u32 m0, s95, 0x1c000
    s_add_u32 s94, s36, 0x11000
    buffer_load_dwordx4 v211, s[68:71], s94 offen offset:0 sc1 lds
    v_mfma_f32_16x16x32_bf16 a[36:39], v[72:75], a[196:199], a[36:39]
    buffer_load_dwordx4 v211, s[68:71], s94 offen offset:1024 sc1 lds
    v_mfma_f32_16x16x32_bf16 a[40:43], v[72:75], a[200:203], a[40:43]
    buffer_load_dwordx4 v211, s[68:71], s94 offen offset:2048 sc1 lds
    v_mfma_f32_16x16x32_bf16 a[44:47], v[72:75], a[204:207], a[44:47]
    buffer_load_dwordx4 v211, s[68:71], s94 offen offset:3072 sc1 lds
    v_mfma_f32_16x16x32_bf16 a[48:51], v[76:79], a[192:195], a[48:51]
    buffer_load_dwordx4 a[176:179], v211, s[24:27], s90 offen offset:1024 sc1
    v_mfma_f32_16x16x32_bf16 a[52:55], v[76:79], a[196:199], a[52:55]
    buffer_load_dwordx4 a[180:183], v211, s[24:27], s91 offen offset:1024 sc1
    v_mfma_f32_16x16x32_bf16 a[56:59], v[76:79], a[200:203], a[56:59]
    buffer_load_dwordx4 a[184:187], v211, s[24:27], s92 offen offset:1024 sc1
    v_mfma_f32_16x16x32_bf16 a[60:63], v[76:79], a[204:207], a[60:63]
    buffer_load_dwordx4 a[188:191], v211, s[24:27], s93 offen offset:1024 sc1
    s_waitcnt vmcnt(44) lgkmcnt(0)
    v_mfma_f32_16x16x32_bf16 a[0:3], v[80:83], a[208:211], a[0:3]
    ds_read_b64_tr_b16 v[64:65], v248 offset:32768
    v_add_f32 v160, v160, v168
    v_mfma_f32_16x16x32_bf16 a[4:7], v[80:83], a[212:215], a[4:7]
    ds_read_b64_tr_b16 v[66:67], v248 offset:34816
    v_add_f32 v161, v161, v169
    v_mfma_f32_16x16x32_bf16 a[8:11], v[80:83], a[216:219], a[8:11]
    ds_read_b64_tr_b16 v[68:69], v249 offset:32768
    v_add_f32 v162, v162, v170
    v_mfma_f32_16x16x32_bf16 a[12:15], v[80:83], a[220:223], a[12:15]
    ds_read_b64_tr_b16 v[70:71], v249 offset:34816
    v_add_f32 v163, v163, v171
    v_mfma_f32_16x16x32_bf16 a[16:19], v[84:87], a[208:211], a[16:19]
    ds_read_b64_tr_b16 v[72:73], v250 offset:32768
    v_add_f32 v164, v164, v172
    v_mfma_f32_16x16x32_bf16 a[20:23], v[84:87], a[212:215], a[20:23]
    ds_read_b64_tr_b16 v[74:75], v250 offset:34816
    v_add_f32 v165, v165, v173
    v_mfma_f32_16x16x32_bf16 a[24:27], v[84:87], a[216:219], a[24:27]
    ds_read_b64_tr_b16 v[76:77], v251 offset:32768
    v_add_f32 v166, v166, v174
    v_mfma_f32_16x16x32_bf16 a[28:31], v[84:87], a[220:223], a[28:31]
    ds_read_b64_tr_b16 v[78:79], v251 offset:34816
    v_add_f32 v167, v167, v175
    v_mfma_f32_16x16x32_bf16 a[32:35], v[88:91], a[208:211], a[32:35]
    s_add_u32 m0, s95, 0x0
    s_add_u32 s94, s36, 0x12000
    buffer_load_dwordx4 v211, s[68:71], s94 offen offset:0 sc1 lds
    v_mfma_f32_16x16x32_bf16 a[36:39], v[88:91], a[212:215], a[36:39]
    buffer_load_dwordx4 v211, s[68:71], s94 offen offset:1024 sc1 lds
    v_mfma_f32_16x16x32_bf16 a[40:43], v[88:91], a[216:219], a[40:43]
    buffer_load_dwordx4 v211, s[68:71], s94 offen offset:2048 sc1 lds
    v_mfma_f32_16x16x32_bf16 a[44:47], v[88:91], a[220:223], a[44:47]
    buffer_load_dwordx4 v211, s[68:71], s94 offen offset:3072 sc1 lds
    v_mfma_f32_16x16x32_bf16 a[48:51], v[92:95], a[208:211], a[48:51]
    buffer_load_dwordx4 a[192:195], v211, s[24:27], s90 offen offset:2048 sc1
    v_mfma_f32_16x16x32_bf16 a[52:55], v[92:95], a[212:215], a[52:55]
    buffer_load_dwordx4 a[196:199], v211, s[24:27], s91 offen offset:2048 sc1
    v_mfma_f32_16x16x32_bf16 a[56:59], v[92:95], a[216:219], a[56:59]
    buffer_load_dwordx4 a[200:203], v211, s[24:27], s92 offen offset:2048 sc1
    v_mfma_f32_16x16x32_bf16 a[60:63], v[92:95], a[220:223], a[60:63]
    buffer_load_dwordx4 a[204:207], v211, s[24:27], s93 offen offset:2048 sc1
    s_waitcnt vmcnt(44) lgkmcnt(0)
    v_mfma_f32_16x16x32_bf16 a[0:3], v[64:67], a[224:227], a[0:3]
    ds_read_b64_tr_b16 v[80:81], v248 offset:49152
    v_add_f32 v136, v144, v160
    v_mfma_f32_16x16x32_bf16 a[4:7], v[64:67], a[228:231], a[4:7]
    ds_read_b64_tr_b16 v[82:83], v248 offset:51200
    v_add_f32 v137, v145, v161
    v_mfma_f32_16x16x32_bf16 a[8:11], v[64:67], a[232:235], a[8:11]
    ds_read_b64_tr_b16 v[84:85], v249 offset:49152
    v_add_f32 v138, v146, v162
    v_mfma_f32_16x16x32_bf16 a[12:15], v[64:67], a[236:239], a[12:15]
    ds_read_b64_tr_b16 v[86:87], v249 offset:51200
    v_add_f32 v139, v147, v163
    v_mfma_f32_16x16x32_bf16 a[16:19], v[68:71], a[224:227], a[16:19]
    ds_read_b64_tr_b16 v[88:89], v250 offset:49152
    v_add_f32 v140, v148, v164
    v_mfma_f32_16x16x32_bf16 a[20:23], v[68:71], a[228:231], a[20:23]
    ds_read_b64_tr_b16 v[90:91], v250 offset:51200
    v_add_f32 v141, v149, v165
    v_mfma_f32_16x16x32_bf16 a[24:27], v[68:71], a[232:235], a[24:27]
    ds_read_b64_tr_b16 v[92:93], v251 offset:49152
    v_add_f32 v142, v150, v166
    v_mfma_f32_16x16x32_bf16 a[28:31], v[68:71], a[236:239], a[28:31]
    ds_read_b64_tr_b16 v[94:95], v251 offset:51200
    v_add_f32 v143, v151, v167
    v_mfma_f32_16x16x32_bf16 a[32:35], v[72:75], a[224:227], a[32:35]
    s_add_u32 m0, s95, 0x4000
    s_add_u32 s94, s36, 0x13000
    buffer_load_dwordx4 v211, s[68:71], s94 offen offset:0 sc1 lds
    v_mfma_f32_16x16x32_bf16 a[36:39], v[72:75], a[228:231], a[36:39]
    buffer_load_dwordx4 v211, s[68:71], s94 offen offset:1024 sc1 lds
    v_mfma_f32_16x16x32_bf16 a[40:43], v[72:75], a[232:235], a[40:43]
    buffer_load_dwordx4 v211, s[68:71], s94 offen offset:2048 sc1 lds
    v_mfma_f32_16x16x32_bf16 a[44:47], v[72:75], a[236:239], a[44:47]
    buffer_load_dwordx4 v211, s[68:71], s94 offen offset:3072 sc1 lds
    v_mfma_f32_16x16x32_bf16 a[48:51], v[76:79], a[224:227], a[48:51]
    buffer_load_dwordx4 a[208:211], v211, s[24:27], s90 offen offset:3072 sc1
    s_add_u32 s90, s90, 4096
    v_mfma_f32_16x16x32_bf16 a[52:55], v[76:79], a[228:231], a[52:55]
    buffer_load_dwordx4 a[212:215], v211, s[24:27], s91 offen offset:3072 sc1
    s_add_u32 s91, s91, 4096
    v_mfma_f32_16x16x32_bf16 a[56:59], v[76:79], a[232:235], a[56:59]
    buffer_load_dwordx4 a[216:219], v211, s[24:27], s92 offen offset:3072 sc1
    s_add_u32 s92, s92, 4096
    v_mfma_f32_16x16x32_bf16 a[60:63], v[76:79], a[236:239], a[60:63]
    buffer_load_dwordx4 a[220:223], v211, s[24:27], s93 offen offset:3072 sc1
    s_add_u32 s93, s93, 4096
    s_waitcnt vmcnt(44) lgkmcnt(0)
    v_mfma_f32_16x16x32_bf16 a[0:3], v[80:83], a[240:243], a[0:3]
    ds_read_b64_tr_b16 v[64:65], v180 offset:0
    v_cvt_pk_bf16_f32 v136, 0, v136
    v_mfma_f32_16x16x32_bf16 a[4:7], v[80:83], a[244:247], a[4:7]
    ds_read_b64_tr_b16 v[66:67], v180 offset:2048
    v_cvt_pk_bf16_f32 v137, 0, v137
    v_mfma_f32_16x16x32_bf16 a[8:11], v[80:83], a[248:251], a[8:11]
    ds_read_b64_tr_b16 v[68:69], v181 offset:0
    v_cvt_pk_bf16_f32 v138, 0, v138
    v_mfma_f32_16x16x32_bf16 a[12:15], v[80:83], a[252:255], a[12:15]
    ds_read_b64_tr_b16 v[70:71], v181 offset:2048
    v_cvt_pk_bf16_f32 v139, 0, v139
    v_mfma_f32_16x16x32_bf16 a[16:19], v[84:87], a[240:243], a[16:19]
    ds_read_b64_tr_b16 v[72:73], v182 offset:0
    v_cvt_pk_bf16_f32 v140, 0, v140
    v_mfma_f32_16x16x32_bf16 a[20:23], v[84:87], a[244:247], a[20:23]
    ds_read_b64_tr_b16 v[74:75], v182 offset:2048
    v_cvt_pk_bf16_f32 v141, 0, v141
    v_mfma_f32_16x16x32_bf16 a[24:27], v[84:87], a[248:251], a[24:27]
    ds_read_b64_tr_b16 v[76:77], v183 offset:0
    v_cvt_pk_bf16_f32 v142, 0, v142
    v_mfma_f32_16x16x32_bf16 a[28:31], v[84:87], a[252:255], a[28:31]
    ds_read_b64_tr_b16 v[78:79], v183 offset:2048
    v_cvt_pk_bf16_f32 v143, 0, v143
    v_mfma_f32_16x16x32_bf16 a[32:35], v[88:91], a[240:243], a[32:35]
    s_add_u32 m0, s95, 0x8000
    s_add_u32 s94, s36, 0x14000
    buffer_load_dwordx4 v211, s[68:71], s94 offen offset:0 sc1 lds
    v_mfma_f32_16x16x32_bf16 a[36:39], v[88:91], a[244:247], a[36:39]
    buffer_load_dwordx4 v211, s[68:71], s94 offen offset:1024 sc1 lds
    v_mfma_f32_16x16x32_bf16 a[40:43], v[88:91], a[248:251], a[40:43]
    buffer_load_dwordx4 v211, s[68:71], s94 offen offset:2048 sc1 lds
    v_mfma_f32_16x16x32_bf16 a[44:47], v[88:91], a[252:255], a[44:47]
    buffer_load_dwordx4 v211, s[68:71], s94 offen offset:3072 sc1 lds
    v_mfma_f32_16x16x32_bf16 a[48:51], v[92:95], a[240:243], a[48:51]
    buffer_load_dwordx4 a[224:227], v211, s[24:27], s90 offen offset:0 sc1
    v_mfma_f32_16x16x32_bf16 a[52:55], v[92:95], a[244:247], a[52:55]
    buffer_load_dwordx4 a[228:231], v211, s[24:27], s91 offen offset:0 sc1
    v_mfma_f32_16x16x32_bf16 a[56:59], v[92:95], a[248:251], a[56:59]
    buffer_load_dwordx4 a[232:235], v211, s[24:27], s92 offen offset:0 sc1
    v_mfma_f32_16x16x32_bf16 a[60:63], v[92:95], a[252:255], a[60:63]
    buffer_load_dwordx4 a[236:239], v211, s[24:27], s93 offen offset:0 sc1
    s_waitcnt vmcnt(44) lgkmcnt(0)
    v_mfma_f32_16x16x32_bf16 a[0:3], v[64:67], a[128:131], a[0:3]
    ds_read_b64_tr_b16 v[80:81], v180 offset:16384
    s_mov_b32 s53, 0xbfb8aa3b
    v_mul_f32 v96, s53, v136
    v_mfma_f32_16x16x32_bf16 a[4:7], v[64:67], a[132:135], a[4:7]
    ds_read_b64_tr_b16 v[82:83], v180 offset:18432
    v_mul_f32 v97, s53, v137
    v_mfma_f32_16x16x32_bf16 a[8:11], v[64:67], a[136:139], a[8:11]
    ds_read_b64_tr_b16 v[84:85], v181 offset:16384
    v_mul_f32 v98, s53, v138
    v_mfma_f32_16x16x32_bf16 a[12:15], v[64:67], a[140:143], a[12:15]
    ds_read_b64_tr_b16 v[86:87], v181 offset:18432
    v_mul_f32 v99, s53, v139
    v_mfma_f32_16x16x32_bf16 a[16:19], v[68:71], a[128:131], a[16:19]
    ds_read_b64_tr_b16 v[88:89], v182 offset:16384
    v_mul_f32 v100, s53, v140
    v_mfma_f32_16x16x32_bf16 a[20:23], v[68:71], a[132:135], a[20:23]
    ds_read_b64_tr_b16 v[90:91], v182 offset:18432
    v_mul_f32 v101, s53, v141
    v_mfma_f32_16x16x32_bf16 a[24:27], v[68:71], a[136:139], a[24:27]
    ds_read_b64_tr_b16 v[92:93], v183 offset:16384
    v_mul_f32 v102, s53, v142
    v_mfma_f32_16x16x32_bf16 a[28:31], v[68:71], a[140:143], a[28:31]
    ds_read_b64_tr_b16 v[94:95], v183 offset:18432
    v_mul_f32 v103, s53, v143
    v_mfma_f32_16x16x32_bf16 a[32:35], v[72:75], a[128:131], a[32:35]
    s_add_u32 m0, s95, 0xc000
    s_add_u32 s94, s36, 0x15000
    buffer_load_dwordx4 v211, s[68:71], s94 offen offset:0 sc1 lds
    v_mfma_f32_16x16x32_bf16 a[36:39], v[72:75], a[132:135], a[36:39]
    buffer_load_dwordx4 v211, s[68:71], s94 offen offset:1024 sc1 lds
    v_mfma_f32_16x16x32_bf16 a[40:43], v[72:75], a[136:139], a[40:43]
    buffer_load_dwordx4 v211, s[68:71], s94 offen offset:2048 sc1 lds
    v_mfma_f32_16x16x32_bf16 a[44:47], v[72:75], a[140:143], a[44:47]
    buffer_load_dwordx4 v211, s[68:71], s94 offen offset:3072 sc1 lds
    v_mfma_f32_16x16x32_bf16 a[48:51], v[76:79], a[128:131], a[48:51]
    buffer_load_dwordx4 a[240:243], v211, s[24:27], s90 offen offset:1024 sc1
    v_mfma_f32_16x16x32_bf16 a[52:55], v[76:79], a[132:135], a[52:55]
    buffer_load_dwordx4 a[244:247], v211, s[24:27], s91 offen offset:1024 sc1
    v_mfma_f32_16x16x32_bf16 a[56:59], v[76:79], a[136:139], a[56:59]
    buffer_load_dwordx4 a[248:251], v211, s[24:27], s92 offen offset:1024 sc1
    v_mfma_f32_16x16x32_bf16 a[60:63], v[76:79], a[140:143], a[60:63]
    buffer_load_dwordx4 a[252:255], v211, s[24:27], s93 offen offset:1024 sc1
    s_waitcnt vmcnt(44) lgkmcnt(0)
    v_mfma_f32_16x16x32_bf16 a[0:3], v[80:83], a[144:147], a[0:3]
    ds_read_b64_tr_b16 v[64:65], v180 offset:32768
    v_exp_f32 v96, v96
    v_mfma_f32_16x16x32_bf16 a[4:7], v[80:83], a[148:151], a[4:7]
    ds_read_b64_tr_b16 v[66:67], v180 offset:34816
    v_exp_f32 v97, v97
    v_mfma_f32_16x16x32_bf16 a[8:11], v[80:83], a[152:155], a[8:11]
    ds_read_b64_tr_b16 v[68:69], v181 offset:32768
    v_exp_f32 v98, v98
    v_mfma_f32_16x16x32_bf16 a[12:15], v[80:83], a[156:159], a[12:15]
    ds_read_b64_tr_b16 v[70:71], v181 offset:34816
    v_exp_f32 v99, v99
    v_mfma_f32_16x16x32_bf16 a[16:19], v[84:87], a[144:147], a[16:19]
    ds_read_b64_tr_b16 v[72:73], v182 offset:32768
    v_exp_f32 v100, v100
    v_mfma_f32_16x16x32_bf16 a[20:23], v[84:87], a[148:151], a[20:23]
    ds_read_b64_tr_b16 v[74:75], v182 offset:34816
    v_exp_f32 v101, v101
    v_mfma_f32_16x16x32_bf16 a[24:27], v[84:87], a[152:155], a[24:27]
    ds_read_b64_tr_b16 v[76:77], v183 offset:32768
    v_exp_f32 v102, v102
    v_mfma_f32_16x16x32_bf16 a[28:31], v[84:87], a[156:159], a[28:31]
    ds_read_b64_tr_b16 v[78:79], v183 offset:34816
    v_exp_f32 v103, v103
    v_mfma_f32_16x16x32_bf16 a[32:35], v[88:91], a[144:147], a[32:35]
    s_add_u32 m0, s95, 0x10000
    s_add_u32 s94, s36, 0x16000
    buffer_load_dwordx4 v211, s[68:71], s94 offen offset:0 sc1 lds
    v_mfma_f32_16x16x32_bf16 a[36:39], v[88:91], a[148:151], a[36:39]
    buffer_load_dwordx4 v211, s[68:71], s94 offen offset:1024 sc1 lds
    v_mfma_f32_16x16x32_bf16 a[40:43], v[88:91], a[152:155], a[40:43]
    buffer_load_dwordx4 v211, s[68:71], s94 offen offset:2048 sc1 lds
    v_mfma_f32_16x16x32_bf16 a[44:47], v[88:91], a[156:159], a[44:47]
    buffer_load_dwordx4 v211, s[68:71], s94 offen offset:3072 sc1 lds
    v_mfma_f32_16x16x32_bf16 a[48:51], v[92:95], a[144:147], a[48:51]
    buffer_load_dwordx4 a[128:131], v211, s[24:27], s90 offen offset:2048 sc1
    v_mfma_f32_16x16x32_bf16 a[52:55], v[92:95], a[148:151], a[52:55]
    buffer_load_dwordx4 a[132:135], v211, s[24:27], s91 offen offset:2048 sc1
    v_mfma_f32_16x16x32_bf16 a[56:59], v[92:95], a[152:155], a[56:59]
    buffer_load_dwordx4 a[136:139], v211, s[24:27], s92 offen offset:2048 sc1
    v_mfma_f32_16x16x32_bf16 a[60:63], v[92:95], a[156:159], a[60:63]
    buffer_load_dwordx4 a[140:143], v211, s[24:27], s93 offen offset:2048 sc1
    s_waitcnt vmcnt(44) lgkmcnt(0)
    v_mfma_f32_16x16x32_bf16 a[0:3], v[64:67], a[160:163], a[0:3]
    ds_read_b64_tr_b16 v[80:81], v180 offset:49152
    v_add_f32 v96, 1.0, v96
    v_mfma_f32_16x16x32_bf16 a[4:7], v[64:67], a[164:167], a[4:7]
    ds_read_b64_tr_b16 v[82:83], v180 offset:51200
    v_add_f32 v97, 1.0, v97
    v_mfma_f32_16x16x32_bf16 a[8:11], v[64:67], a[168:171], a[8:11]
    ds_read_b64_tr_b16 v[84:85], v181 offset:49152
    v_add_f32 v98, 1.0, v98
    v_mfma_f32_16x16x32_bf16 a[12:15], v[64:67], a[172:175], a[12:15]
    ds_read_b64_tr_b16 v[86:87], v181 offset:51200
    v_add_f32 v99, 1.0, v99
    v_mfma_f32_16x16x32_bf16 a[16:19], v[68:71], a[160:163], a[16:19]
    ds_read_b64_tr_b16 v[88:89], v182 offset:49152
    v_add_f32 v100, 1.0, v100
    v_mfma_f32_16x16x32_bf16 a[20:23], v[68:71], a[164:167], a[20:23]
    ds_read_b64_tr_b16 v[90:91], v182 offset:51200
    v_add_f32 v101, 1.0, v101
    v_mfma_f32_16x16x32_bf16 a[24:27], v[68:71], a[168:171], a[24:27]
    ds_read_b64_tr_b16 v[92:93], v183 offset:49152
    v_add_f32 v102, 1.0, v102
    v_mfma_f32_16x16x32_bf16 a[28:31], v[68:71], a[172:175], a[28:31]
    ds_read_b64_tr_b16 v[94:95], v183 offset:51200
    v_add_f32 v103, 1.0, v103
    v_mfma_f32_16x16x32_bf16 a[32:35], v[72:75], a[160:163], a[32:35]
    s_add_u32 m0, s95, 0x14000
    s_add_u32 s94, s36, 0x17000
    buffer_load_dwordx4 v211, s[68:71], s94 offen offset:0 sc1 lds
    v_mfma_f32_16x16x32_bf16 a[36:39], v[72:75], a[164:167], a[36:39]
    buffer_load_dwordx4 v211, s[68:71], s94 offen offset:1024 sc1 lds
    v_mfma_f32_16x16x32_bf16 a[40:43], v[72:75], a[168:171], a[40:43]
    buffer_load_dwordx4 v211, s[68:71], s94 offen offset:2048 sc1 lds
    v_mfma_f32_16x16x32_bf16 a[44:47], v[72:75], a[172:175], a[44:47]
    buffer_load_dwordx4 v211, s[68:71], s94 offen offset:3072 sc1 lds
    v_mfma_f32_16x16x32_bf16 a[48:51], v[76:79], a[160:163], a[48:51]
    buffer_load_dwordx4 a[144:147], v211, s[24:27], s90 offen offset:3072 sc1
    s_add_u32 s90, s90, 4096
    v_mfma_f32_16x16x32_bf16 a[52:55], v[76:79], a[164:167], a[52:55]
    buffer_load_dwordx4 a[148:151], v211, s[24:27], s91 offen offset:3072 sc1
    s_add_u32 s91, s91, 4096
    v_mfma_f32_16x16x32_bf16 a[56:59], v[76:79], a[168:171], a[56:59]
    buffer_load_dwordx4 a[152:155], v211, s[24:27], s92 offen offset:3072 sc1
    s_add_u32 s92, s92, 4096
    v_mfma_f32_16x16x32_bf16 a[60:63], v[76:79], a[172:175], a[60:63]
    buffer_load_dwordx4 a[156:159], v211, s[24:27], s93 offen offset:3072 sc1
    s_add_u32 s93, s93, 4096
    s_waitcnt vmcnt(44) lgkmcnt(0)
    v_mfma_f32_16x16x32_bf16 a[0:3], v[80:83], a[176:179], a[0:3]
    ds_read_b64_tr_b16 v[64:65], v248 offset:0
    v_rcp_f32 v96, v96
    v_mfma_f32_16x16x32_bf16 a[4:7], v[80:83], a[180:183], a[4:7]
    ds_read_b64_tr_b16 v[66:67], v248 offset:2048
    v_rcp_f32 v97, v97
    v_mfma_f32_16x16x32_bf16 a[8:11], v[80:83], a[184:187], a[8:11]
    ds_read_b64_tr_b16 v[68:69], v249 offset:0
    v_rcp_f32 v98, v98
    v_mfma_f32_16x16x32_bf16 a[12:15], v[80:83], a[188:191], a[12:15]
    ds_read_b64_tr_b16 v[70:71], v249 offset:2048
    v_rcp_f32 v99, v99
    v_mfma_f32_16x16x32_bf16 a[16:19], v[84:87], a[176:179], a[16:19]
    ds_read_b64_tr_b16 v[72:73], v250 offset:0
    v_rcp_f32 v100, v100
    v_mfma_f32_16x16x32_bf16 a[20:23], v[84:87], a[180:183], a[20:23]
    ds_read_b64_tr_b16 v[74:75], v250 offset:2048
    v_rcp_f32 v101, v101
    v_mfma_f32_16x16x32_bf16 a[24:27], v[84:87], a[184:187], a[24:27]
    ds_read_b64_tr_b16 v[76:77], v251 offset:0
    v_rcp_f32 v102, v102
    v_mfma_f32_16x16x32_bf16 a[28:31], v[84:87], a[188:191], a[28:31]
    ds_read_b64_tr_b16 v[78:79], v251 offset:2048
    v_rcp_f32 v103, v103
    v_mfma_f32_16x16x32_bf16 a[32:35], v[88:91], a[176:179], a[32:35]
    s_add_u32 m0, s95, 0x18000
    s_add_u32 s94, s36, 0x18000
    buffer_load_dwordx4 v211, s[68:71], s94 offen offset:0 sc1 lds
    v_mfma_f32_16x16x32_bf16 a[36:39], v[88:91], a[180:183], a[36:39]
    buffer_load_dwordx4 v211, s[68:71], s94 offen offset:1024 sc1 lds
    v_mfma_f32_16x16x32_bf16 a[40:43], v[88:91], a[184:187], a[40:43]
    buffer_load_dwordx4 v211, s[68:71], s94 offen offset:2048 sc1 lds
    v_mfma_f32_16x16x32_bf16 a[44:47], v[88:91], a[188:191], a[44:47]
    buffer_load_dwordx4 v211, s[68:71], s94 offen offset:3072 sc1 lds
    v_mfma_f32_16x16x32_bf16 a[48:51], v[92:95], a[176:179], a[48:51]
    buffer_load_dwordx4 a[160:163], v211, s[24:27], s90 offen offset:0 sc1
    v_mfma_f32_16x16x32_bf16 a[52:55], v[92:95], a[180:183], a[52:55]
    buffer_load_dwordx4 a[164:167], v211, s[24:27], s91 offen offset:0 sc1
    v_mfma_f32_16x16x32_bf16 a[56:59], v[92:95], a[184:187], a[56:59]
    buffer_load_dwordx4 a[168:171], v211, s[24:27], s92 offen offset:0 sc1
    v_mfma_f32_16x16x32_bf16 a[60:63], v[92:95], a[188:191], a[60:63]
    buffer_load_dwordx4 a[172:175], v211, s[24:27], s93 offen offset:0 sc1
    s_waitcnt vmcnt(44) lgkmcnt(0)
    v_mfma_f32_16x16x32_bf16 a[0:3], v[64:67], a[192:195], a[0:3]
    ds_read_b64_tr_b16 v[80:81], v248 offset:16384
    v_mul_f32 v136, v136, v96
    v_mfma_f32_16x16x32_bf16 a[4:7], v[64:67], a[196:199], a[4:7]
    ds_read_b64_tr_b16 v[82:83], v248 offset:18432
    v_mul_f32 v137, v137, v97
    v_mfma_f32_16x16x32_bf16 a[8:11], v[64:67], a[200:203], a[8:11]
    ds_read_b64_tr_b16 v[84:85], v249 offset:16384
    v_mul_f32 v138, v138, v98
    v_mfma_f32_16x16x32_bf16 a[12:15], v[64:67], a[204:207], a[12:15]
    ds_read_b64_tr_b16 v[86:87], v249 offset:18432
    v_mul_f32 v139, v139, v99
    v_mfma_f32_16x16x32_bf16 a[16:19], v[68:71], a[192:195], a[16:19]
    ds_read_b64_tr_b16 v[88:89], v250 offset:16384
    v_mul_f32 v140, v140, v100
    v_mfma_f32_16x16x32_bf16 a[20:23], v[68:71], a[196:199], a[20:23]
    ds_read_b64_tr_b16 v[90:91], v250 offset:18432
    v_mul_f32 v141, v141, v101
    v_mfma_f32_16x16x32_bf16 a[24:27], v[68:71], a[200:203], a[24:27]
    ds_read_b64_tr_b16 v[92:93], v251 offset:16384
    v_mul_f32 v142, v142, v102
    v_mfma_f32_16x16x32_bf16 a[28:31], v[68:71], a[204:207], a[28:31]
    ds_read_b64_tr_b16 v[94:95], v251 offset:18432
    v_mul_f32 v143, v143, v103
    v_mfma_f32_16x16x32_bf16 a[32:35], v[72:75], a[192:195], a[32:35]
    s_add_u32 m0, s95, 0x1c000
    s_add_u32 s94, s36, 0x19000
    buffer_load_dwordx4 v211, s[68:71], s94 offen offset:0 sc1 lds
    v_mfma_f32_16x16x32_bf16 a[36:39], v[72:75], a[196:199], a[36:39]
    buffer_load_dwordx4 v211, s[68:71], s94 offen offset:1024 sc1 lds
    v_mfma_f32_16x16x32_bf16 a[40:43], v[72:75], a[200:203], a[40:43]
    buffer_load_dwordx4 v211, s[68:71], s94 offen offset:2048 sc1 lds
    v_mfma_f32_16x16x32_bf16 a[44:47], v[72:75], a[204:207], a[44:47]
    buffer_load_dwordx4 v211, s[68:71], s94 offen offset:3072 sc1 lds
    v_mfma_f32_16x16x32_bf16 a[48:51], v[76:79], a[192:195], a[48:51]
    buffer_load_dwordx4 a[176:179], v211, s[24:27], s90 offen offset:1024 sc1
    v_mfma_f32_16x16x32_bf16 a[52:55], v[76:79], a[196:199], a[52:55]
    buffer_load_dwordx4 a[180:183], v211, s[24:27], s91 offen offset:1024 sc1
    v_mfma_f32_16x16x32_bf16 a[56:59], v[76:79], a[200:203], a[56:59]
    buffer_load_dwordx4 a[184:187], v211, s[24:27], s92 offen offset:1024 sc1
    v_mfma_f32_16x16x32_bf16 a[60:63], v[76:79], a[204:207], a[60:63]
    buffer_load_dwordx4 a[188:191], v211, s[24:27], s93 offen offset:1024 sc1
    s_waitcnt vmcnt(44) lgkmcnt(0)
    v_mfma_f32_16x16x32_bf16 a[0:3], v[80:83], a[208:211], a[0:3]
    ds_read_b64_tr_b16 v[64:65], v248 offset:32768
    v_cvt_pk_bf16_f32 v136, 0, v136
    v_mfma_f32_16x16x32_bf16 a[4:7], v[80:83], a[212:215], a[4:7]
    ds_read_b64_tr_b16 v[66:67], v248 offset:34816
    v_cvt_pk_bf16_f32 v137, 0, v137
    v_mfma_f32_16x16x32_bf16 a[8:11], v[80:83], a[216:219], a[8:11]
    ds_read_b64_tr_b16 v[68:69], v249 offset:32768
    v_cvt_pk_bf16_f32 v138, 0, v138
    v_mfma_f32_16x16x32_bf16 a[12:15], v[80:83], a[220:223], a[12:15]
    ds_read_b64_tr_b16 v[70:71], v249 offset:34816
    v_cvt_pk_bf16_f32 v139, 0, v139
    v_mfma_f32_16x16x32_bf16 a[16:19], v[84:87], a[208:211], a[16:19]
    ds_read_b64_tr_b16 v[72:73], v250 offset:32768
    v_cvt_pk_bf16_f32 v140, 0, v140
    v_mfma_f32_16x16x32_bf16 a[20:23], v[84:87], a[212:215], a[20:23]
    ds_read_b64_tr_b16 v[74:75], v250 offset:34816
    v_cvt_pk_bf16_f32 v141, 0, v141
    v_mfma_f32_16x16x32_bf16 a[24:27], v[84:87], a[216:219], a[24:27]
    ds_read_b64_tr_b16 v[76:77], v251 offset:32768
    v_cvt_pk_bf16_f32 v142, 0, v142
    v_mfma_f32_16x16x32_bf16 a[28:31], v[84:87], a[220:223], a[28:31]
    ds_read_b64_tr_b16 v[78:79], v251 offset:34816
    v_cvt_pk_bf16_f32 v143, 0, v143
    v_mfma_f32_16x16x32_bf16 a[32:35], v[88:91], a[208:211], a[32:35]
    s_add_u32 m0, s95, 0x0
    s_add_u32 s94, s36, 0x1a000
    buffer_load_dwordx4 v211, s[68:71], s94 offen offset:0 sc1 lds
    v_mfma_f32_16x16x32_bf16 a[36:39], v[88:91], a[212:215], a[36:39]
    buffer_load_dwordx4 v211, s[68:71], s94 offen offset:1024 sc1 lds
    v_mfma_f32_16x16x32_bf16 a[40:43], v[88:91], a[216:219], a[40:43]
    buffer_load_dwordx4 v211, s[68:71], s94 offen offset:2048 sc1 lds
    v_mfma_f32_16x16x32_bf16 a[44:47], v[88:91], a[220:223], a[44:47]
    buffer_load_dwordx4 v211, s[68:71], s94 offen offset:3072 sc1 lds
    v_mfma_f32_16x16x32_bf16 a[48:51], v[92:95], a[208:211], a[48:51]
    buffer_load_dwordx4 a[192:195], v211, s[24:27], s90 offen offset:2048 sc1
    v_mfma_f32_16x16x32_bf16 a[52:55], v[92:95], a[212:215], a[52:55]
    buffer_load_dwordx4 a[196:199], v211, s[24:27], s91 offen offset:2048 sc1
    v_mfma_f32_16x16x32_bf16 a[56:59], v[92:95], a[216:219], a[56:59]
    buffer_load_dwordx4 a[200:203], v211, s[24:27], s92 offen offset:2048 sc1
    v_mfma_f32_16x16x32_bf16 a[60:63], v[92:95], a[220:223], a[60:63]
    buffer_load_dwordx4 a[204:207], v211, s[24:27], s93 offen offset:2048 sc1
    s_waitcnt vmcnt(44) lgkmcnt(0)
    v_mfma_f32_16x16x32_bf16 a[0:3], v[64:67], a[224:227], a[0:3]
    ds_read_b64_tr_b16 v[80:81], v248 offset:49152
    s_add_u32 s3, s44, 1
    s_and_b32 s3, s3, 3
    s_lshl_b32 s3, s3, 14
    s_lshl_b32 s52, s44, 12
    s_add_u32 s3, s3, s52
    v_add_u32 v204, s3, v211
    v_mfma_f32_16x16x32_bf16 a[4:7], v[64:67], a[228:231], a[4:7]
    ds_read_b64_tr_b16 v[82:83], v248 offset:51200
    s_add_u32 s3, s44, 3
    s_and_b32 s3, s3, 3
    s_lshl_b32 s3, s3, 12
    s_lshl_b32 s52, s44, 14
    s_add_u32 s3, s3, s52
    v_add_u32 v192, s3, v211
    v_mfma_f32_16x16x32_bf16 a[8:11], v[64:67], a[232:235], a[8:11]
    ds_read_b64_tr_b16 v[84:85], v249 offset:49152
    s_add_u32 s3, s44, 2
    s_and_b32 s3, s3, 3
    s_lshl_b32 s3, s3, 14
    s_lshl_b32 s52, s44, 12
    s_add_u32 s3, s3, s52
    v_add_u32 v205, s3, v211
    v_mfma_f32_16x16x32_bf16 a[12:15], v[64:67], a[236:239], a[12:15]
    ds_read_b64_tr_b16 v[86:87], v249 offset:51200
    s_add_u32 s3, s44, 2
    s_and_b32 s3, s3, 3
    s_lshl_b32 s3, s3, 12
    s_lshl_b32 s52, s44, 14
    s_add_u32 s3, s3, s52
    v_add_u32 v193, s3, v211
    v_mfma_f32_16x16x32_bf16 a[16:19], v[68:71], a[224:227], a[16:19]
    ds_read_b64_tr_b16 v[88:89], v250 offset:49152
    s_add_u32 s3, s44, 3
    s_and_b32 s3, s3, 3
    s_lshl_b32 s3, s3, 14
    s_lshl_b32 s52, s44, 12
    s_add_u32 s3, s3, s52
    v_add_u32 v206, s3, v211
    v_mfma_f32_16x16x32_bf16 a[20:23], v[68:71], a[228:231], a[20:23]
    ds_read_b64_tr_b16 v[90:91], v250 offset:51200
    s_add_u32 s3, s44, 1
    s_and_b32 s3, s3, 3
    s_lshl_b32 s3, s3, 12
    s_lshl_b32 s52, s44, 14
    s_add_u32 s3, s3, s52
    v_add_u32 v194, s3, v211
    v_mfma_f32_16x16x32_bf16 a[24:27], v[68:71], a[232:235], a[24:27]
    ds_read_b64_tr_b16 v[92:93], v251 offset:49152
    v_mfma_f32_16x16x32_bf16 a[28:31], v[68:71], a[236:239], a[28:31]
    ds_read_b64_tr_b16 v[94:95], v251 offset:51200
    v_mfma_f32_16x16x32_bf16 a[32:35], v[72:75], a[224:227], a[32:35]
    s_add_u32 m0, s95, 0x4000
    s_add_u32 s94, s36, 0x1b000
    buffer_load_dwordx4 v211, s[68:71], s94 offen offset:0 sc1 lds
    v_mfma_f32_16x16x32_bf16 a[36:39], v[72:75], a[228:231], a[36:39]
    buffer_load_dwordx4 v211, s[68:71], s94 offen offset:1024 sc1 lds
    v_mfma_f32_16x16x32_bf16 a[40:43], v[72:75], a[232:235], a[40:43]
    buffer_load_dwordx4 v211, s[68:71], s94 offen offset:2048 sc1 lds
    v_mfma_f32_16x16x32_bf16 a[44:47], v[72:75], a[236:239], a[44:47]
    buffer_load_dwordx4 v211, s[68:71], s94 offen offset:3072 sc1 lds
    v_mfma_f32_16x16x32_bf16 a[48:51], v[76:79], a[224:227], a[48:51]
    buffer_load_dwordx4 a[208:211], v211, s[24:27], s90 offen offset:3072 sc1
    s_add_u32 s90, s90, 4096
    v_mfma_f32_16x16x32_bf16 a[52:55], v[76:79], a[228:231], a[52:55]
    buffer_load_dwordx4 a[212:215], v211, s[24:27], s91 offen offset:3072 sc1
    s_add_u32 s91, s91, 4096
    v_mfma_f32_16x16x32_bf16 a[56:59], v[76:79], a[232:235], a[56:59]
    buffer_load_dwordx4 a[216:219], v211, s[24:27], s92 offen offset:3072 sc1
    s_add_u32 s92, s92, 4096
    v_mfma_f32_16x16x32_bf16 a[60:63], v[76:79], a[236:239], a[60:63]
    buffer_load_dwordx4 a[220:223], v211, s[24:27], s93 offen offset:3072 sc1
    s_add_u32 s93, s93, 4096
    s_waitcnt vmcnt(44) lgkmcnt(0)
    v_mfma_f32_16x16x32_bf16 a[0:3], v[80:83], a[240:243], a[0:3]
    ds_read_b64_tr_b16 v[64:65], v180 offset:0
    v_mfma_f32_16x16x32_bf16 a[4:7], v[80:83], a[244:247], a[4:7]
    ds_read_b64_tr_b16 v[66:67], v180 offset:2048
    v_mfma_f32_16x16x32_bf16 a[8:11], v[80:83], a[248:251], a[8:11]
    ds_read_b64_tr_b16 v[68:69], v181 offset:0
    v_mfma_f32_16x16x32_bf16 a[12:15], v[80:83], a[252:255], a[12:15]
    ds_read_b64_tr_b16 v[70:71], v181 offset:2048
    v_mfma_f32_16x16x32_bf16 a[16:19], v[84:87], a[240:243], a[16:19]
    ds_read_b64_tr_b16 v[72:73], v182 offset:0
    v_mfma_f32_16x16x32_bf16 a[20:23], v[84:87], a[244:247], a[20:23]
    ds_read_b64_tr_b16 v[74:75], v182 offset:2048
    v_mfma_f32_16x16x32_bf16 a[24:27], v[84:87], a[248:251], a[24:27]
    ds_read_b64_tr_b16 v[76:77], v183 offset:0
    v_mfma_f32_16x16x32_bf16 a[28:31], v[84:87], a[252:255], a[28:31]
    ds_read_b64_tr_b16 v[78:79], v183 offset:2048
    v_mfma_f32_16x16x32_bf16 a[32:35], v[88:91], a[240:243], a[32:35]
    s_add_u32 m0, s95, 0x8000
    s_add_u32 s94, s36, 0x1c000
    buffer_load_dwordx4 v211, s[68:71], s94 offen offset:0 sc1 lds
    v_mfma_f32_16x16x32_bf16 a[36:39], v[88:91], a[244:247], a[36:39]
    buffer_load_dwordx4 v211, s[68:71], s94 offen offset:1024 sc1 lds
    v_mfma_f32_16x16x32_bf16 a[40:43], v[88:91], a[248:251], a[40:43]
L_it12:
    s_cbranch_execz L_itrB
    buffer_load_dwordx4 v211, s[68:71], s94 offen offset:2048 sc1 lds
    v_mfma_f32_16x16x32_bf16 a[44:47], v[88:91], a[252:255], a[44:47]
    buffer_load_dwordx4 v211, s[68:71], s94 offen offset:3072 sc1 lds
    v_mfma_f32_16x16x32_bf16 a[48:51], v[92:95], a[240:243], a[48:51]
    buffer_load_dwordx4 a[224:227], v211, s[24:27], s90 offen offset:0 sc1
    v_mfma_f32_16x16x32_bf16 a[52:55], v[92:95], a[244:247], a[52:55]
    buffer_load_dwordx4 a[228:231], v211, s[24:27], s91 offen offset:0 sc1
    v_mfma_f32_16x16x32_bf16 a[56:59], v[92:95], a[248:251], a[56:59]
    buffer_load_dwordx4 a[232:235], v211, s[24:27], s92 offen offset:0 sc1
    v_mfma_f32_16x16x32_bf16 a[60:63], v[92:95], a[252:255], a[60:63]
    buffer_load_dwordx4 a[236:239], v211, s[24:27], s93 offen offset:0 sc1
    s_waitcnt vmcnt(44) lgkmcnt(0)
    v_mfma_f32_16x16x32_bf16 a[0:3], v[64:67], a[128:131], a[0:3]
    ds_read_b64_tr_b16 v[80:81], v180 offset:16384
    v_mfma_f32_16x16x32_bf16 a[4:7], v[64:67], a[132:135], a[4:7]
    ds_read_b64_tr_b16 v[82:83], v180 offset:18432
    v_mfma_f32_16x16x32_bf16 a[8:11], v[64:67], a[136:139], a[8:11]
    ds_read_b64_tr_b16 v[84:85], v181 offset:16384
    v_mfma_f32_16x16x32_bf16 a[12:15], v[64:67], a[140:143], a[12:15]
    ds_read_b64_tr_b16 v[86:87], v181 offset:18432
    v_mfma_f32_16x16x32_bf16 a[16:19], v[68:71], a[128:131], a[16:19]
    ds_read_b64_tr_b16 v[88:89], v182 offset:16384
    v_mfma_f32_16x16x32_bf16 a[20:23], v[68:71], a[132:135], a[20:23]
    ds_read_b64_tr_b16 v[90:91], v182 offset:18432
    v_mfma_f32_16x16x32_bf16 a[24:27], v[68:71], a[136:139], a[24:27]
    ds_read_b64_tr_b16 v[92:93], v183 offset:16384
    v_mfma_f32_16x16x32_bf16 a[28:31], v[68:71], a[140:143], a[28:31]
    ds_read_b64_tr_b16 v[94:95], v183 offset:18432
    v_mfma_f32_16x16x32_bf16 a[32:35], v[72:75], a[128:131], a[32:35]
    s_add_u32 m0, s95, 0xc000
    s_add_u32 s94, s36, 0x1d000
    buffer_load_dwordx4 v211, s[68:71], s94 offen offset:0 sc1 lds
    v_mfma_f32_16x16x32_bf16 a[36:39], v[72:75], a[132:135], a[36:39]
    buffer_load_dwordx4 v211, s[68:71], s94 offen offset:1024 sc1 lds
    v_mfma_f32_16x16x32_bf16 a[40:43], v[72:75], a[136:139], a[40:43]
    buffer_load_dwordx4 v211, s[68:71], s94 offen offset:2048 sc1 lds
    v_mfma_f32_16x16x32_bf16 a[44:47], v[72:75], a[140:143], a[44:47]
    buffer_load_dwordx4 v211, s[68:71], s94 offen offset:3072 sc1 lds
    v_mfma_f32_16x16x32_bf16 a[48:51], v[76:79], a[128:131], a[48:51]
    buffer_load_dwordx4 a[240:243], v211, s[24:27], s90 offen offset:1024 sc1
    v_mfma_f32_16x16x32_bf16 a[52:55], v[76:79], a[132:135], a[52:55]
    buffer_load_dwordx4 a[244:247], v211, s[24:27], s91 offen offset:1024 sc1
    v_mfma_f32_16x16x32_bf16 a[56:59], v[76:79], a[136:139], a[56:59]
    buffer_load_dwordx4 a[248:251], v211, s[24:27], s92 offen offset:1024 sc1
    v_mfma_f32_16x16x32_bf16 a[60:63], v[76:79], a[140:143], a[60:63]
    buffer_load_dwordx4 a[252:255], v211, s[24:27], s93 offen offset:1024 sc1
    s_waitcnt vmcnt(44) lgkmcnt(0)
    v_mfma_f32_16x16x32_bf16 a[0:3], v[80:83], a[144:147], a[0:3]
    ds_read_b64_tr_b16 v[64:65], v180 offset:32768
    v_mfma_f32_16x16x32_bf16 a[4:7], v[80:83], a[148:151], a[4:7]
    ds_read_b64_tr_b16 v[66:67], v180 offset:34816
    v_mfma_f32_16x16x32_bf16 a[8:11], v[80:83], a[152:155], a[8:11]
    ds_read_b64_tr_b16 v[68:69], v181 offset:32768
    v_mfma_f32_16x16x32_bf16 a[12:15], v[80:83], a[156:159], a[12:15]
    ds_read_b64_tr_b16 v[70:71], v181 offset:34816
    v_mfma_f32_16x16x32_bf16 a[16:19], v[84:87], a[144:147], a[16:19]
    ds_read_b64_tr_b16 v[72:73], v182 offset:32768
    v_mfma_f32_16x16x32_bf16 a[20:23], v[84:87], a[148:151], a[20:23]
    ds_read_b64_tr_b16 v[74:75], v182 offset:34816
    v_mfma_f32_16x16x32_bf16 a[24:27], v[84:87], a[152:155], a[24:27]
    ds_read_b64_tr_b16 v[76:77], v183 offset:32768
    v_mfma_f32_16x16x32_bf16 a[28:31], v[84:87], a[156:159], a[28:31]
    ds_read_b64_tr_b16 v[78:79], v183 offset:34816
    v_mfma_f32_16x16x32_bf16 a[32:35], v[88:91], a[144:147], a[32:35]
    s_add_u32 m0, s95, 0x10000
    s_add_u32 s94, s36, 0x1e000
    buffer_load_dwordx4 v211, s[68:71], s94 offen offset:0 sc1 lds
    v_mfma_f32_16x16x32_bf16 a[36:39], v[88:91], a[148:151], a[36:39]
    buffer_load_dwordx4 v211, s[68:71], s94 offen offset:1024 sc1 lds
    v_mfma_f32_16x16x32_bf16 a[40:43], v[88:91], a[152:155], a[40:43]
    buffer_load_dwordx4 v211, s[68:71], s94 offen offset:2048 sc1 lds
    v_mfma_f32_16x16x32_bf16 a[44:47], v[88:91], a[156:159], a[44:47]
    buffer_load_dwordx4 v211, s[68:71], s94 offen offset:3072 sc1 lds
    v_mfma_f32_16x16x32_bf16 a[48:51], v[92:95], a[144:147], a[48:51]
    buffer_load_dwordx4 a[128:131], v211, s[24:27], s90 offen offset:2048 sc1
    v_mfma_f32_16x16x32_bf16 a[52:55], v[92:95], a[148:151], a[52:55]
    buffer_load_dwordx4 a[132:135], v211, s[24:27], s91 offen offset:2048 sc1
    v_mfma_f32_16x16x32_bf16 a[56:59], v[92:95], a[152:155], a[56:59]
    buffer_load_dwordx4 a[136:139], v211, s[24:27], s92 offen offset:2048 sc1
    v_mfma_f32_16x16x32_bf16 a[60:63], v[92:95], a[156:159], a[60:63]
    buffer_load_dwordx4 a[140:143], v211, s[24:27], s93 offen offset:2048 sc1
    s_waitcnt vmcnt(44) lgkmcnt(0)
    v_mfma_f32_16x16x32_bf16 a[0:3], v[64:67], a[160:163], a[0:3]
    ds_read_b64_tr_b16 v[80:81], v180 offset:49152
    v_mfma_f32_16x16x32_bf16 a[4:7], v[64:67], a[164:167], a[4:7]
    ds_read_b64_tr_b16 v[82:83], v180 offset:51200
    v_mfma_f32_16x16x32_bf16 a[8:11], v[64:67], a[168:171], a[8:11]
    ds_read_b64_tr_b16 v[84:85], v181 offset:49152
    v_mfma_f32_16x16x32_bf16 a[12:15], v[64:67], a[172:175], a[12:15]
    ds_read_b64_tr_b16 v[86:87], v181 offset:51200
    v_mfma_f32_16x16x32_bf16 a[16:19], v[68:71], a[160:163], a[16:19]
    ds_read_b64_tr_b16 v[88:89], v182 offset:49152
    v_mfma_f32_16x16x32_bf16 a[20:23], v[68:71], a[164:167], a[20:23]
    ds_read_b64_tr_b16 v[90:91], v182 offset:51200
    v_mfma_f32_16x16x32_bf16 a[24:27], v[68:71], a[168:171], a[24:27]
    ds_read_b64_tr_b16 v[92:93], v183 offset:49152
    v_mfma_f32_16x16x32_bf16 a[28:31], v[68:71], a[172:175], a[28:31]
    ds_read_b64_tr_b16 v[94:95], v183 offset:51200
    v_mfma_f32_16x16x32_bf16 a[32:35], v[72:75], a[160:163], a[32:35]
    s_add_u32 m0, s95, 0x14000
    s_add_u32 s94, s36, 0x1f000
    buffer_load_dwordx4 v211, s[68:71], s94 offen offset:0 sc1 lds
    v_mfma_f32_16x16x32_bf16 a[36:39], v[72:75], a[164:167], a[36:39]
    buffer_load_dwordx4 v211, s[68:71], s94 offen offset:1024 sc1 lds
    v_mfma_f32_16x16x32_bf16 a[40:43], v[72:75], a[168:171], a[40:43]
    buffer_load_dwordx4 v211, s[68:71], s94 offen offset:2048 sc1 lds
    v_mfma_f32_16x16x32_bf16 a[44:47], v[72:75], a[172:175], a[44:47]
    buffer_load_dwordx4 v211, s[68:71], s94 offen offset:3072 sc1 lds
    v_mfma_f32_16x16x32_bf16 a[48:51], v[76:79], a[160:163], a[48:51]
    buffer_load_dwordx4 a[144:147], v211, s[24:27], s90 offen offset:3072 sc1
    s_add_u32 s90, s90, 4096
    v_mfma_f32_16x16x32_bf16 a[52:55], v[76:79], a[164:167], a[52:55]
    buffer_load_dwordx4 a[148:151], v211, s[24:27], s91 offen offset:3072 sc1
    s_add_u32 s91, s91, 4096
    v_mfma_f32_16x16x32_bf16 a[56:59], v[76:79], a[168:171], a[56:59]
    buffer_load_dwordx4 a[152:155], v211, s[24:27], s92 offen offset:3072 sc1
    s_add_u32 s92, s92, 4096
    v_mfma_f32_16x16x32_bf16 a[60:63], v[76:79], a[172:175], a[60:63]
    buffer_load_dwordx4 a[156:159], v211, s[24:27], s93 offen offset:3072 sc1
    s_add_u32 s93, s93, 4096
    s_waitcnt vmcnt(44) lgkmcnt(0)
    v_mfma_f32_16x16x32_bf16 a[0:3], v[80:83], a[176:179], a[0:3]
    ds_read_b64_tr_b16 v[64:65], v248 offset:0
    v_mfma_f32_16x16x32_bf16 a[4:7], v[80:83], a[180:183], a[4:7]
    ds_read_b64_tr_b16 v[66:67], v248 offset:2048
    v_mfma_f32_16x16x32_bf16 a[8:11], v[80:83], a[184:187], a[8:11]
    ds_read_b64_tr_b16 v[68:69], v249 offset:0
    v_mfma_f32_16x16x32_bf16 a[12:15], v[80:83], a[188:191], a[12:15]
    ds_read_b64_tr_b16 v[70:71], v249 offset:2048
    v_mfma_f32_16x16x32_bf16 a[16:19], v[84:87], a[176:179], a[16:19]
    ds_read_b64_tr_b16 v[72:73], v250 offset:0
    v_mfma_f32_16x16x32_bf16 a[20:23], v[84:87], a[180:183], a[20:23]
    ds_read_b64_tr_b16 v[74:75], v250 offset:2048
    v_mfma_f32_16x16x32_bf16 a[24:27], v[84:87], a[184:187], a[24:27]
    ds_read_b64_tr_b16 v[76:77], v251 offset:0
    v_mfma_f32_16x16x32_bf16 a[28:31], v[84:87], a[188:191], a[28:31]
    ds_read_b64_tr_b16 v[78:79], v251 offset:2048
    v_mfma_f32_16x16x32_bf16 a[32:35], v[88:91], a[176:179], a[32:35]
    buffer_load_dwordx2 v[196:197], v252, s[76:79], 0 offen offset:0
    v_mfma_f32_16x16x32_bf16 a[36:39], v[88:91], a[180:183], a[36:39]
    buffer_load_dwordx2 v[198:199], v252, s[76:79], 0 offen offset:32
    v_mfma_f32_16x16x32_bf16 a[40:43], v[88:91], a[184:187], a[40:43]
    buffer_load_dwordx2 v[200:201], v252, s[76:79], 0 offen offset:64
    v_mfma_f32_16x16x32_bf16 a[44:47], v[88:91], a[188:191], a[44:47]
    buffer_load_dwordx2 v[202:203], v252, s[76:79], 0 offen offset:96
    v_mfma_f32_16x16x32_bf16 a[48:51], v[92:95], a[176:179], a[48:51]
    v_mfma_f32_16x16x32_bf16 a[52:55], v[92:95], a[180:183], a[52:55]
    v_mfma_f32_16x16x32_bf16 a[56:59], v[92:95], a[184:187], a[56:59]
    v_mfma_f32_16x16x32_bf16 a[60:63], v[92:95], a[188:191], a[60:63]
    s_waitcnt vmcnt(40) lgkmcnt(0)
    v_mfma_f32_16x16x32_bf16 a[0:3], v[64:67], a[192:195], a[0:3]
    ds_read_b64_tr_b16 v[80:81], v248 offset:16384
    v_mfma_f32_16x16x32_bf16 a[4:7], v[64:67], a[196:199], a[4:7]
    ds_read_b64_tr_b16 v[82:83], v248 offset:18432
    v_mfma_f32_16x16x32_bf16 a[8:11], v[64:67], a[200:203], a[8:11]
    ds_read_b64_tr_b16 v[84:85], v249 offset:16384
    v_mfma_f32_16x16x32_bf16 a[12:15], v[64:67], a[204:207], a[12:15]
    ds_read_b64_tr_b16 v[86:87], v249 offset:18432
    v_mfma_f32_16x16x32_bf16 a[16:19], v[68:71], a[192:195], a[16:19]
    ds_read_b64_tr_b16 v[88:89], v250 offset:16384
    v_mfma_f32_16x16x32_bf16 a[20:23], v[68:71], a[196:199], a[20:23]
    ds_read_b64_tr_b16 v[90:91], v250 offset:18432
    v_mfma_f32_16x16x32_bf16 a[24:27], v[68:71], a[200:203], a[24:27]
    ds_read_b64_tr_b16 v[92:93], v251 offset:16384
    v_mfma_f32_16x16x32_bf16 a[28:31], v[68:71], a[204:207], a[28:31]
    ds_read_b64_tr_b16 v[94:95], v251 offset:18432
    v_mfma_f32_16x16x32_bf16 a[32:35], v[72:75], a[192:195], a[32:35]
    v_mfma_f32_16x16x32_bf16 a[36:39], v[72:75], a[196:199], a[36:39]
    v_mfma_f32_16x16x32_bf16 a[40:43], v[72:75], a[200:203], a[40:43]
    v_mfma_f32_16x16x32_bf16 a[44:47], v[72:75], a[204:207], a[44:47]
    v_mfma_f32_16x16x32_bf16 a[48:51], v[76:79], a[192:195], a[48:51]
    v_mfma_f32_16x16x32_bf16 a[52:55], v[76:79], a[196:199], a[52:55]
    v_mfma_f32_16x16x32_bf16 a[56:59], v[76:79], a[200:203], a[56:59]
    v_mfma_f32_16x16x32_bf16 a[60:63], v[76:79], a[204:207], a[60:63]
    s_waitcnt vmcnt(32) lgkmcnt(0)
    v_mfma_f32_16x16x32_bf16 a[0:3], v[80:83], a[208:211], a[0:3]
    ds_read_b64_tr_b16 v[64:65], v248 offset:32768
    v_mfma_f32_16x16x32_bf16 a[4:7], v[80:83], a[212:215], a[4:7]
    ds_read_b64_tr_b16 v[66:67], v248 offset:34816
    v_mfma_f32_16x16x32_bf16 a[8:11], v[80:83], a[216:219], a[8:11]
    ds_read_b64_tr_b16 v[68:69], v249 offset:32768
    v_mfma_f32_16x16x32_bf16 a[12:15], v[80:83], a[220:223], a[12:15]
    ds_read_b64_tr_b16 v[70:71], v249 offset:34816
    v_mfma_f32_16x16x32_bf16 a[16:19], v[84:87], a[208:211], a[16:19]
    ds_read_b64_tr_b16 v[72:73], v250 offset:32768
    v_mfma_f32_16x16x32_bf16 a[20:23], v[84:87], a[212:215], a[20:23]
    ds_read_b64_tr_b16 v[74:75], v250 offset:34816
    v_mfma_f32_16x16x32_bf16 a[24:27], v[84:87], a[216:219], a[24:27]
    ds_read_b64_tr_b16 v[76:77], v251 offset:32768
    v_mfma_f32_16x16x32_bf16 a[28:31], v[84:87], a[220:223], a[28:31]
    ds_read_b64_tr_b16 v[78:79], v251 offset:34816
    v_mfma_f32_16x16x32_bf16 a[32:35], v[88:91], a[208:211], a[32:35]
    v_mfma_f32_16x16x32_bf16 a[36:39], v[88:91], a[212:215], a[36:39]
    v_mfma_f32_16x16x32_bf16 a[40:43], v[88:91], a[216:219], a[40:43]
    v_mfma_f32_16x16x32_bf16 a[44:47], v[88:91], a[220:223], a[44:47]
    v_mfma_f32_16x16x32_bf16 a[48:51], v[92:95], a[208:211], a[48:51]
    v_mfma_f32_16x16x32_bf16 a[52:55], v[92:95], a[212:215], a[52:55]
    v_mfma_f32_16x16x32_bf16 a[56:59], v[92:95], a[216:219], a[56:59]
    v_mfma_f32_16x16x32_bf16 a[60:63], v[92:95], a[220:223], a[60:63]
    s_waitcnt vmcnt(24) lgkmcnt(0)
    v_mfma_f32_16x16x32_bf16 a[0:3], v[64:67], a[224:227], a[0:3]
    ds_read_b64_tr_b16 v[80:81], v248 offset:49152
    v_mfma_f32_16x16x32_bf16 a[4:7], v[64:67], a[228:231], a[4:7]
    ds_read_b64_tr_b16 v[82:83], v248 offset:51200
    v_mfma_f32_16x16x32_bf16 a[8:11], v[64:67], a[232:235], a[8:11]
    ds_read_b64_tr_b16 v[84:85], v249 offset:49152
    v_mfma_f32_16x16x32_bf16 a[12:15], v[64:67], a[236:239], a[12:15]
    ds_read_b64_tr_b16 v[86:87], v249 offset:51200
    v_mfma_f32_16x16x32_bf16 a[16:19], v[68:71], a[224:227], a[16:19]
    ds_read_b64_tr_b16 v[88:89], v250 offset:49152
    v_mfma_f32_16x16x32_bf16 a[20:23], v[68:71], a[228:231], a[20:23]
    ds_read_b64_tr_b16 v[90:91], v250 offset:51200
    v_mfma_f32_16x16x32_bf16 a[24:27], v[68:71], a[232:235], a[24:27]
    ds_read_b64_tr_b16 v[92:93], v251 offset:49152
    v_mfma_f32_16x16x32_bf16 a[28:31], v[68:71], a[236:239], a[28:31]
    ds_read_b64_tr_b16 v[94:95], v251 offset:51200
    v_mfma_f32_16x16x32_bf16 a[32:35], v[72:75], a[224:227], a[32:35]
    v_mfma_f32_16x16x32_bf16 a[36:39], v[72:75], a[228:231], a[36:39]
    v_mfma_f32_16x16x32_bf16 a[40:43], v[72:75], a[232:235], a[40:43]
    v_mfma_f32_16x16x32_bf16 a[44:47], v[72:75], a[236:239], a[44:47]
    v_mfma_f32_16x16x32_bf16 a[48:51], v[76:79], a[224:227], a[48:51]
    v_mfma_f32_16x16x32_bf16 a[52:55], v[76:79], a[228:231], a[52:55]
    v_mfma_f32_16x16x32_bf16 a[56:59], v[76:79], a[232:235], a[56:59]
    v_mfma_f32_16x16x32_bf16 a[60:63], v[76:79], a[236:239], a[60:63]
    s_waitcnt vmcnt(8) lgkmcnt(0)
    v_mfma_f32_16x16x32_bf16 a[0:3], v[80:83], a[240:243], a[0:3]
    ds_read_b64_tr_b16 v[64:65], v180 offset:0
    v_mfma_f32_16x16x32_bf16 a[4:7], v[80:83], a[244:247], a[4:7]
    ds_read_b64_tr_b16 v[66:67], v180 offset:2048
    v_mfma_f32_16x16x32_bf16 a[8:11], v[80:83], a[248:251], a[8:11]
    ds_read_b64_tr_b16 v[68:69], v181 offset:0
    v_mfma_f32_16x16x32_bf16 a[12:15], v[80:83], a[252:255], a[12:15]
    ds_read_b64_tr_b16 v[70:71], v181 offset:2048
    v_mfma_f32_16x16x32_bf16 a[16:19], v[84:87], a[240:243], a[16:19]
    ds_read_b64_tr_b16 v[72:73], v182 offset:0
    v_mfma_f32_16x16x32_bf16 a[20:23], v[84:87], a[244:247], a[20:23]
    ds_read_b64_tr_b16 v[74:75], v182 offset:2048
    v_mfma_f32_16x16x32_bf16 a[24:27], v[84:87], a[248:251], a[24:27]
    ds_read_b64_tr_b16 v[76:77], v183 offset:0
    v_mfma_f32_16x16x32_bf16 a[28:31], v[84:87], a[252:255], a[28:31]
    ds_read_b64_tr_b16 v[78:79], v183 offset:2048
    v_mfma_f32_16x16x32_bf16 a[32:35], v[88:91], a[240:243], a[32:35]
    ds_read_b64_tr_b16 v[0:1], v180 offset:16384
    v_mfma_f32_16x16x32_bf16 a[36:39], v[88:91], a[244:247], a[36:39]
    ds_read_b64_tr_b16 v[2:3], v180 offset:18432
    v_mfma_f32_16x16x32_bf16 a[40:43], v[88:91], a[248:251], a[40:43]
    ds_read_b64_tr_b16 v[4:5], v181 offset:16384
    v_mfma_f32_16x16x32_bf16 a[44:47], v[88:91], a[252:255], a[44:47]
    ds_read_b64_tr_b16 v[6:7], v181 offset:18432
    v_mfma_f32_16x16x32_bf16 a[48:51], v[92:95], a[240:243], a[48:51]
    ds_read_b64_tr_b16 v[8:9], v182 offset:16384
    v_mfma_f32_16x16x32_bf16 a[52:55], v[92:95], a[244:247], a[52:55]
    ds_read_b64_tr_b16 v[10:11], v182 offset:18432
    v_mfma_f32_16x16x32_bf16 a[56:59], v[92:95], a[248:251], a[56:59]
    ds_read_b64_tr_b16 v[12:13], v183 offset:16384
    v_mfma_f32_16x16x32_bf16 a[60:63], v[92:95], a[252:255], a[60:63]
    ds_read_b64_tr_b16 v[14:15], v183 offset:18432
    s_waitcnt vmcnt(4) lgkmcnt(0)
    v_mfma_f32_16x16x32_bf16 a[4:7], v[64:67], a[132:135], a[4:7]
    v_mfma_f32_16x16x32_bf16 a[4:7], v[0:3], a[148:151], a[4:7]
    v_mfma_f32_16x16x32_bf16 a[8:11], v[64:67], a[136:139], a[8:11]
    v_mfma_f32_16x16x32_bf16 a[8:11], v[0:3], a[152:155], a[8:11]
    v_mfma_f32_16x16x32_bf16 a[12:15], v[64:67], a[140:143], a[12:15]
    v_mfma_f32_16x16x32_bf16 a[12:15], v[0:3], a[156:159], a[12:15]
    s_nop 3
    ds_write_b128 v204, a[4:7] offset:0
    v_mfma_f32_16x16x32_bf16 a[20:23], v[68:71], a[132:135], a[20:23]
    v_mfma_f32_16x16x32_bf16 a[20:23], v[4:7], a[148:151], a[20:23]
    ds_write_b128 v205, a[8:11] offset:0
    v_mfma_f32_16x16x32_bf16 a[24:27], v[68:71], a[136:139], a[24:27]
    v_mfma_f32_16x16x32_bf16 a[24:27], v[4:7], a[152:155], a[24:27]
    ds_write_b128 v206, a[12:15] offset:0
    v_mfma_f32_16x16x32_bf16 a[28:31], v[68:71], a[140:143], a[28:31]
    v_mfma_f32_16x16x32_bf16 a[28:31], v[4:7], a[156:159], a[28:31]
    s_nop 1
    ds_write_b128 v204, a[20:23] offset:1024
    v_mfma_f32_16x16x32_bf16 a[36:39], v[72:75], a[132:135], a[36:39]
    v_mfma_f32_16x16x32_bf16 a[36:39], v[8:11], a[148:151], a[36:39]
    ds_write_b128 v205, a[24:27] offset:1024
    v_mfma_f32_16x16x32_bf16 a[40:43], v[72:75], a[136:139], a[40:43]
    v_mfma_f32_16x16x32_bf16 a[40:43], v[8:11], a[152:155], a[40:43]
    ds_write_b128 v206, a[28:31] offset:1024
    v_mfma_f32_16x16x32_bf16 a[44:47], v[72:75], a[140:143], a[44:47]
    v_mfma_f32_16x16x32_bf16 a[44:47], v[8:11], a[156:159], a[44:47]
    s_nop 1
    ds_write_b128 v204, a[36:39] offset:2048
    v_mfma_f32_16x16x32_bf16 a[52:55], v[76:79], a[132:135], a[52:55]
    v_mfma_f32_16x16x32_bf16 a[52:55], v[12:15], a[148:151], a[52:55]
    ds_write_b128 v205, a[40:43] offset:2048
    v_mfma_f32_16x16x32_bf16 a[56:59], v[76:79], a[136:139], a[56:59]
    v_mfma_f32_16x16x32_bf16 a[56:59], v[12:15], a[152:155], a[56:59]
    ds_write_b128 v206, a[44:47] offset:2048
    v_mfma_f32_16x16x32_bf16 a[60:63], v[76:79], a[140:143], a[60:63]
    v_mfma_f32_16x16x32_bf16 a[60:63], v[12:15], a[156:159], a[60:63]
    s_nop 1
    ds_write_b128 v204, a[52:55] offset:3072
    v_mfma_f32_16x16x32_bf16 a[0:3], v[64:67], a[128:131], a[0:3]
    v_mfma_f32_16x16x32_bf16 a[0:3], v[0:3], a[144:147], a[0:3]
    ds_write_b128 v205, a[56:59] offset:3072
    v_mfma_f32_16x16x32_bf16 a[16:19], v[68:71], a[128:131], a[16:19]
    v_mfma_f32_16x16x32_bf16 a[16:19], v[4:7], a[144:147], a[16:19]
    ds_write_b128 v206, a[60:63] offset:3072
    v_mfma_f32_16x16x32_bf16 a[32:35], v[72:75], a[128:131], a[32:35]
    v_mfma_f32_16x16x32_bf16 a[32:35], v[8:11], a[144:147], a[32:35]
    v_mfma_f32_16x16x32_bf16 a[48:51], v[76:79], a[128:131], a[48:51]
    v_mfma_f32_16x16x32_bf16 a[48:51], v[12:15], a[144:147], a[48:51]
    s_waitcnt vmcnt(0)
    v_lshlrev_b32 v144, 16, v196
    v_and_b32 v145, 0xffff0000, v196
    v_lshlrev_b32 v146, 16, v197
    v_and_b32 v147, 0xffff0000, v197
    v_lshlrev_b32 v148, 16, v198
    v_and_b32 v149, 0xffff0000, v198
    v_lshlrev_b32 v150, 16, v199
    v_and_b32 v151, 0xffff0000, v199
    v_lshlrev_b32 v152, 16, v200
    v_and_b32 v153, 0xffff0000, v200
    v_lshlrev_b32 v154, 16, v201
    v_and_b32 v155, 0xffff0000, v201
    v_lshlrev_b32 v156, 16, v202
    v_and_b32 v157, 0xffff0000, v202
    v_lshlrev_b32 v158, 16, v203
    v_and_b32 v159, 0xffff0000, v203
    v_accvgpr_read_b32 v64, a0
    v_accvgpr_read_b32 v65, a1
    v_accvgpr_read_b32 v66, a2
    v_accvgpr_read_b32 v67, a3
    v_accvgpr_read_b32 v80, a16
    v_accvgpr_read_b32 v81, a17
    v_accvgpr_read_b32 v82, a18
    v_accvgpr_read_b32 v83, a19
    v_accvgpr_read_b32 v96, a32
    v_accvgpr_read_b32 v97, a33
    v_accvgpr_read_b32 v98, a34
    v_accvgpr_read_b32 v99, a35
    v_accvgpr_read_b32 v112, a48
    v_accvgpr_read_b32 v113, a49
    v_accvgpr_read_b32 v114, a50
    v_accvgpr_read_b32 v115, a51
    s_waitcnt lgkmcnt(0)
    s_barrier
    ds_read_b128 v[68:71], v192 offset:0
    ds_read_b128 v[72:75], v193 offset:0
    ds_read_b128 v[76:79], v194 offset:0
    ds_read_b128 v[84:87], v192 offset:1024
    ds_read_b128 v[88:91], v193 offset:1024
    ds_read_b128 v[92:95], v194 offset:1024
    ds_read_b128 v[100:103], v192 offset:2048
    ds_read_b128 v[104:107], v193 offset:2048
    ds_read_b128 v[108:111], v194 offset:2048
    ds_read_b128 v[116:119], v192 offset:3072
    ds_read_b128 v[120:123], v193 offset:3072
    ds_read_b128 v[124:127], v194 offset:3072
    s_waitcnt lgkmcnt(9)
    v_pk_add_f32 v[64:65], v[64:65], v[68:69]
    v_pk_add_f32 v[66:67], v[66:67], v[70:71]
    v_pk_add_f32 v[72:73], v[72:73], v[76:77]
    v_pk_add_f32 v[74:75], v[74:75], v[78:79]
    v_pk_add_f32 v[64:65], v[64:65], v[72:73]
    v_pk_add_f32 v[66:67], v[66:67], v[74:75]
    v_cvt_pk_bf16_f32 v64, 0, v64
    v_cvt_pk_bf16_f32 v65, 0, v65
    v_cvt_pk_bf16_f32 v66, 0, v66
    v_cvt_pk_bf16_f32 v67, 0, v67
    v_pk_mul_f32 v[64:65], v[64:65], v[128:129]
    v_pk_mul_f32 v[66:67], v[66:67], v[130:131]
    v_cvt_pk_bf16_f32 v64, 0, v64
    v_cvt_pk_bf16_f32 v65, 0, v65
    v_cvt_pk_bf16_f32 v66, 0, v66
    v_cvt_pk_bf16_f32 v67, 0, v67
    v_pk_add_f32 v[64:65], v[64:65], v[144:145]
    v_pk_add_f32 v[66:67], v[66:67], v[146:147]
    v_cvt_pk_bf16_f32 v164, v64, v65
    v_cvt_pk_bf16_f32 v165, v66, v67
    buffer_store_dwordx2 v[164:165], v252, s[80:83], 0 offen offset:0
    s_waitcnt lgkmcnt(6)
    v_pk_add_f32 v[80:81], v[80:81], v[84:85]
    v_pk_add_f32 v[82:83], v[82:83], v[86:87]
    v_pk_add_f32 v[88:89], v[88:89], v[92:93]
    v_pk_add_f32 v[90:91], v[90:91], v[94:95]
    v_pk_add_f32 v[80:81], v[80:81], v[88:89]
    v_pk_add_f32 v[82:83], v[82:83], v[90:91]
    v_cvt_pk_bf16_f32 v80, 0, v80
    v_cvt_pk_bf16_f32 v81, 0, v81
    v_cvt_pk_bf16_f32 v82, 0, v82
    v_cvt_pk_bf16_f32 v83, 0, v83
    v_pk_mul_f32 v[80:81], v[80:81], v[132:133]
    v_pk_mul_f32 v[82:83], v[82:83], v[134:135]
    v_cvt_pk_bf16_f32 v80, 0, v80
    v_cvt_pk_bf16_f32 v81, 0, v81
    v_cvt_pk_bf16_f32 v82, 0, v82
    v_cvt_pk_bf16_f32 v83, 0, v83
    v_pk_add_f32 v[80:81], v[80:81], v[148:149]
    v_pk_add_f32 v[82:83], v[82:83], v[150:151]
    v_cvt_pk_bf16_f32 v166, v80, v81
    v_cvt_pk_bf16_f32 v167, v82, v83
    buffer_store_dwordx2 v[166:167], v252, s[80:83], 0 offen offset:32
    s_waitcnt lgkmcnt(3)
    v_pk_add_f32 v[96:97], v[96:97], v[100:101]
    v_pk_add_f32 v[98:99], v[98:99], v[102:103]
    v_pk_add_f32 v[104:105], v[104:105], v[108:109]
    v_pk_add_f32 v[106:107], v[106:107], v[110:111]
    v_pk_add_f32 v[96:97], v[96:97], v[104:105]
    v_pk_add_f32 v[98:99], v[98:99], v[106:107]
    v_cvt_pk_bf16_f32 v96, 0, v96
    v_cvt_pk_bf16_f32 v97, 0, v97
    v_cvt_pk_bf16_f32 v98, 0, v98
    v_cvt_pk_bf16_f32 v99, 0, v99
    v_pk_mul_f32 v[96:97], v[96:97], v[136:137]
    v_pk_mul_f32 v[98:99], v[98:99], v[138:139]
    v_cvt_pk_bf16_f32 v96, 0, v96
    v_cvt_pk_bf16_f32 v97, 0, v97
    v_cvt_pk_bf16_f32 v98, 0, v98
    v_cvt_pk_bf16_f32 v99, 0, v99
    v_pk_add_f32 v[96:97], v[96:97], v[152:153]
    v_pk_add_f32 v[98:99], v[98:99], v[154:155]
    v_cvt_pk_bf16_f32 v168, v96, v97
    v_cvt_pk_bf16_f32 v169, v98, v99
    buffer_store_dwordx2 v[168:169], v252, s[80:83], 0 offen offset:64
    s_waitcnt lgkmcnt(0)
    v_pk_add_f32 v[112:113], v[112:113], v[116:117]
    v_pk_add_f32 v[114:115], v[114:115], v[118:119]
    v_pk_add_f32 v[120:121], v[120:121], v[124:125]
    v_pk_add_f32 v[122:123], v[122:123], v[126:127]
    v_pk_add_f32 v[112:113], v[112:113], v[120:121]
    v_pk_add_f32 v[114:115], v[114:115], v[122:123]
    v_cvt_pk_bf16_f32 v112, 0, v112
    v_cvt_pk_bf16_f32 v113, 0, v113
    v_cvt_pk_bf16_f32 v114, 0, v114
    v_cvt_pk_bf16_f32 v115, 0, v115
    v_pk_mul_f32 v[112:113], v[112:113], v[140:141]
    v_pk_mul_f32 v[114:115], v[114:115], v[142:143]
    v_cvt_pk_bf16_f32 v112, 0, v112
    v_cvt_pk_bf16_f32 v113, 0, v113
    v_cvt_pk_bf16_f32 v114, 0, v114
    v_cvt_pk_bf16_f32 v115, 0, v115
    v_pk_add_f32 v[112:113], v[112:113], v[156:157]
    v_pk_add_f32 v[114:115], v[114:115], v[158:159]
    v_cvt_pk_bf16_f32 v170, v112, v113
    v_cvt_pk_bf16_f32 v171, v114, v115
    buffer_store_dwordx2 v[170:171], v252, s[80:83], 0 offen offset:96
    s_and_b32 s3, s2, 31
    s_or_b32 s3, s3, s44
    s_cmp_eq_u32 s3, 0
    s_cbranch_scc0 L3_noup
    s_xor_b32 s3, s72, 0x9e3779b1
    s_add_u32 s3, s3, 1
    v_mov_b32 v245, s3
    v_lshlrev_b32 v244, 22, v211
    s_lshl_b32 s3, s43, 7
    s_add_u32 s3, s3, 0x4000
    buffer_store_dword v245, v244, s[24:27], s3 offen sc1
L3_noup:
    s_endpgm
    .p2align 12
L2_dost:
L_it13:
    s_cbranch_execz L_itrB
    s_mov_b32 s74, 65536
L2_spin1:
    buffer_load_dwordx2 v[228:229], v236, s[24:27], 0 offen offset:0 sc1
    buffer_load_dwordx2 v[230:231], v236, s[24:27], 0 offen offset:128 sc1
    buffer_load_dwordx2 v[232:233], v236, s[24:27], 0 offen offset:256 sc1
    buffer_load_dwordx2 v[234:235], v236, s[24:27], 0 offen offset:384 sc1
    s_waitcnt vmcnt(0)
    v_cmp_eq_u32 vcc, s72, v229
    v_cmp_eq_u32 s[88:89], s72, v231
    v_cmp_eq_u32 s[90:91], s72, v233
    v_cmp_eq_u32 s[92:93], s72, v235
    s_nop 1
    s_and_b64 vcc, vcc, s[88:89]
    s_nop 0
    s_and_b64 s[90:91], s[90:91], s[92:93]
    s_and_b64 vcc, vcc, s[90:91]
    s_cmp_eq_u64 vcc, -1
    s_cbranch_scc1 L2_retst
    s_sub_u32 s74, s74, 1
    s_cmp_lg_u32 s74, 0
    s_cbranch_scc1 L2_spin1
    s_branch L2_retst
L2_dosa:
    s_cmp_eq_u32 s49, 1
    s_cbranch_scc1 L2_sa1
    s_cmp_eq_u32 s49, 2
    s_cbranch_scc1 L2_sa2
    s_cmp_eq_u32 s49, 5
    s_cbranch_scc1 L2_sa5
    s_cmp_eq_u32 s49, 6
    s_cbranch_scc1 L2_sa6
    buffer_load_dwordx4 v[212:215], v211, s[60:63], s4 offen offset:0
    buffer_load_dwordx4 v[216:219], v211, s[60:63], s4 offen offset:1024
    s_branch L2_retsa
L2_sa1:
    buffer_load_dwordx4 v[212:215], v211, s[60:63], s4 offen offset:2048
    buffer_load_dwordx4 v[216:219], v211, s[60:63], s4 offen offset:3072
    s_branch L2_retsa
L2_sa2:
    buffer_load_dwordx4 v[212:215], v211, s[64:67], s56 offen
    buffer_load_dwordx4 v[216:219], v211, s[64:67], s57 offen
    s_branch L2_retsa
L2_sa5:
    buffer_load_dword v254, v253, s[84:87], 0 offen sc1
    s_branch L2_retsa
L2_sa6:
    buffer_load_dwordx4 a[224:227], v211, s[24:27], s90 offen sc1
    s_add_u32 s90, s90, 4096
    buffer_load_dwordx4 a[228:231], v211, s[24:27], s91 offen sc1
    s_add_u32 s91, s91, 4096
    buffer_load_dwordx4 a[232:235], v211, s[24:27], s92 offen sc1
    s_add_u32 s92, s92, 4096
    buffer_load_dwordx4 a[236:239], v211, s[24:27], s93 offen sc1
    s_add_u32 s93, s93, 4096
    buffer_load_dwordx4 a[240:243], v211, s[24:27], s90 offen sc1
    s_add_u32 s90, s90, 4096
    buffer_load_dwordx4 a[244:247], v211, s[24:27], s91 offen sc1
    s_add_u32 s91, s91, 4096
    buffer_load_dwordx4 a[248:251], v211, s[24:27], s92 offen sc1
    s_add_u32 s92, s92, 4096
    buffer_load_dwordx4 a[252:255], v211, s[24:27], s93 offen sc1
    s_add_u32 s93, s93, 4096
    s_branch L2_retsa
L2_dovsw:
    s_mov_b32 s12, s68
    s_mov_b32 s13, s69
    s_mov_b32 s14, s70
    s_mov_b32 s15, 0x00020000
    v_add_u32 v194, s45, v211
    v_mov_b32 v195, v194
    s_lshl_b32 s3, s44, 12
    s_sub_u32 s3, s37, s3
    s_add_u32 s48, s3, 0x10000
    s_branch L2_retvsw
L2_dochk:
    v_and_b32 v254, 0x2020202, v254
    v_cmp_eq_u32 vcc, 0x2020202, v254
    s_nop 3
    s_cmp_eq_u64 vcc, -1
    s_cbranch_scc1 L2_retchk
    s_mov_b32 s74, 65536
L2_spin2:
    buffer_load_dword v254, v253, s[84:87], 0 offen sc1
    s_waitcnt vmcnt(0)
    v_and_b32 v254, 0x2020202, v254
    v_cmp_eq_u32 vcc, 0x2020202, v254
    s_nop 3
    s_cmp_eq_u64 vcc, -1
    s_cbranch_scc1 L2_retchk
    s_sub_u32 s74, s74, 1
    s_cmp_lg_u32 s74, 0
    s_cbranch_scc1 L2_spin2
    s_branch L2_retchk
L2_dosb:
    s_cmp_eq_u32 s49, 1
    s_cbranch_scc1 L2_sb1
    s_cmp_eq_u32 s49, 2
    s_cbranch_scc1 L2_sb2
    s_cmp_eq_u32 s49, 3
    s_cbranch_scc1 L2_sb3
    s_cmp_eq_u32 s49, 5
    s_cbranch_scc1 L2_sb5
    s_cmp_eq_u32 s49, 6
    s_cbranch_scc1 L2_sb6
    buffer_store_dwordx4 v[212:215], v244, s[68:71], s5 offen offset:0 sc1
    buffer_store_dwordx4 v[216:219], v244, s[68:71], s5 offen offset:128 sc1
    s_branch L2_retsb
L2_sb1:
    buffer_store_dwordx4 v[212:215], v245, s[68:71], s5 offen offset:256 sc1
    buffer_store_dwordx4 v[216:219], v245, s[68:71], s5 offen offset:384 sc1
    s_branch L2_retsb
L2_sb2:
    buffer_store_dwordx4 v[212:215], v246, s[68:71], s58 offen sc1
    buffer_store_dwordx4 v[216:219], v247, s[68:71], s59 offen sc1
    s_branch L2_retsb
L2_sb3:
    s_lshl_b32 s3, s44, 8
    v_lshlrev_b32 v225, 4, v211
    v_add_u32 v225, s3, v225
    v_mov_b32 v226, 3
    buffer_store_byte v226, v225, s[84:87], s2 offen sc1
    s_branch L2_retsb
L2_sb5:
    s_mov_b32 s90, s38
    s_add_u32 s91, s90, 57344
    s_add_u32 s92, s91, 57344
    s_add_u32 s93, s92, 57344
    buffer_load_dwordx4 a[192:195], v211, s[24:27], s90 offen sc1
    s_add_u32 s90, s90, 4096
    buffer_load_dwordx4 a[196:199], v211, s[24:27], s91 offen sc1
    s_add_u32 s91, s91, 4096
    buffer_load_dwordx4 a[200:203], v211, s[24:27], s92 offen sc1
    s_add_u32 s92, s92, 4096
    buffer_load_dwordx4 a[204:207], v211, s[24:27], s93 offen sc1
    s_add_u32 s93, s93, 4096
    buffer_load_dwordx4 a[208:211], v211, s[24:27], s90 offen sc1
    s_add_u32 s90, s90, 4096
    buffer_load_dwordx4 a[212:215], v211, s[24:27], s91 offen sc1
    s_add_u32 s91, s91, 4096
    buffer_load_dwordx4 a[216:219], v211, s[24:27], s92 offen sc1
    s_add_u32 s92, s92, 4096
    buffer_load_dwordx4 a[220:223], v211, s[24:27], s93 offen sc1
    s_add_u32 s93, s93, 4096
    s_branch L2_retsb
L2_sb6:
    s_mov_b32 s8, s68
    s_mov_b32 s9, s69
    s_mov_b32 s10, s70
    s_mov_b32 s11, 0x00020000
    v_add_u32 v192, s45, v211
    v_mov_b32 v193, v192
    s_lshl_b32 s3, s44, 12
    s_sub_u32 s47, s37, s3
    v_lshrrev_b32 v225, 4, v211
    v_lshlrev_b32 v226, 7, v225
    s_lshr_b32 s3, s2, 3
    s_and_b32 s3, s3, 3
    s_mul_i32 s3, s3, 57344
    s_add_u32 s3, s3, s38
    s_mul_i32 s51, s44, 7168
    s_add_u32 s3, s3, s51
    s_add_u32 s3, s3, 24576
    buffer_load_dword v223, v226, s[24:27], s3 offen sc1
    v_min_u32 v225, 31, v225
    v_lshlrev_b32 v225, 7, v225
    s_lshl_b32 s3, s43, 14
    s_add_u32 s3, s3, s37
    s_add_u32 s3, s3, 98304
    buffer_load_dword v224, v225, s[68:71], s3 offen sc1
    s_branch L2_retsb
L3_dobar:
    s_barrier
    s_branch L3_go
L2_fb:
    s_waitcnt vmcnt(0) lgkmcnt(0)
    s_barrier
    s_load_dwordx2 s[8:9], s[0:1], 8
    s_load_dwordx2 s[12:13], s[0:1], 16
    s_lshl_b32 s3, s42, 19
    v_lshrrev_b32 v213, 4, v211
    v_lshrrev_b32 v214, 4, v213
    v_and_b32 v215, 15, v213
    v_mov_b32 v219, s44
    v_lshl_add_u32 v219, v219, 3, v214
    v_add_u32 v218, 0, v219
    v_and_b32 v218, 15, v218
    v_xor_b32 v218, v218, v215
    v_lshlrev_b32 v218, 4, v218
    v_lshl_add_u32 v192, v219, 8, v218
    v_add_u32 v218, 0, v214
    v_lshlrev_b32 v218, 1, v218
    v_xor_b32 v218, v218, v215
    v_lshlrev_b32 v218, 4, v218
    v_lshl_add_u32 v194, v219, 8, v218
    v_add_u32 v218, 4, v219
    v_and_b32 v218, 15, v218
    v_xor_b32 v218, v218, v215
    v_lshlrev_b32 v218, 4, v218
    v_lshl_add_u32 v193, v219, 8, v218
    v_add_u32 v218, 4, v214
    v_lshlrev_b32 v218, 1, v218
    v_xor_b32 v218, v218, v215
    v_lshlrev_b32 v218, 4, v218
    v_lshl_add_u32 v195, v219, 8, v218
    s_waitcnt lgkmcnt(0)
    s_add_u32 s8, s8, s3
    s_addc_u32 s9, s9, 0
    s_mov_b32 s10, 0x80000
    s_mov_b32 s11, 0x00020000
    s_add_u32 s12, s12, s3
    s_addc_u32 s13, s13, 0
    s_mov_b32 s14, 0x80000
    s_mov_b32 s15, 0x00020000
    v_mov_b32 v212, 0xff800000
    v_mov_b32 v213, 0xff800000
    v_mov_b32 v214, 0xff800000
    v_mov_b32 v215, 0xff800000
    s_mov_b32 s47, 0
L2_mx:
    s_add_u32 m0, s45, 0x0
    s_nop 0
    buffer_load_dwordx4 v192, s[8:11], s47 offen lds
    buffer_load_dwordx4 v193, s[8:11], s47 offen offset:1024 lds
    s_waitcnt vmcnt(0)
    s_barrier
    ds_read_b128 a[128:131], v180 offset:0
    ds_read_b128 a[132:135], v180 offset:4096
    ds_read_b128 a[136:139], v181 offset:0
    ds_read_b128 a[140:143], v181 offset:4096
    ds_read_b128 a[144:147], v182 offset:0
    ds_read_b128 a[148:151], v182 offset:4096
    ds_read_b128 a[152:155], v183 offset:0
    ds_read_b128 a[156:159], v183 offset:4096
    s_waitcnt lgkmcnt(0)
    s_barrier
    v_mfma_f32_16x16x32_bf16 v[64:67], a[128:131], v[0:3], 0
    v_mfma_f32_16x16x32_bf16 v[68:71], a[128:131], v[4:7], 0
    v_mfma_f32_16x16x32_bf16 v[72:75], a[128:131], v[8:11], 0
    v_mfma_f32_16x16x32_bf16 v[76:79], a[128:131], v[12:15], 0
    v_mfma_f32_16x16x32_bf16 v[80:83], a[132:135], v[0:3], 0
    v_mfma_f32_16x16x32_bf16 v[84:87], a[132:135], v[4:7], 0
    v_mfma_f32_16x16x32_bf16 v[88:91], a[132:135], v[8:11], 0
    v_mfma_f32_16x16x32_bf16 v[92:95], a[132:135], v[12:15], 0
    v_mfma_f32_16x16x32_bf16 v[64:67], a[136:139], v[16:19], v[64:67]
    v_mfma_f32_16x16x32_bf16 v[68:71], a[136:139], v[20:23], v[68:71]
    v_mfma_f32_16x16x32_bf16 v[72:75], a[136:139], v[24:27], v[72:75]
    v_mfma_f32_16x16x32_bf16 v[76:79], a[136:139], v[28:31], v[76:79]
    v_mfma_f32_16x16x32_bf16 v[80:83], a[140:143], v[16:19], v[80:83]
    v_mfma_f32_16x16x32_bf16 v[84:87], a[140:143], v[20:23], v[84:87]
    v_mfma_f32_16x16x32_bf16 v[88:91], a[140:143], v[24:27], v[88:91]
    v_mfma_f32_16x16x32_bf16 v[92:95], a[140:143], v[28:31], v[92:95]
    v_mfma_f32_16x16x32_bf16 v[64:67], a[144:147], v[32:35], v[64:67]
    v_mfma_f32_16x16x32_bf16 v[68:71], a[144:147], v[36:39], v[68:71]
    v_mfma_f32_16x16x32_bf16 v[72:75], a[144:147], v[40:43], v[72:75]
    v_mfma_f32_16x16x32_bf16 v[76:79], a[144:147], v[44:47], v[76:79]
    v_mfma_f32_16x16x32_bf16 v[80:83], a[148:151], v[32:35], v[80:83]
    v_mfma_f32_16x16x32_bf16 v[84:87], a[148:151], v[36:39], v[84:87]
    v_mfma_f32_16x16x32_bf16 v[88:91], a[148:151], v[40:43], v[88:91]
    v_mfma_f32_16x16x32_bf16 v[92:95], a[148:151], v[44:47], v[92:95]
    v_mfma_f32_16x16x32_bf16 v[64:67], a[152:155], v[48:51], v[64:67]
    v_mfma_f32_16x16x32_bf16 v[68:71], a[152:155], v[52:55], v[68:71]
    v_mfma_f32_16x16x32_bf16 v[72:75], a[152:155], v[56:59], v[72:75]
    v_mfma_f32_16x16x32_bf16 v[76:79], a[152:155], v[60:63], v[76:79]
    v_mfma_f32_16x16x32_bf16 v[80:83], a[156:159], v[48:51], v[80:83]
    v_mfma_f32_16x16x32_bf16 v[84:87], a[156:159], v[52:55], v[84:87]
    v_mfma_f32_16x16x32_bf16 v[88:91], a[156:159], v[56:59], v[88:91]
    v_mfma_f32_16x16x32_bf16 v[92:95], a[156:159], v[60:63], v[92:95]
    s_nop 0
    v_max3_f32 v212, v212, v64, v65
    v_max3_f32 v212, v212, v66, v67
    s_nop 1
    v_max3_f32 v212, v212, v80, v81
    v_max3_f32 v212, v212, v82, v83
    v_max3_f32 v213, v213, v68, v69
    v_max3_f32 v213, v213, v70, v71
    v_max3_f32 v213, v213, v84, v85
    v_max3_f32 v213, v213, v86, v87
    v_max3_f32 v214, v214, v72, v73
    v_max3_f32 v214, v214, v74, v75
    v_max3_f32 v214, v214, v88, v89
    v_max3_f32 v214, v214, v90, v91
    v_max3_f32 v215, v215, v76, v77
    v_max3_f32 v215, v215, v78, v79
    v_max3_f32 v215, v215, v92, v93
    v_max3_f32 v215, v215, v94, v95
    s_add_u32 s47, s47, 8192
    s_cmp_lt_u32 s47, 0x80000
    s_cbranch_scc1 L2_mx
    v_mov_b32 v220, v212
    s_nop 1
    v_permlane16_swap_b32 v212, v220
    v_max_f32 v212, v212, v220
    v_mov_b32 v220, v212
    s_nop 1
    v_permlane32_swap_b32 v212, v220
    v_max_f32 v212, v212, v220
    v_mov_b32 v221, v213
    s_nop 1
    v_permlane16_swap_b32 v213, v221
    v_max_f32 v213, v213, v221
    v_mov_b32 v221, v213
    s_nop 1
    v_permlane32_swap_b32 v213, v221
    v_max_f32 v213, v213, v221
    v_mov_b32 v222, v214
    s_nop 1
    v_permlane16_swap_b32 v214, v222
    v_max_f32 v214, v214, v222
    v_mov_b32 v222, v214
    s_nop 1
    v_permlane32_swap_b32 v214, v222
    v_max_f32 v214, v214, v222
    v_mov_b32 v223, v215
    s_nop 1
    v_permlane16_swap_b32 v215, v223
    v_max_f32 v215, v215, v223
    v_mov_b32 v223, v215
    s_nop 1
    v_permlane32_swap_b32 v215, v223
    v_max_f32 v215, v215, v223
    v_sub_f32 v160, 0, v212
    v_sub_f32 v161, 0, v212
    v_sub_f32 v162, 0, v212
    v_sub_f32 v163, 0, v212
    v_sub_f32 v164, 0, v213
    v_sub_f32 v165, 0, v213
    v_sub_f32 v166, 0, v213
    v_sub_f32 v167, 0, v213
    v_sub_f32 v168, 0, v214
    v_sub_f32 v169, 0, v214
    v_sub_f32 v170, 0, v214
    v_sub_f32 v171, 0, v214
    v_sub_f32 v172, 0, v215
    v_sub_f32 v173, 0, v215
    v_sub_f32 v174, 0, v215
    v_sub_f32 v175, 0, v215
    s_mov_b32 s50, 1
    s_add_u32 m0, s45, 0x0
    s_mov_b32 s51, 0x0
    buffer_load_dwordx4 v192, s[8:11], s51 offen lds
    buffer_load_dwordx4 v193, s[8:11], s51 offen offset:1024 lds
    s_add_u32 m0, s45, 0x2000
    s_mov_b32 s51, 0x2000
    buffer_load_dwordx4 v192, s[8:11], s51 offen lds
    buffer_load_dwordx4 v193, s[8:11], s51 offen offset:1024 lds
    s_add_u32 m0, s45, 0x4000
    s_mov_b32 s51, 0x4000
    buffer_load_dwordx4 v192, s[8:11], s51 offen lds
    buffer_load_dwordx4 v193, s[8:11], s51 offen offset:1024 lds
    s_add_u32 m0, s45, 0x6000
    s_mov_b32 s51, 0x6000
    buffer_load_dwordx4 v192, s[8:11], s51 offen lds
    buffer_load_dwordx4 v193, s[8:11], s51 offen offset:1024 lds
    s_add_u32 m0, s45, 0x8000
    s_mov_b32 s51, 0x8000
    buffer_load_dwordx4 v192, s[8:11], s51 offen lds
    buffer_load_dwordx4 v193, s[8:11], s51 offen offset:1024 lds
    s_add_u32 m0, s45, 0xa000
    s_mov_b32 s51, 0xa000
    buffer_load_dwordx4 v192, s[8:11], s51 offen lds
    buffer_load_dwordx4 v193, s[8:11], s51 offen offset:1024 lds
    s_add_u32 m0, s45, 0xc000
    s_mov_b32 s51, 0xc000
    buffer_load_dwordx4 v192, s[8:11], s51 offen lds
    buffer_load_dwordx4 v193, s[8:11], s51 offen offset:1024 lds
    s_add_u32 m0, s45, 0xe000
    s_mov_b32 s51, 0xe000
    buffer_load_dwordx4 v192, s[8:11], s51 offen lds
    buffer_load_dwordx4 v193, s[8:11], s51 offen offset:1024 lds
    s_add_u32 m0, s45, 0x10000
    s_mov_b32 s51, 0x0
    buffer_load_dwordx4 v194, s[12:15], s51 offen lds
    buffer_load_dwordx4 v195, s[12:15], s51 offen offset:1024 lds
    s_add_u32 m0, s45, 0x12000
    s_mov_b32 s51, 0x2000
    buffer_load_dwordx4 v194, s[12:15], s51 offen lds
    buffer_load_dwordx4 v195, s[12:15], s51 offen offset:1024 lds
    s_add_u32 m0, s45, 0x14000
    s_mov_b32 s51, 0x4000
    buffer_load_dwordx4 v194, s[12:15], s51 offen lds
    buffer_load_dwordx4 v195, s[12:15], s51 offen offset:1024 lds
    s_add_u32 m0, s45, 0x16000
    s_mov_b32 s51, 0x6000
    buffer_load_dwordx4 v194, s[12:15], s51 offen lds
    buffer_load_dwordx4 v195, s[12:15], s51 offen offset:1024 lds
    s_add_u32 m0, s45, 0x18000
    s_mov_b32 s51, 0x8000
    buffer_load_dwordx4 v194, s[12:15], s51 offen lds
    buffer_load_dwordx4 v195, s[12:15], s51 offen offset:1024 lds
    s_mov_b32 s6, 0
    s_mov_b32 s7, 64
    s_mov_b32 s75, 0xffff
    s_waitcnt vmcnt(0)
    s_barrier
    s_branch L2_att
L2_end:
    s_endpgm
.section .rodata,"a"
.p2align 6
.amdhsa_kernel recurrent_scan__mha_block_cached__dense_activation_silu__prompt_kernel
  .amdhsa_next_free_vgpr 512
  .amdhsa_next_free_sgpr 102
  .amdhsa_accum_offset 256
  .amdhsa_group_segment_fixed_size 0
  .amdhsa_kernarg_size 88
  .amdhsa_user_sgpr_count 2
  .amdhsa_user_sgpr_kernarg_segment_ptr 1
  .amdhsa_system_sgpr_workgroup_id_x 1
  .amdhsa_float_denorm_mode_32 3
.end_amdhsa_kernel
.text
```
